```python
import torch

def _softmax(x, axis=-1):
    return torch.softmax(x, dim=axis)
def _gelu(x):
    return torch.nn.functional.gelu(x, approximate="tanh")
def _silu(x):
    return torch.nn.functional.silu(x)
def _sigmoid(x):
    return torch.sigmoid(x)
def _layernorm(x, axis=-1, eps=1e-5):
    m = x.mean(dim=axis, keepdim=True)
    v = x.var(dim=axis, keepdim=True, unbiased=False)
    return (x - m) / torch.sqrt(v + eps)
def _scatter_add(tgt, idx, src, axis=0):
    return tgt.clone().index_add_(axis, idx, src)
def _segment_sum(src, seg, n):
    out = torch.zeros((n,) + src.shape[1:], dtype=src.dtype)
    return out.index_add_(0, seg, src)
def _pad(x, pw):
    flat = tuple(v for pair in reversed(pw) for v in pair)
    return torch.nn.functional.pad(x, flat)

kernel_name = 'parallel_sum__linear_kernel_hedgehog__mixer_token_mlp__prompt'

def setup_inputs():

    _w = (lambda a: (lambda t: t.to(torch.bfloat16) if t.is_floating_point() else t)(torch.as_tensor(a)))
    def _A_setup():
        B, S, D, H = 1, 2048, 640, 32
        Dh = D // H
        return {
            "x": _w((lambda *s: torch.randn(*s, dtype=torch.bfloat16) * 0.05)(B, S, D)),
            "wqkv": _w((lambda *s: torch.randn(*s, dtype=torch.bfloat16) * 0.2)(D, 3 * D)),
            "w_phi": _w((lambda *s: torch.randn(*s, dtype=torch.bfloat16) * 0.2)(H, Dh, Dh) * (Dh ** -0.5)),
            "wo": _w((lambda *s: torch.randn(*s, dtype=torch.bfloat16) * 0.05)(D, D)),
        }
    _A_in = _A_setup()

    def _B_setup():
        B, S, D, F = 1, 2048, 640, 1728
        return {
            "x": _w((lambda *s: torch.randn(*s, dtype=torch.bfloat16) * 0.05)(B, S, D)),
            "w1": _w((lambda *s: torch.randn(*s, dtype=torch.bfloat16) * 0.8)(S, F) * (S ** -0.5)),
            "b1": _w((lambda *s: torch.randn(*s, dtype=torch.bfloat16) * 12.8)(F) * 0.02),
            "w2": _w((lambda *s: torch.randn(*s, dtype=torch.bfloat16) * 0.1)(F, S) * (F ** -0.5)),
            "b2": _w((lambda *s: torch.randn(*s, dtype=torch.bfloat16) * 1.6)(S) * 0.02),
        }
    _B_in = _B_setup()

    return {
        "A_x": _A_in["x"],
        "A_wqkv": _A_in["wqkv"],
        "A_w_phi": _A_in["w_phi"],
        "A_wo": _A_in["wo"],
        "B_x": _B_in["x"],
        "B_w1": _B_in["w1"],
        "B_b1": _B_in["b1"],
        "B_w2": _B_in["w2"],
        "B_b2": _B_in["b2"],
    }

def reference(A_x, A_wqkv, A_w_phi, A_wo, B_x, B_w1, B_b1, B_w2, B_b2):
    def _A_ref(x, wqkv, w_phi, wo):
        B, S, D = x.shape
        H = 32; Dh = D // H
        qkv = (lambda x, *d: x.permute(*d))((x @ wqkv).reshape(B, S, 3, H, Dh), 2, 0, 3, 1, 4)
        q, k, v = qkv[0], qkv[1], qkv[2]
        pq = torch.einsum("bhsd,hdf->bhsf", q, w_phi)
        pk = torch.einsum("bhsd,hdf->bhsf", k, w_phi)
        phi_q = torch.concatenate([_softmax(pq, axis=-1), _softmax(-pq, axis=-1)], axis=-1)
        phi_k = torch.concatenate([_softmax(pk, axis=-1), _softmax(-pk, axis=-1)], axis=-1)
        kv = torch.einsum("bhsf,bhsd->bhfd", phi_k, v)
        z  = torch.einsum("bhsf->bhf", phi_k)
        num = torch.einsum("bhqf,bhfd->bhqd", phi_q, kv)
        den = torch.einsum("bhqf,bhf->bhq", phi_q, z)[..., None] + 1e-6
        o = num / den
        return (lambda x, *d: x.permute(*d))(o, 0, 2, 1, 3).reshape(B, S, D) @ wo

    def _B_ref(x, w1, b1, w2, b2):
        B, S, D = x.shape
        h = _layernorm(x, axis=-1)
        u = torch.einsum("bsd,sf->bdf", h, w1) + b1
        u = _gelu(u)
        y = torch.einsum("bdf,fs->bds", u, w2) + b2
        return (lambda x, *d: x.permute(*d))(y, 0, 2, 1)

    x = A_x
    xn = _layernorm(x, axis=-1)
    return x + _A_ref(xn, A_wqkv, A_w_phi, A_wo) + _B_ref(xn, B_w1, B_b1, B_w2, B_b2)
```

```asm
; @launch kernel=kp_kernel grid=(256,1,1) block=(512,1,1) lds=57856
; @launch kernel=k1_kernel grid=(256,1,1) block=(256,1,1) lds=163840
.amdgcn_target "amdgcn-amd-amdhsa--gfx950"
.text
.globl kp_kernel
.p2align 8
.type kp_kernel,@function
kp_kernel:
    s_cmp_ge_u32 s2, 256
    s_cbranch_scc1 KP_end
    s_load_dwordx16 s[64:79], s[0:1], 0
    s_load_dwordx8 s[80:87], s[0:1], 64
    s_getpc_b64 s[44:45]
KP_pc:
    s_sub_u32 s44, s44, KP_pc-kp_kernel
    s_subb_u32 s45, s45, 0
    s_mov_b32 s46, CODE_END-kp_kernel
    s_mov_b32 s47, 0x20000
    s_lshr_b32 s3, s2, 3
    s_lshl_b32 s3, s3, 11
    v_and_b32 v124, 127, v0
    v_lshlrev_b32 v124, 4, v124
    v_cmp_le_u32 vcc, 384, v0
    s_nop 0
    s_and_saveexec_b64 s[4:5], vcc
    s_cbranch_execz KP_nocp
    buffer_load_dwordx4 v[132:135], v124, s[44:47], s3 offen
KP_nocp:
    s_mov_b64 exec, s[4:5]
    v_and_b32 v1, 63, v0
    v_lshrrev_b32 v4, 6, v0
    v_lshrrev_b32 v2, 4, v1
    v_readfirstlane_b32 s24, v4
    v_and_b32 v3, 15, v1
    s_and_b32 s39, s2, 7
    s_lshr_b32 s48, s2, 3
    s_bfe_u32 s38, s2, 0x10001
    s_lshl_b32 s38, s38, 7
    s_bfe_u32 s25, s2, 0x10002
    s_lshl_b32 s25, s25, 6
    s_add_u32 s38, s38, s25
    s_and_b32 s25, s2, 1
    s_lshl_b32 s25, s25, 5
    s_add_u32 s38, s38, s25
    s_add_u32 s38, s38, s48
    s_and_b32 s25, s2, 3
    s_mul_i32 s25, s25, 7
    s_and_b32 s25, s25, 30
    s_lshl_b32 s35, s25, 7
    s_lshr_b32 s25, s2, 6
    s_lshl_b32 s25, s25, 7
    s_bfe_u32 s26, s2, 0x30003
    s_lshl_b32 s26, s26, 3
    s_add_u32 s25, s25, s26
    s_add_u32 s25, s25, s24
    s_mul_i32 s25, s25, 13824
    s_add_u32 s35, s35, s25
    v_lshlrev_b32 v7, 4, v1
    v_and_b32 v5, 31, v1
    s_cmp_lt_u32 s39, 4
    s_cselect_b32 s25, 6912, 0
    s_add_u32 s35, s35, s25
    s_cmp_ge_u32 s24, 4
    s_cbranch_scc1 KP_tr
    v_lshrrev_b32 v4, 5, v1
    v_mul_u32_u24 v6, 1280, v4
    v_lshl_add_u32 v6, v5, 3, v6
    s_lshl_b32 s25, s38, 2
    s_add_u32 s25, s25, s24
    s_mul_i32 s25, s25, 2560
    s_waitcnt lgkmcnt(0)
    s_mov_b32 s8, s64
    s_mov_b32 s9, s65
    s_mov_b32 s10, 2621440
    s_mov_b32 s11, 0x20000
    buffer_load_dwordx2 v[10:11], v6, s[8:11], s25 offen offset:0 nt
    buffer_load_dwordx2 v[12:13], v6, s[8:11], s25 offen offset:256 nt
    buffer_load_dwordx2 v[14:15], v6, s[8:11], s25 offen offset:512 nt
    buffer_load_dwordx2 v[16:17], v6, s[8:11], s25 offen offset:768 nt
    buffer_load_dwordx2 v[18:19], v6, s[8:11], s25 offen offset:1024 nt
    s_branch KP_lnrest
KP_tr:
    s_sub_u32 s24, s24, 4
    s_cmp_lt_u32 s24, 2
    s_cselect_b32 s25, 30, 20
    s_cmp_eq_u32 s24, 3
    s_cselect_b32 s25, 0, s25
    s_cmp_ge_u32 s48, s25
    s_cbranch_scc1 KP_zero
    s_mul_i32 s28, s48, 26
    s_lshr_b32 s28, s28, 8
    s_mul_i32 s25, s28, 10
    s_sub_u32 s29, s48, s25
    s_lshl_b32 s29, s29, 1
    s_add_u32 s29, s29, s24
    s_lshr_b32 s25, s39, 1
    s_mul_i32 s25, s25, 3
    s_add_u32 s25, s25, s28
    s_lshr_b32 s36, s25, 2
    s_and_b32 s37, s25, 3
    s_and_b32 s25, s39, 1
    s_lshl_b32 s25, s25, 2
    s_add_u32 s37, s37, s25
    s_cmp_eq_u32 s24, 2
    s_cselect_b32 s36, 3, s36
    s_cselect_b32 s37, s39, s37
    s_cselect_b32 s29, s48, s29
    s_mov_b32 s15, 0x20000
    s_cmp_eq_u32 s36, 3
    s_cbranch_scc1 KP_wo
    s_mov_b32 s14, 2457600
    s_mov_b32 s30, 4
    s_mov_b32 s31, 16
    s_mov_b32 s32, 3840
    s_mul_i32 s33, s29, 122880
    s_mul_i32 s25, s36, 1280
    s_add_u32 s33, s33, s25
    s_mul_i32 s34, s37, 20
    s_add_u32 s34, s34, s29
    s_mul_i32 s34, s34, 3
    s_add_u32 s34, s34, s36
    s_mul_i32 s34, s34, 5120
    s_add_u32 s34, s34, 5242880
    s_branch KP_go
KP_wo:
    s_mov_b32 s14, 819200
    s_mov_b32 s32, 1280
    s_mul_i32 s34, s37, 20
    s_add_u32 s34, s34, s29
    s_mul_i32 s34, s34, 5120
    s_add_u32 s34, s34, 16142336
    s_and_b32 s25, s29, 7
    s_lshr_b32 s26, s29, 3
    s_cmp_ge_u32 s29, 16
    s_cselect_b32 s30, 40, 20
    s_cselect_b32 s31, 20, 4
    s_lshl_b32 s27, s30, 2
    s_mul_i32 s25, s25, s27
    s_lshl_b32 s26, s26, 3
    s_add_u32 s25, s25, s26
    s_mul_i32 s33, s25, 1280
KP_go:
    s_mul_i32 s25, s37, 160
    s_add_u32 s33, s33, s25
    s_mul_i32 s28, s24, 9216
    s_add_u32 s28, s28, 20992
    v_add_u32 v4, 0, v1
    v_mul_u32_u24 v5, 205, v4
    v_lshrrev_b32 v5, 11, v5
    v_mul_u32_u24 v6, 10, v5
    v_sub_u32 v4, v4, v6
    v_bfe_u32 v6, v5, 2, 2
    v_mul_u32_u24 v6, s30, v6
    v_lshrrev_b32 v9, 4, v5
    v_mad_u32_u24 v6, v9, s31, v6
    v_and_b32 v5, 3, v5
    v_add_u32 v6, v6, v5
    v_mul_u32_u24 v6, s32, v6
    v_lshl_add_u32 v20, v4, 4, v6
    v_add_u32 v4, 64, v1
    v_mul_u32_u24 v5, 205, v4
    v_lshrrev_b32 v5, 11, v5
    v_mul_u32_u24 v6, 10, v5
    v_sub_u32 v4, v4, v6
    v_bfe_u32 v6, v5, 2, 2
    v_mul_u32_u24 v6, s30, v6
    v_lshrrev_b32 v9, 4, v5
    v_mad_u32_u24 v6, v9, s31, v6
    v_and_b32 v5, 3, v5
    v_add_u32 v6, v6, v5
    v_mul_u32_u24 v6, s32, v6
    v_lshl_add_u32 v21, v4, 4, v6
    v_add_u32 v4, 128, v1
    v_mul_u32_u24 v5, 205, v4
    v_lshrrev_b32 v5, 11, v5
    v_mul_u32_u24 v6, 10, v5
    v_sub_u32 v4, v4, v6
    v_bfe_u32 v6, v5, 2, 2
    v_mul_u32_u24 v6, s30, v6
    v_lshrrev_b32 v9, 4, v5
    v_mad_u32_u24 v6, v9, s31, v6
    v_and_b32 v5, 3, v5
    v_add_u32 v6, v6, v5
    v_mul_u32_u24 v6, s32, v6
    v_lshl_add_u32 v22, v4, 4, v6
    v_add_u32 v4, 192, v1
    v_mul_u32_u24 v5, 205, v4
    v_lshrrev_b32 v5, 11, v5
    v_mul_u32_u24 v6, 10, v5
    v_sub_u32 v4, v4, v6
    v_bfe_u32 v6, v5, 2, 2
    v_mul_u32_u24 v6, s30, v6
    v_lshrrev_b32 v9, 4, v5
    v_mad_u32_u24 v6, v9, s31, v6
    v_and_b32 v5, 3, v5
    v_add_u32 v6, v6, v5
    v_mul_u32_u24 v6, s32, v6
    v_lshl_add_u32 v23, v4, 4, v6
    v_add_u32 v4, 256, v1
    v_mul_u32_u24 v5, 205, v4
    v_lshrrev_b32 v5, 11, v5
    v_mul_u32_u24 v6, 10, v5
    v_sub_u32 v4, v4, v6
    v_bfe_u32 v6, v5, 2, 2
    v_mul_u32_u24 v6, s30, v6
    v_lshrrev_b32 v9, 4, v5
    v_mad_u32_u24 v6, v9, s31, v6
    v_and_b32 v5, 3, v5
    v_add_u32 v6, v6, v5
    v_mul_u32_u24 v6, s32, v6
    v_lshl_add_u32 v24, v4, 4, v6
    s_waitcnt lgkmcnt(0)
    s_mov_b32 s16, s68
    s_mov_b32 s17, s69
    s_mov_b32 s18, 25600
    s_mov_b32 s19, 0x20000
    s_cmp_eq_u32 s36, 3
    s_cselect_b32 s12, s70, s66
    s_cselect_b32 s13, s71, s67
    v_lshlrev_b32 v8, 4, v1
    s_cmp_ge_u32 s36, 2
    s_cbranch_scc1 KP_ident
    s_mul_i32 s25, s37, 3200
    s_mov_b32 m0, s28
    s_nop 0
    buffer_load_dwordx4 v8, s[16:19], s25 offen lds
    buffer_load_dwordx4 v8, s[16:19], s25 offen offset:1024 lds
    buffer_load_dwordx4 v8, s[16:19], s25 offen offset:2048 lds
    s_mov_b64 exec, 0xff
    buffer_load_dwordx4 v8, s[16:19], s25 offen offset:3072 lds
    s_mov_b64 exec, -1
    s_branch KP_go2
KP_ident:
    v_add_u32 v8, s28, v8
    v_mov_b32 v10, 0
    v_mov_b32 v11, 0
    v_mov_b32 v12, 0
    v_mov_b32 v13, 0
    ds_write_b128 v8, v[10:13]
    ds_write_b128 v8, v[10:13] offset:1024
    ds_write_b128 v8, v[10:13] offset:2048
    ds_write_b128 v8, v[10:13] offset:3072
    v_mul_u32_u24 v8, 42, v1
    v_add_u32 v8, s28, v8
    v_mov_b32 v10, 0x3f80
    s_mov_b64 exec, 0xfffff
    ds_write_b16 v8, v10
    ds_write_b16 v8, v10 offset:800
    ds_write_b16 v8, v10 offset:1600
    ds_write_b16 v8, v10 offset:2400
    s_mov_b64 exec, -1
KP_go2:
    s_add_u32 m0, s28, 4096
    s_nop 0
    buffer_load_dwordx4 v20, s[12:15], s33 offen nt lds
    s_add_u32 m0, s28, 5120
    s_nop 0
    buffer_load_dwordx4 v21, s[12:15], s33 offen nt lds
    s_add_u32 m0, s28, 6144
    s_nop 0
    buffer_load_dwordx4 v22, s[12:15], s33 offen nt lds
    s_add_u32 m0, s28, 7168
    s_nop 0
    buffer_load_dwordx4 v23, s[12:15], s33 offen nt lds
    s_add_u32 m0, s28, 8192
    s_nop 0
    buffer_load_dwordx4 v24, s[12:15], s33 offen nt lds
    s_mov_b32 s20, s86
    s_mov_b32 s21, s87
    s_mov_b32 s22, 16961536
    s_mov_b32 s23, 0x20000
    s_mov_b32 s40, s74
    s_mov_b32 s41, s75
    s_mov_b32 s42, 7077888
    s_mov_b32 s43, 0x20000
    s_barrier
    buffer_load_dwordx4 v[120:123], v7, s[40:43], s35 offen
    s_add_u32 s35, s35, 3456
    buffer_load_dwordx4 v[120:123], v7, s[40:43], s35 offen
    s_add_u32 s35, s35, 3456
KP_npf_4:
    v_lshrrev_b32 v5, 2, v3
    v_lshl_add_u32 v4, v2, 3, v5
    v_mul_u32_u24 v4, 40, v4
    v_add_u32 v4, s28, v4
    v_lshl_add_u32 v6, v2, 2, v5
    v_mul_u32_u24 v6, 40, v6
    v_add_u32 v6, s28, v6
    v_lshlrev_b32 v8, 1, v2
    v_add_u32 v8, 0, v8
    v_mul_u32_u24 v8, 52, v8
    v_lshrrev_b32 v8, 8, v8
    v_cmp_eq_u32 vcc, v8, v5
    s_nop 1
    v_cndmask_b32 v124, 0, -1, vcc
    v_lshlrev_b32 v8, 1, v2
    v_add_u32 v8, 1, v8
    v_mul_u32_u24 v8, 52, v8
    v_lshrrev_b32 v8, 8, v8
    v_cmp_eq_u32 vcc, v8, v5
    s_nop 1
    v_cndmask_b32 v125, 0, -1, vcc
    v_lshlrev_b32 v8, 1, v2
    v_add_u32 v8, 8, v8
    v_mul_u32_u24 v8, 52, v8
    v_lshrrev_b32 v8, 8, v8
    v_cmp_eq_u32 vcc, v8, v5
    s_nop 1
    v_cndmask_b32 v126, 0, -1, vcc
    v_lshlrev_b32 v8, 1, v2
    v_add_u32 v8, 9, v8
    v_mul_u32_u24 v8, 52, v8
    v_lshrrev_b32 v8, 8, v8
    v_cmp_eq_u32 vcc, v8, v5
    s_nop 1
    v_cndmask_b32 v127, 0, -1, vcc
    v_cmp_eq_u32 vcc, 3, v5
    s_nop 1
    v_cndmask_b32 v128, 0, -1, vcc
    v_mul_u32_u24 v8, 160, v3
    v_add_u32 v8, s28, v8
    v_lshl_add_u32 v9, v2, 3, v8
    v_lshl_add_u32 v8, v2, 4, v8
    s_cmp_lt_u32 s39, 4
    s_cbranch_scc1 KP_w_5
    s_waitcnt vmcnt(7)
    s_branch KP_w_6
KP_w_5:
    s_waitcnt vmcnt(7)
KP_w_6:
    ds_read_b64_tr_b16 v[30:31], v4 offset:0
    ds_read_b64_tr_b16 v[32:33], v4 offset:160
    ds_read_b64_tr_b16 v[34:35], v4 offset:1280
    ds_read_b64_tr_b16 v[36:37], v4 offset:1440
    ds_read_b64_tr_b16 v[38:39], v6 offset:2560
    ds_read_b64_tr_b16 v[40:41], v4 offset:8
    ds_read_b64_tr_b16 v[42:43], v4 offset:168
    ds_read_b64_tr_b16 v[44:45], v4 offset:1288
    ds_read_b64_tr_b16 v[46:47], v4 offset:1448
    ds_read_b64_tr_b16 v[48:49], v6 offset:2568
    ds_read_b64_tr_b16 v[50:51], v4 offset:16
    ds_read_b64_tr_b16 v[52:53], v4 offset:176
    ds_read_b64_tr_b16 v[54:55], v4 offset:1296
    ds_read_b64_tr_b16 v[56:57], v4 offset:1456
    ds_read_b64_tr_b16 v[58:59], v6 offset:2576
    s_waitcnt lgkmcnt(10)
    ds_read_b64_tr_b16 v[60:61], v4 offset:24
    ds_read_b64_tr_b16 v[62:63], v4 offset:184
    ds_read_b64_tr_b16 v[64:65], v4 offset:1304
    ds_read_b64_tr_b16 v[66:67], v4 offset:1464
    ds_read_b64_tr_b16 v[68:69], v6 offset:2584
    ds_read_b64_tr_b16 v[70:71], v4 offset:32
    ds_read_b64_tr_b16 v[72:73], v4 offset:192
    ds_read_b64_tr_b16 v[74:75], v4 offset:1312
    ds_read_b64_tr_b16 v[76:77], v4 offset:1472
    ds_read_b64_tr_b16 v[78:79], v6 offset:2592
    v_and_b32 v30, v124, v30
    v_and_b32 v31, v124, v31
    v_and_b32 v32, v125, v32
    v_and_b32 v33, v125, v33
    v_and_b32 v34, v126, v34
    v_and_b32 v35, v126, v35
    v_and_b32 v36, v127, v36
    v_and_b32 v37, v127, v37
    v_and_b32 v38, v128, v38
    v_and_b32 v39, v128, v39
    s_waitcnt lgkmcnt(15)
    v_and_b32 v40, v124, v40
    v_and_b32 v41, v124, v41
    v_and_b32 v42, v125, v42
    v_and_b32 v43, v125, v43
    v_and_b32 v44, v126, v44
    v_and_b32 v45, v126, v45
    v_and_b32 v46, v127, v46
    v_and_b32 v47, v127, v47
    v_and_b32 v48, v128, v48
    v_and_b32 v49, v128, v49
    s_waitcnt lgkmcnt(10)
    v_and_b32 v50, v124, v50
    v_and_b32 v51, v124, v51
    v_and_b32 v52, v125, v52
    v_and_b32 v53, v125, v53
    v_and_b32 v54, v126, v54
    v_and_b32 v55, v126, v55
    v_and_b32 v56, v127, v56
    v_and_b32 v57, v127, v57
    v_and_b32 v58, v128, v58
    v_and_b32 v59, v128, v59
    s_waitcnt lgkmcnt(5)
    v_and_b32 v60, v124, v60
    v_and_b32 v61, v124, v61
    v_and_b32 v62, v125, v62
    v_and_b32 v63, v125, v63
    v_and_b32 v64, v126, v64
    v_and_b32 v65, v126, v65
    v_and_b32 v66, v127, v66
    v_and_b32 v67, v127, v67
    v_and_b32 v68, v128, v68
    v_and_b32 v69, v128, v69
    s_waitcnt lgkmcnt(0)
    v_and_b32 v70, v124, v70
    v_and_b32 v71, v124, v71
    v_and_b32 v72, v125, v72
    v_and_b32 v73, v125, v73
    v_and_b32 v74, v126, v74
    v_and_b32 v75, v126, v75
    v_and_b32 v76, v127, v76
    v_and_b32 v77, v127, v77
    v_and_b32 v78, v128, v78
    v_and_b32 v79, v128, v79
    s_barrier
    s_cmp_lt_u32 s39, 4
    s_cbranch_scc1 KP_w_7
    s_waitcnt vmcnt(2)
    s_branch KP_w_8
KP_w_7:
    s_waitcnt vmcnt(2)
KP_w_8:
    ds_read_b128 v[10:13], v8 offset:4096
    ds_read_b128 v[14:17], v8 offset:4160
    ds_read_b64 v[18:19], v9 offset:4224
    ds_read_b128 v[20:23], v8 offset:6656
    ds_read_b128 v[24:27], v8 offset:6720
    ds_read_b64 v[28:29], v9 offset:6784
    s_waitcnt lgkmcnt(0)
    v_mfma_f32_16x16x32_bf16 v[80:83], v[10:13], v[30:33], 0
    v_mfma_f32_16x16x32_bf16 v[84:87], v[20:23], v[30:33], 0
    v_mfma_f32_16x16x32_bf16 v[88:91], v[10:13], v[40:43], 0
    v_mfma_f32_16x16x32_bf16 v[92:95], v[20:23], v[40:43], 0
    v_mfma_f32_16x16x32_bf16 v[96:99], v[10:13], v[50:53], 0
    v_mfma_f32_16x16x32_bf16 v[100:103], v[20:23], v[50:53], 0
    v_mfma_f32_16x16x32_bf16 v[104:107], v[10:13], v[60:63], 0
    v_mfma_f32_16x16x32_bf16 v[108:111], v[20:23], v[60:63], 0
    v_mfma_f32_16x16x32_bf16 v[112:115], v[10:13], v[70:73], 0
    v_mfma_f32_16x16x32_bf16 v[116:119], v[20:23], v[70:73], 0
    v_mfma_f32_16x16x32_bf16 v[80:83], v[14:17], v[34:37], v[80:83]
    v_mfma_f32_16x16x32_bf16 v[84:87], v[24:27], v[34:37], v[84:87]
    v_mfma_f32_16x16x32_bf16 v[88:91], v[14:17], v[44:47], v[88:91]
    v_mfma_f32_16x16x32_bf16 v[92:95], v[24:27], v[44:47], v[92:95]
    v_mfma_f32_16x16x32_bf16 v[96:99], v[14:17], v[54:57], v[96:99]
    v_mfma_f32_16x16x32_bf16 v[100:103], v[24:27], v[54:57], v[100:103]
    v_mfma_f32_16x16x32_bf16 v[104:107], v[14:17], v[64:67], v[104:107]
    v_mfma_f32_16x16x32_bf16 v[108:111], v[24:27], v[64:67], v[108:111]
    v_mfma_f32_16x16x32_bf16 v[112:115], v[14:17], v[74:77], v[112:115]
    v_mfma_f32_16x16x32_bf16 v[116:119], v[24:27], v[74:77], v[116:119]
    v_mfma_f32_16x16x16_bf16 v[80:83], v[18:19], v[38:39], v[80:83]
    v_mfma_f32_16x16x16_bf16 v[84:87], v[28:29], v[38:39], v[84:87]
    v_mfma_f32_16x16x16_bf16 v[88:91], v[18:19], v[48:49], v[88:91]
    v_mfma_f32_16x16x16_bf16 v[92:95], v[28:29], v[48:49], v[92:95]
    v_mfma_f32_16x16x16_bf16 v[96:99], v[18:19], v[58:59], v[96:99]
    v_mfma_f32_16x16x16_bf16 v[100:103], v[28:29], v[58:59], v[100:103]
    v_mfma_f32_16x16x16_bf16 v[104:107], v[18:19], v[68:69], v[104:107]
    v_mfma_f32_16x16x16_bf16 v[108:111], v[28:29], v[68:69], v[108:111]
    v_mfma_f32_16x16x16_bf16 v[112:115], v[18:19], v[78:79], v[112:115]
    v_mfma_f32_16x16x16_bf16 v[116:119], v[28:29], v[78:79], v[116:119]
    v_lshlrev_b32 v4, 4, v1
    v_add_u32 v5, 4096, v4
    v_cvt_pk_bf16_f32 v32, v80, v81
    v_cvt_pk_bf16_f32 v33, v82, v83
    v_cvt_pk_bf16_f32 v34, v84, v85
    v_cvt_pk_bf16_f32 v35, v86, v87
    buffer_store_dwordx4 v[32:35], v4, s[20:23], s34 offen offset:0
    v_cvt_pk_bf16_f32 v36, v88, v89
    v_cvt_pk_bf16_f32 v37, v90, v91
    v_cvt_pk_bf16_f32 v38, v92, v93
    v_cvt_pk_bf16_f32 v39, v94, v95
    buffer_store_dwordx4 v[36:39], v4, s[20:23], s34 offen offset:1024
    v_cvt_pk_bf16_f32 v40, v96, v97
    v_cvt_pk_bf16_f32 v41, v98, v99
    v_cvt_pk_bf16_f32 v42, v100, v101
    v_cvt_pk_bf16_f32 v43, v102, v103
    buffer_store_dwordx4 v[40:43], v4, s[20:23], s34 offen offset:2048
    v_cvt_pk_bf16_f32 v44, v104, v105
    v_cvt_pk_bf16_f32 v45, v106, v107
    v_cvt_pk_bf16_f32 v46, v108, v109
    v_cvt_pk_bf16_f32 v47, v110, v111
    buffer_store_dwordx4 v[44:47], v4, s[20:23], s34 offen offset:3072
    v_cvt_pk_bf16_f32 v48, v112, v113
    v_cvt_pk_bf16_f32 v49, v114, v115
    v_cvt_pk_bf16_f32 v50, v116, v117
    v_cvt_pk_bf16_f32 v51, v118, v119
    buffer_store_dwordx4 v[48:51], v5, s[20:23], s34 offen
    s_add_u32 s24, s24, 4
    s_branch KP_fin
KP_lnrest:
    s_mov_b32 s20, s86
    s_mov_b32 s21, s87
    s_mov_b32 s22, 16961536
    s_mov_b32 s23, 0x20000
    s_mov_b32 s40, s74
    s_mov_b32 s41, s75
    s_mov_b32 s42, 7077888
    s_mov_b32 s43, 0x20000
    s_barrier
    buffer_load_dwordx4 v[120:123], v7, s[40:43], s35 offen
    s_add_u32 s35, s35, 3456
    buffer_load_dwordx4 v[120:123], v7, s[40:43], s35 offen
    s_add_u32 s35, s35, 3456
KP_npf_1:
    s_mul_i32 s26, s24, 2624
    v_mul_u32_u24 v6, 1312, v4
    v_lshl_add_u32 v6, v5, 3, v6
    v_add_u32 v6, s26, v6
    v_mov_b32 v20, 0
    v_mov_b32 v22, 0
    v_mov_b32 v24, 0x3f803f80
    s_cmp_lt_u32 s39, 4
    s_cbranch_scc1 KP_w_2
    s_waitcnt vmcnt(2)
    s_branch KP_w_3
KP_w_2:
    s_waitcnt vmcnt(2)
KP_w_3:
    v_dot2c_f32_bf16 v20, v10, v24
    v_dot2c_f32_bf16 v22, v10, v10
    v_dot2c_f32_bf16 v20, v11, v24
    v_dot2c_f32_bf16 v22, v11, v11
    v_dot2c_f32_bf16 v20, v12, v24
    v_dot2c_f32_bf16 v22, v12, v12
    v_dot2c_f32_bf16 v20, v13, v24
    v_dot2c_f32_bf16 v22, v13, v13
    v_dot2c_f32_bf16 v20, v14, v24
    v_dot2c_f32_bf16 v22, v14, v14
    v_dot2c_f32_bf16 v20, v15, v24
    v_dot2c_f32_bf16 v22, v15, v15
    v_dot2c_f32_bf16 v20, v16, v24
    v_dot2c_f32_bf16 v22, v16, v16
    v_dot2c_f32_bf16 v20, v17, v24
    v_dot2c_f32_bf16 v22, v17, v17
    v_dot2c_f32_bf16 v20, v18, v24
    v_dot2c_f32_bf16 v22, v18, v18
    v_dot2c_f32_bf16 v20, v19, v24
    v_dot2c_f32_bf16 v22, v19, v19
    v_lshlrev_b32 v30, 16, v10
    v_and_b32 v31, 0xffff0000, v10
    v_lshlrev_b32 v32, 16, v11
    v_and_b32 v33, 0xffff0000, v11
    v_lshlrev_b32 v34, 16, v12
    v_and_b32 v35, 0xffff0000, v12
    v_lshlrev_b32 v36, 16, v13
    v_and_b32 v37, 0xffff0000, v13
    v_lshlrev_b32 v38, 16, v14
    v_and_b32 v39, 0xffff0000, v14
    v_lshlrev_b32 v40, 16, v15
    v_and_b32 v41, 0xffff0000, v15
    v_lshlrev_b32 v42, 16, v16
    v_and_b32 v43, 0xffff0000, v16
    v_lshlrev_b32 v44, 16, v17
    v_and_b32 v45, 0xffff0000, v17
    v_lshlrev_b32 v46, 16, v18
    v_and_b32 v47, 0xffff0000, v18
    v_lshlrev_b32 v48, 16, v19
    v_and_b32 v49, 0xffff0000, v19
    v_add_f32_dpp v20, v20, v20 quad_perm:[1,0,3,2] row_mask:0xf bank_mask:0xf
    v_add_f32_dpp v22, v22, v22 quad_perm:[1,0,3,2] row_mask:0xf bank_mask:0xf
    s_nop 0
    v_add_f32_dpp v20, v20, v20 quad_perm:[2,3,0,1] row_mask:0xf bank_mask:0xf
    v_add_f32_dpp v22, v22, v22 quad_perm:[2,3,0,1] row_mask:0xf bank_mask:0xf
    s_nop 0
    v_add_f32_dpp v20, v20, v20 row_half_mirror row_mask:0xf bank_mask:0xf
    v_add_f32_dpp v22, v22, v22 row_half_mirror row_mask:0xf bank_mask:0xf
    s_nop 0
    v_add_f32_dpp v20, v20, v20 row_mirror row_mask:0xf bank_mask:0xf
    v_add_f32_dpp v22, v22, v22 row_mirror row_mask:0xf bank_mask:0xf
    v_mov_b32 v21, v20
    v_mov_b32 v23, v22
    s_nop 0
    v_permlane16_swap_b32 v20, v21
    v_permlane16_swap_b32 v22, v23
    v_add_f32 v20, v20, v21
    v_add_f32 v22, v22, v23
    v_mul_f32 v20, 0x3acccccd, v20
    v_mul_f32 v22, 0x3acccccd, v22
    v_fma_f32 v22, -v20, v20, v22
    v_max_f32 v22, 0, v22
    v_add_f32 v21, 0x3727c5ac, v22
    v_rsq_f32 v26, v21
    s_nop 0
    v_mul_f32 v23, v26, v26
    v_mul_f32 v27, v20, v26
    v_sub_f32 v27, 0, v27
    v_mul_f32 v23, v23, v22
    v_add_f32 v23, 0x3727c5ac, v23
    v_rsq_f32 v28, v23
    v_pk_fma_f32 v[30:31], v[30:31], v[26:27], v[26:27] op_sel:[0,0,1] op_sel_hi:[1,0,1]
    v_pk_fma_f32 v[32:33], v[32:33], v[26:27], v[26:27] op_sel:[0,0,1] op_sel_hi:[1,0,1]
    v_pk_fma_f32 v[34:35], v[34:35], v[26:27], v[26:27] op_sel:[0,0,1] op_sel_hi:[1,0,1]
    v_pk_fma_f32 v[36:37], v[36:37], v[26:27], v[26:27] op_sel:[0,0,1] op_sel_hi:[1,0,1]
    v_pk_fma_f32 v[38:39], v[38:39], v[26:27], v[26:27] op_sel:[0,0,1] op_sel_hi:[1,0,1]
    v_pk_fma_f32 v[40:41], v[40:41], v[26:27], v[26:27] op_sel:[0,0,1] op_sel_hi:[1,0,1]
    v_pk_fma_f32 v[42:43], v[42:43], v[26:27], v[26:27] op_sel:[0,0,1] op_sel_hi:[1,0,1]
    v_pk_fma_f32 v[44:45], v[44:45], v[26:27], v[26:27] op_sel:[0,0,1] op_sel_hi:[1,0,1]
    v_pk_fma_f32 v[46:47], v[46:47], v[26:27], v[26:27] op_sel:[0,0,1] op_sel_hi:[1,0,1]
    v_pk_fma_f32 v[48:49], v[48:49], v[26:27], v[26:27] op_sel:[0,0,1] op_sel_hi:[1,0,1]
    v_cvt_pk_bf16_f32 v50, v30, v31
    v_cvt_pk_bf16_f32 v51, v32, v33
    v_cvt_pk_bf16_f32 v52, v34, v35
    v_cvt_pk_bf16_f32 v53, v36, v37
    v_cvt_pk_bf16_f32 v54, v38, v39
    v_cvt_pk_bf16_f32 v55, v40, v41
    v_cvt_pk_bf16_f32 v56, v42, v43
    v_cvt_pk_bf16_f32 v57, v44, v45
    v_cvt_pk_bf16_f32 v58, v46, v47
    v_cvt_pk_bf16_f32 v59, v48, v49
    ds_write_b64 v6, v[50:51] offset:0
    ds_write_b64 v6, v[52:53] offset:256
    ds_write_b64 v6, v[54:55] offset:512
    ds_write_b64 v6, v[56:57] offset:768
    ds_write_b64 v6, v[58:59] offset:1024
    v_pk_mul_f32 v[30:31], v[30:31], v[28:29] op_sel:[0,0] op_sel_hi:[1,0]
    v_pk_mul_f32 v[32:33], v[32:33], v[28:29] op_sel:[0,0] op_sel_hi:[1,0]
    v_pk_mul_f32 v[34:35], v[34:35], v[28:29] op_sel:[0,0] op_sel_hi:[1,0]
    v_pk_mul_f32 v[36:37], v[36:37], v[28:29] op_sel:[0,0] op_sel_hi:[1,0]
    v_pk_mul_f32 v[38:39], v[38:39], v[28:29] op_sel:[0,0] op_sel_hi:[1,0]
    v_pk_mul_f32 v[40:41], v[40:41], v[28:29] op_sel:[0,0] op_sel_hi:[1,0]
    v_pk_mul_f32 v[42:43], v[42:43], v[28:29] op_sel:[0,0] op_sel_hi:[1,0]
    v_pk_mul_f32 v[44:45], v[44:45], v[28:29] op_sel:[0,0] op_sel_hi:[1,0]
    v_pk_mul_f32 v[46:47], v[46:47], v[28:29] op_sel:[0,0] op_sel_hi:[1,0]
    v_pk_mul_f32 v[48:49], v[48:49], v[28:29] op_sel:[0,0] op_sel_hi:[1,0]
    v_cvt_pk_bf16_f32 v60, v30, v31
    v_cvt_pk_bf16_f32 v61, v32, v33
    v_cvt_pk_bf16_f32 v62, v34, v35
    v_cvt_pk_bf16_f32 v63, v36, v37
    v_cvt_pk_bf16_f32 v64, v38, v39
    v_cvt_pk_bf16_f32 v65, v40, v41
    v_cvt_pk_bf16_f32 v66, v42, v43
    v_cvt_pk_bf16_f32 v67, v44, v45
    v_cvt_pk_bf16_f32 v68, v46, v47
    v_cvt_pk_bf16_f32 v69, v48, v49
    ds_write_b64 v6, v[60:61] offset:10496
    ds_write_b64 v6, v[62:63] offset:10752
    ds_write_b64 v6, v[64:65] offset:11008
    ds_write_b64 v6, v[66:67] offset:11264
    ds_write_b64 v6, v[68:69] offset:11520
    v_and_b32 v4, 7, v0
    v_mul_u32_u24 v70, 1312, v4
    v_bfe_u32 v5, v0, 3, 2
    v_lshl_add_u32 v70, v5, 3, v70
    v_lshrrev_b32 v6, 5, v0
    v_lshl_add_u32 v70, v6, 6, v70
    v_lshlrev_b32 v71, 4, v4
    v_lshl_add_u32 v71, v5, 8, v71
    v_lshl_add_u32 v71, v6, 10, v71
    s_lshr_b32 s25, s38, 1
    s_mul_i32 s25, s25, 20480
    s_and_b32 s26, s38, 1
    s_lshl_b32 s26, s26, 7
    s_add_u32 s25, s25, s26
    s_add_u32 s34, s25, 2621440
    s_lshr_b32 s25, s38, 2
    s_mul_i32 s25, s25, 5120
    s_and_b32 s26, s38, 3
    s_lshl_b32 s26, s26, 8
    s_add_u32 s25, s25, s26
    s_add_u32 s33, s25, 0
    v_lshrrev_b32 v4, 2, v3
    v_mul_u32_u24 v4, 1312, v4
    v_and_b32 v5, 3, v3
    v_mul_u32_u24 v5, 40, v5
    v_add_u32 v4, v4, v5
    s_mov_b32 s27, 322560
    v_lshrrev_b32 v5, 4, v0
    v_add_u32 v5, 0, v5
    v_mul_u32_u24 v6, 52, v5
    v_lshrrev_b32 v6, 8, v6
    v_mul_u32_u24 v74, 120, v6
    v_lshl_add_u32 v74, v5, 3, v74
    v_add_u32 v74, v74, v4
    v_mul_lo_u32 v78, v6, s27
    v_lshl_add_u32 v78, v5, 10, v78
    v_lshl_add_u32 v78, v3, 4, v78
    v_lshrrev_b32 v5, 4, v0
    v_add_u32 v5, 16, v5
    v_mul_u32_u24 v6, 52, v5
    v_lshrrev_b32 v6, 8, v6
    v_mul_u32_u24 v75, 120, v6
    v_lshl_add_u32 v75, v5, 3, v75
    v_add_u32 v75, v75, v4
    v_mul_lo_u32 v79, v6, s27
    v_lshl_add_u32 v79, v5, 10, v79
    v_lshl_add_u32 v79, v3, 4, v79
    v_lshrrev_b32 v5, 4, v0
    v_add_u32 v5, 32, v5
    v_mul_u32_u24 v6, 52, v5
    v_lshrrev_b32 v6, 8, v6
    v_mul_u32_u24 v76, 120, v6
    v_lshl_add_u32 v76, v5, 3, v76
    v_add_u32 v76, v76, v4
    v_mul_lo_u32 v80, v6, s27
    v_lshl_add_u32 v80, v5, 10, v80
    v_lshl_add_u32 v80, v3, 4, v80
    s_waitcnt lgkmcnt(0)
    s_barrier
    ds_read2_b64 v[30:33], v70 offset0:0 offset1:4
    ds_read_b64_tr_b16 v[42:43], v74 offset:10496
    ds_read_b64_tr_b16 v[44:45], v74 offset:15744
    ds_read2_b64 v[34:37], v70 offset0:64 offset1:68
    ds_read_b64_tr_b16 v[46:47], v75 offset:10496
    ds_read_b64_tr_b16 v[48:49], v75 offset:15744
    s_waitcnt lgkmcnt(3)
    buffer_store_dwordx4 v[30:33], v71, s[20:23], s34 offen
    s_add_u32 s34, s34, 8192
    buffer_store_dwordx4 v[42:45], v78, s[20:23], s33 offen
    s_waitcnt lgkmcnt(0)
    buffer_store_dwordx4 v[34:37], v71, s[20:23], s34 offen
    s_add_u32 s34, s34, 8192
    buffer_store_dwordx4 v[46:49], v79, s[20:23], s33 offen
    s_cmp_ge_u32 s24, 2
    s_cbranch_scc1 KP_fin
    ds_read2_b64 v[38:41], v70 offset0:128 offset1:132
    ds_read_b64_tr_b16 v[50:51], v76 offset:10496
    ds_read_b64_tr_b16 v[52:53], v76 offset:15744
    s_waitcnt lgkmcnt(0)
    buffer_store_dwordx4 v[38:41], v71, s[20:23], s34 offen
    buffer_store_dwordx4 v[50:53], v80, s[20:23], s33 offen
    s_branch KP_fin
KP_zero:
    s_waitcnt lgkmcnt(0)
    s_mov_b32 s20, s86
    s_mov_b32 s21, s87
    s_mov_b32 s22, 16961536
    s_mov_b32 s23, 0x20000
    s_mov_b32 s40, s74
    s_mov_b32 s41, s75
    s_mov_b32 s42, 7077888
    s_mov_b32 s43, 0x20000
    s_cmp_eq_u32 s24, 3
    s_cselect_b32 s25, s2, 0x3ff
    s_lshl_b32 s25, s25, 10
    s_add_u32 s24, s24, 4
    s_cmp_ge_u32 s25, 122880
    s_cbranch_scc1 KP_nz
    s_add_u32 s25, s25, 7864320
    v_lshlrev_b32 v4, 4, v1
    v_mov_b32 v10, 0
    v_mov_b32 v11, 0
    v_mov_b32 v12, 0
    v_mov_b32 v13, 0
    buffer_store_dwordx4 v[10:13], v4, s[20:23], s25 offen sc1
KP_nz:
    s_barrier
    buffer_load_dwordx4 v[120:123], v7, s[40:43], s35 offen
    s_add_u32 s35, s35, 3456
    buffer_load_dwordx4 v[120:123], v7, s[40:43], s35 offen
    s_add_u32 s35, s35, 3456
KP_npf_9:
    s_barrier
KP_fin:
KP_end:
    s_endpgm
.globl k1_kernel
.p2align 8
.type k1_kernel,@function
k1_kernel:
    s_cmp_ge_u32 s2, 256
    s_cbranch_scc1 K1_end
    s_load_dwordx16 s[64:79], s[0:1], 0
    s_load_dwordx8 s[80:87], s[0:1], 64
    v_and_b32 v1, 63, v0
    v_lshrrev_b32 v4, 6, v0
    v_lshrrev_b32 v2, 4, v1
    v_readfirstlane_b32 s24, v4
    v_and_b32 v3, 15, v1
    s_and_b32 s25, s2, 7
    s_lshr_b32 s26, s2, 3
    s_and_b32 s29, s25, 3
    s_mul_i32 s29, s29, 28
    s_add_u32 s29, s29, s26
    s_lshr_b32 s27, s29, 3
    s_and_b32 s28, s29, 7
    s_cmp_lt_u32 s25, 4
    s_cbranch_scc1 K1_att
    s_cmp_ge_u32 s26, 28
    s_cbranch_scc1 K1_pf
    s_mul_i32 s33, s24, 30720
    s_mul_i32 s39, s27, 3
    s_add_u32 s39, s39, s28
    s_mul_i32 s38, s24, 1769472
    s_lshl_b32 s29, s27, 8
    s_add_u32 s38, s38, s29
    s_lshl_b32 s29, s28, 2
    s_add_u32 s29, s29, s24
    s_mul_i32 s37, s29, 81920
    s_add_u32 s37, s37, 0
    s_movk_i32 s40, 128
    s_cmp_eq_u32 s27, 13
    s_cselect_b32 s40, 2130706432, s40
    v_lshrrev_b32 v4, 3, v1
    v_and_b32 v5, 6, v4
    v_xor_b32 v5, v5, v1
    v_and_b32 v5, 7, v5
    v_and_b32 v6, 4, v4
    v_add_u32 v4, v4, v6
    v_mul_u32_u24 v6, 3456, v4
    v_lshl_add_u32 v6, v5, 4, v6
    v_add_u32 v7, 54272, v6
    v_add_u32 v8, 11776, v6
    v_add_u32 v9, 66048, v6
    v_lshlrev_b32 v10, 4, v1
    v_add_u32 v11, 4096, v10
    v_lshrrev_b32 v4, 2, v1
    v_lshlrev_b32 v20, 7, v4
    v_and_b32 v5, 3, v1
    v_lshl_add_u32 v20, v5, 3, v20
    v_add_u32 v20, s33, v20
    v_lshrrev_b32 v4, 3, v1
    v_and_b32 v4, 3, v4
    s_lshl_b32 s29, s24, 1
    s_add_u32 s29, s29, 0
    s_and_b32 s30, s29, 3
    s_and_b32 s29, s29, 4
    s_lshl_b32 s29, s29, 10
    v_xor_b32 v5, s30, v4
    v_lshl_add_u32 v12, v5, 5, v20
    v_add_u32 v12, s29, v12
    s_lshl_b32 s29, s24, 1
    s_add_u32 s29, s29, 1
    s_and_b32 s30, s29, 3
    s_and_b32 s29, s29, 4
    s_lshl_b32 s29, s29, 10
    v_xor_b32 v5, s30, v4
    v_lshl_add_u32 v13, v5, 5, v20
    v_add_u32 v13, s29, v13
    s_lshl_b32 s29, s24, 1
    s_add_u32 s29, s29, 2
    s_and_b32 s30, s29, 3
    s_and_b32 s29, s29, 4
    s_lshl_b32 s29, s29, 10
    v_xor_b32 v5, s30, v4
    v_lshl_add_u32 v14, v5, 5, v20
    v_add_u32 v14, s29, v14
    s_lshl_b32 s29, s24, 1
    s_add_u32 s29, s29, 3
    s_and_b32 s30, s29, 3
    s_and_b32 s29, s29, 4
    s_lshl_b32 s29, s29, 10
    v_xor_b32 v5, s30, v4
    v_lshl_add_u32 v15, v5, 5, v20
    v_add_u32 v15, s29, v15
    s_lshl_b32 s29, s24, 1
    s_add_u32 s29, s29, 4
    s_and_b32 s30, s29, 3
    s_and_b32 s29, s29, 4
    s_lshl_b32 s29, s29, 10
    v_xor_b32 v5, s30, v4
    v_lshl_add_u32 v16, v5, 5, v20
    v_add_u32 v16, s29, v16
    s_lshl_b32 s29, s24, 1
    s_add_u32 s29, s29, 5
    s_and_b32 s30, s29, 3
    s_and_b32 s29, s29, 4
    s_lshl_b32 s29, s29, 10
    v_xor_b32 v5, s30, v4
    v_lshl_add_u32 v17, v5, 5, v20
    v_add_u32 v17, s29, v17
    s_lshl_b32 s29, s24, 1
    s_add_u32 s29, s29, 6
    s_and_b32 s30, s29, 3
    s_and_b32 s29, s29, 4
    s_lshl_b32 s29, s29, 10
    v_xor_b32 v5, s30, v4
    v_lshl_add_u32 v18, v5, 5, v20
    v_add_u32 v18, s29, v18
    s_lshl_b32 s29, s24, 1
    s_add_u32 s29, s29, 7
    s_and_b32 s30, s29, 3
    s_and_b32 s29, s29, 4
    s_lshl_b32 s29, s29, 10
    v_xor_b32 v5, s30, v4
    v_lshl_add_u32 v19, v5, 5, v20
    v_add_u32 v19, s29, v19
    s_waitcnt lgkmcnt(0)
    s_mov_b32 s20, s86
    s_mov_b32 s21, s87
    s_mov_b32 s22, 16961536
    s_mov_b32 s23, 0x20000
    s_mov_b32 s8, s74
    s_mov_b32 s9, s75
    s_mov_b32 s10, 7077888
    s_mov_b32 s11, 0x20000
    s_mov_b32 s16, s76
    s_mov_b32 s17, s77
    s_mov_b32 s18, 3456
    s_mov_b32 s19, 0x20000
    s_mov_b32 s12, s78
    s_mov_b32 s13, s79
    s_mov_b32 s14, 7077888
    s_mov_b32 s15, 0x20000
    v_lshlrev_b32 v20, 3, v2
    s_lshl_b32 s29, s27, 8
    s_lshl_b32 s30, s24, 6
    s_add_u32 s29, s29, s30
    buffer_load_dwordx2 v[22:23], v20, s[16:19], s29 offen offset:0
    buffer_load_dwordx2 v[24:25], v20, s[16:19], s29 offen offset:32
    s_add_u32 s32, s39, 0
    s_and_b32 s32, s32, 3
    s_mul_i32 s35, s32, 110592
    s_add_u32 s35, s35, s38
    s_mul_i32 s34, s32, 5120
    s_add_u32 s34, s34, s37
    s_add_u32 m0, s33, 0
    s_add_u32 s36, s35, s40
    buffer_load_dwordx4 v6, s[8:11], s35 offen offset:0 lds
    buffer_load_dwordx4 v7, s[8:11], s35 offen offset:1024 lds
    buffer_load_dwordx4 v8, s[8:11], s35 offen offset:2048 lds
    buffer_load_dwordx4 v9, s[8:11], s35 offen offset:3072 lds
    s_add_u32 m0, s33, 4096
    s_nop 0
    buffer_load_dwordx4 v6, s[8:11], s36 offen offset:0 lds
    buffer_load_dwordx4 v7, s[8:11], s36 offen offset:1024 lds
    buffer_load_dwordx4 v8, s[8:11], s36 offen offset:2048 lds
    buffer_load_dwordx4 v9, s[8:11], s36 offen offset:3072 lds
    buffer_load_dwordx4 v[32:35], v10, s[20:23], s34 offen offset:0
    buffer_load_dwordx4 v[36:39], v10, s[20:23], s34 offen offset:1024
    buffer_load_dwordx4 v[40:43], v10, s[20:23], s34 offen offset:2048
    buffer_load_dwordx4 v[44:47], v10, s[20:23], s34 offen offset:3072
    buffer_load_dwordx4 v[48:51], v11, s[20:23], s34 offen
    s_add_u32 s32, s39, 1
    s_and_b32 s32, s32, 3
    s_mul_i32 s35, s32, 110592
    s_add_u32 s35, s35, s38
    s_mul_i32 s34, s32, 5120
    s_add_u32 s34, s34, s37
    s_add_u32 m0, s33, 8192
    s_add_u32 s36, s35, s40
    buffer_load_dwordx4 v6, s[8:11], s35 offen offset:0 lds
    buffer_load_dwordx4 v7, s[8:11], s35 offen offset:1024 lds
    buffer_load_dwordx4 v8, s[8:11], s35 offen offset:2048 lds
    buffer_load_dwordx4 v9, s[8:11], s35 offen offset:3072 lds
    s_add_u32 m0, s33, 12288
    s_nop 0
    buffer_load_dwordx4 v6, s[8:11], s36 offen offset:0 lds
    buffer_load_dwordx4 v7, s[8:11], s36 offen offset:1024 lds
    buffer_load_dwordx4 v8, s[8:11], s36 offen offset:2048 lds
    buffer_load_dwordx4 v9, s[8:11], s36 offen offset:3072 lds
    buffer_load_dwordx4 v[52:55], v10, s[20:23], s34 offen offset:0
    buffer_load_dwordx4 v[56:59], v10, s[20:23], s34 offen offset:1024
    buffer_load_dwordx4 v[60:63], v10, s[20:23], s34 offen offset:2048
    buffer_load_dwordx4 v[64:67], v10, s[20:23], s34 offen offset:3072
    buffer_load_dwordx4 v[68:71], v11, s[20:23], s34 offen
    s_add_u32 s32, s39, 2
    s_and_b32 s32, s32, 3
    s_mul_i32 s35, s32, 110592
    s_add_u32 s35, s35, s38
    s_mul_i32 s34, s32, 5120
    s_add_u32 s34, s34, s37
    s_add_u32 m0, s33, 16384
    s_add_u32 s36, s35, s40
    buffer_load_dwordx4 v6, s[8:11], s35 offen offset:0 lds
    buffer_load_dwordx4 v7, s[8:11], s35 offen offset:1024 lds
    buffer_load_dwordx4 v8, s[8:11], s35 offen offset:2048 lds
    buffer_load_dwordx4 v9, s[8:11], s35 offen offset:3072 lds
    s_add_u32 m0, s33, 20480
    s_nop 0
    buffer_load_dwordx4 v6, s[8:11], s36 offen offset:0 lds
    buffer_load_dwordx4 v7, s[8:11], s36 offen offset:1024 lds
    buffer_load_dwordx4 v8, s[8:11], s36 offen offset:2048 lds
    buffer_load_dwordx4 v9, s[8:11], s36 offen offset:3072 lds
    buffer_load_dwordx4 v[72:75], v10, s[20:23], s34 offen offset:0
    buffer_load_dwordx4 v[76:79], v10, s[20:23], s34 offen offset:1024
    buffer_load_dwordx4 v[80:83], v10, s[20:23], s34 offen offset:2048
    buffer_load_dwordx4 v[84:87], v10, s[20:23], s34 offen offset:3072
    buffer_load_dwordx4 v[88:91], v11, s[20:23], s34 offen
    s_waitcnt vmcnt(26)
    ds_read_b64_tr_b16 v[92:93], v12 offset:0
    ds_read_b64_tr_b16 v[94:95], v12 offset:2048
    ds_read_b64_tr_b16 v[96:97], v13 offset:0
    ds_read_b64_tr_b16 v[98:99], v13 offset:2048
    ds_read_b64_tr_b16 v[100:101], v14 offset:0
    ds_read_b64_tr_b16 v[102:103], v14 offset:2048
    ds_read_b64_tr_b16 v[104:105], v15 offset:0
    ds_read_b64_tr_b16 v[106:107], v15 offset:2048
    ds_read_b64_tr_b16 v[108:109], v16 offset:0
    ds_read_b64_tr_b16 v[110:111], v16 offset:2048
    ds_read_b64_tr_b16 v[112:113], v17 offset:0
    ds_read_b64_tr_b16 v[114:115], v17 offset:2048
    ds_read_b64_tr_b16 v[116:117], v18 offset:0
    ds_read_b64_tr_b16 v[118:119], v18 offset:2048
    ds_read_b64_tr_b16 v[120:121], v19 offset:0
    ds_read_b64_tr_b16 v[122:123], v19 offset:2048
    s_waitcnt lgkmcnt(0)
    s_add_u32 s32, s39, 3
    s_and_b32 s32, s32, 3
    s_mul_i32 s35, s32, 110592
    s_add_u32 s35, s35, s38
    s_mul_i32 s34, s32, 5120
    s_add_u32 s34, s34, s37
    s_add_u32 m0, s33, 0
    s_add_u32 s36, s35, s40
    v_mfma_f32_16x16x32_bf16 a[0:3], v[92:95], v[32:35], 0
    v_mfma_f32_16x16x32_bf16 a[4:7], v[96:99], v[32:35], 0
    buffer_load_dwordx4 v6, s[8:11], s35 offen offset:0 lds
    v_mfma_f32_16x16x32_bf16 a[40:43], v[100:103], v[32:35], 0
    v_mfma_f32_16x16x32_bf16 a[44:47], v[104:107], v[32:35], 0
    v_mfma_f32_16x16x32_bf16 a[80:83], v[108:111], v[32:35], 0
    buffer_load_dwordx4 v7, s[8:11], s35 offen offset:1024 lds
    v_mfma_f32_16x16x32_bf16 a[84:87], v[112:115], v[32:35], 0
    v_mfma_f32_16x16x32_bf16 a[120:123], v[116:119], v[32:35], 0
    v_mfma_f32_16x16x32_bf16 a[124:127], v[120:123], v[32:35], 0
    buffer_load_dwordx4 v[32:35], v10, s[20:23], s34 offen offset:0
    v_mfma_f32_16x16x32_bf16 a[8:11], v[92:95], v[36:39], 0
    v_mfma_f32_16x16x32_bf16 a[12:15], v[96:99], v[36:39], 0
    buffer_load_dwordx4 v8, s[8:11], s35 offen offset:2048 lds
    v_mfma_f32_16x16x32_bf16 a[48:51], v[100:103], v[36:39], 0
    v_mfma_f32_16x16x32_bf16 a[52:55], v[104:107], v[36:39], 0
    v_mfma_f32_16x16x32_bf16 a[88:91], v[108:111], v[36:39], 0
    buffer_load_dwordx4 v9, s[8:11], s35 offen offset:3072 lds
    v_mfma_f32_16x16x32_bf16 a[92:95], v[112:115], v[36:39], 0
    v_mfma_f32_16x16x32_bf16 a[128:131], v[116:119], v[36:39], 0
    v_mfma_f32_16x16x32_bf16 a[132:135], v[120:123], v[36:39], 0
    buffer_load_dwordx4 v[36:39], v10, s[20:23], s34 offen offset:1024
    v_mfma_f32_16x16x32_bf16 a[16:19], v[92:95], v[40:43], 0
    v_mfma_f32_16x16x32_bf16 a[20:23], v[96:99], v[40:43], 0
    s_add_u32 m0, s33, 4096
    s_nop 0
    buffer_load_dwordx4 v6, s[8:11], s36 offen offset:0 lds
    v_mfma_f32_16x16x32_bf16 a[56:59], v[100:103], v[40:43], 0
    v_mfma_f32_16x16x32_bf16 a[60:63], v[104:107], v[40:43], 0
    v_mfma_f32_16x16x32_bf16 a[96:99], v[108:111], v[40:43], 0
    buffer_load_dwordx4 v7, s[8:11], s36 offen offset:1024 lds
    v_mfma_f32_16x16x32_bf16 a[100:103], v[112:115], v[40:43], 0
    v_mfma_f32_16x16x32_bf16 a[136:139], v[116:119], v[40:43], 0
    v_mfma_f32_16x16x32_bf16 a[140:143], v[120:123], v[40:43], 0
    buffer_load_dwordx4 v[40:43], v10, s[20:23], s34 offen offset:2048
    s_waitcnt vmcnt(22)
    ds_read_b64_tr_b16 v[124:125], v12 offset:8192
    ds_read_b64_tr_b16 v[126:127], v12 offset:10240
    ds_read_b64_tr_b16 v[128:129], v13 offset:8192
    ds_read_b64_tr_b16 v[130:131], v13 offset:10240
    ds_read_b64_tr_b16 v[132:133], v14 offset:8192
    ds_read_b64_tr_b16 v[134:135], v14 offset:10240
    ds_read_b64_tr_b16 v[136:137], v15 offset:8192
    ds_read_b64_tr_b16 v[138:139], v15 offset:10240
    v_mfma_f32_16x16x32_bf16 a[24:27], v[92:95], v[44:47], 0
    v_mfma_f32_16x16x32_bf16 a[28:31], v[96:99], v[44:47], 0
    buffer_load_dwordx4 v8, s[8:11], s36 offen offset:2048 lds
    v_mfma_f32_16x16x32_bf16 a[64:67], v[100:103], v[44:47], 0
    v_mfma_f32_16x16x32_bf16 a[68:71], v[104:107], v[44:47], 0
    v_mfma_f32_16x16x32_bf16 a[104:107], v[108:111], v[44:47], 0
    buffer_load_dwordx4 v9, s[8:11], s36 offen offset:3072 lds
    v_mfma_f32_16x16x32_bf16 a[108:111], v[112:115], v[44:47], 0
    v_mfma_f32_16x16x32_bf16 a[144:147], v[116:119], v[44:47], 0
    v_mfma_f32_16x16x32_bf16 a[148:151], v[120:123], v[44:47], 0
    buffer_load_dwordx4 v[44:47], v10, s[20:23], s34 offen offset:3072
    ds_read_b64_tr_b16 v[140:141], v16 offset:8192
    ds_read_b64_tr_b16 v[142:143], v16 offset:10240
    ds_read_b64_tr_b16 v[144:145], v17 offset:8192
    ds_read_b64_tr_b16 v[146:147], v17 offset:10240
    ds_read_b64_tr_b16 v[148:149], v18 offset:8192
    ds_read_b64_tr_b16 v[150:151], v18 offset:10240
    ds_read_b64_tr_b16 v[152:153], v19 offset:8192
    ds_read_b64_tr_b16 v[154:155], v19 offset:10240
    v_mfma_f32_16x16x32_bf16 a[32:35], v[92:95], v[48:51], 0
    v_mfma_f32_16x16x32_bf16 a[36:39], v[96:99], v[48:51], 0
    v_mfma_f32_16x16x32_bf16 a[72:75], v[100:103], v[48:51], 0
    v_mfma_f32_16x16x32_bf16 a[76:79], v[104:107], v[48:51], 0
    v_mfma_f32_16x16x32_bf16 a[112:115], v[108:111], v[48:51], 0
    v_mfma_f32_16x16x32_bf16 a[116:119], v[112:115], v[48:51], 0
    v_mfma_f32_16x16x32_bf16 a[152:155], v[116:119], v[48:51], 0
    v_mfma_f32_16x16x32_bf16 a[156:159], v[120:123], v[48:51], 0
    buffer_load_dwordx4 v[48:51], v11, s[20:23], s34 offen
    s_waitcnt lgkmcnt(0)
    s_add_u32 s32, s39, 0
    s_and_b32 s32, s32, 3
    s_add_u32 s32, s32, 4
    s_mul_i32 s35, s32, 110592
    s_add_u32 s35, s35, s38
    s_mul_i32 s34, s32, 5120
    s_add_u32 s34, s34, s37
    s_add_u32 m0, s33, 8192
    s_add_u32 s36, s35, s40
    v_mfma_f32_16x16x32_bf16 a[0:3], v[124:127], v[52:55], a[0:3]
    v_mfma_f32_16x16x32_bf16 a[4:7], v[128:131], v[52:55], a[4:7]
    buffer_load_dwordx4 v6, s[8:11], s35 offen offset:0 lds
    v_mfma_f32_16x16x32_bf16 a[40:43], v[132:135], v[52:55], a[40:43]
    v_mfma_f32_16x16x32_bf16 a[44:47], v[136:139], v[52:55], a[44:47]
    v_mfma_f32_16x16x32_bf16 a[80:83], v[140:143], v[52:55], a[80:83]
    buffer_load_dwordx4 v7, s[8:11], s35 offen offset:1024 lds
    v_mfma_f32_16x16x32_bf16 a[84:87], v[144:147], v[52:55], a[84:87]
    v_mfma_f32_16x16x32_bf16 a[120:123], v[148:151], v[52:55], a[120:123]
    v_mfma_f32_16x16x32_bf16 a[124:127], v[152:155], v[52:55], a[124:127]
    buffer_load_dwordx4 v[52:55], v10, s[20:23], s34 offen offset:0
    v_mfma_f32_16x16x32_bf16 a[8:11], v[124:127], v[56:59], a[8:11]
    v_mfma_f32_16x16x32_bf16 a[12:15], v[128:131], v[56:59], a[12:15]
    buffer_load_dwordx4 v8, s[8:11], s35 offen offset:2048 lds
    v_mfma_f32_16x16x32_bf16 a[48:51], v[132:135], v[56:59], a[48:51]
    v_mfma_f32_16x16x32_bf16 a[52:55], v[136:139], v[56:59], a[52:55]
    v_mfma_f32_16x16x32_bf16 a[88:91], v[140:143], v[56:59], a[88:91]
    buffer_load_dwordx4 v9, s[8:11], s35 offen offset:3072 lds
    v_mfma_f32_16x16x32_bf16 a[92:95], v[144:147], v[56:59], a[92:95]
    v_mfma_f32_16x16x32_bf16 a[128:131], v[148:151], v[56:59], a[128:131]
    v_mfma_f32_16x16x32_bf16 a[132:135], v[152:155], v[56:59], a[132:135]
    buffer_load_dwordx4 v[56:59], v10, s[20:23], s34 offen offset:1024
    v_mfma_f32_16x16x32_bf16 a[16:19], v[124:127], v[60:63], a[16:19]
    v_mfma_f32_16x16x32_bf16 a[20:23], v[128:131], v[60:63], a[20:23]
    s_add_u32 m0, s33, 12288
    s_nop 0
    buffer_load_dwordx4 v6, s[8:11], s36 offen offset:0 lds
    v_mfma_f32_16x16x32_bf16 a[56:59], v[132:135], v[60:63], a[56:59]
    v_mfma_f32_16x16x32_bf16 a[60:63], v[136:139], v[60:63], a[60:63]
    v_mfma_f32_16x16x32_bf16 a[96:99], v[140:143], v[60:63], a[96:99]
    buffer_load_dwordx4 v7, s[8:11], s36 offen offset:1024 lds
    v_mfma_f32_16x16x32_bf16 a[100:103], v[144:147], v[60:63], a[100:103]
    v_mfma_f32_16x16x32_bf16 a[136:139], v[148:151], v[60:63], a[136:139]
    v_mfma_f32_16x16x32_bf16 a[140:143], v[152:155], v[60:63], a[140:143]
    buffer_load_dwordx4 v[60:63], v10, s[20:23], s34 offen offset:2048
    s_waitcnt vmcnt(22)
    ds_read_b64_tr_b16 v[92:93], v12 offset:16384
    ds_read_b64_tr_b16 v[94:95], v12 offset:18432
    ds_read_b64_tr_b16 v[96:97], v13 offset:16384
    ds_read_b64_tr_b16 v[98:99], v13 offset:18432
    ds_read_b64_tr_b16 v[100:101], v14 offset:16384
    ds_read_b64_tr_b16 v[102:103], v14 offset:18432
    ds_read_b64_tr_b16 v[104:105], v15 offset:16384
    ds_read_b64_tr_b16 v[106:107], v15 offset:18432
    v_mfma_f32_16x16x32_bf16 a[24:27], v[124:127], v[64:67], a[24:27]
    v_mfma_f32_16x16x32_bf16 a[28:31], v[128:131], v[64:67], a[28:31]
    buffer_load_dwordx4 v8, s[8:11], s36 offen offset:2048 lds
    v_mfma_f32_16x16x32_bf16 a[64:67], v[132:135], v[64:67], a[64:67]
    v_mfma_f32_16x16x32_bf16 a[68:71], v[136:139], v[64:67], a[68:71]
    v_mfma_f32_16x16x32_bf16 a[104:107], v[140:143], v[64:67], a[104:107]
    buffer_load_dwordx4 v9, s[8:11], s36 offen offset:3072 lds
    v_mfma_f32_16x16x32_bf16 a[108:111], v[144:147], v[64:67], a[108:111]
    v_mfma_f32_16x16x32_bf16 a[144:147], v[148:151], v[64:67], a[144:147]
    v_mfma_f32_16x16x32_bf16 a[148:151], v[152:155], v[64:67], a[148:151]
    buffer_load_dwordx4 v[64:67], v10, s[20:23], s34 offen offset:3072
    ds_read_b64_tr_b16 v[108:109], v16 offset:16384
    ds_read_b64_tr_b16 v[110:111], v16 offset:18432
    ds_read_b64_tr_b16 v[112:113], v17 offset:16384
    ds_read_b64_tr_b16 v[114:115], v17 offset:18432
    ds_read_b64_tr_b16 v[116:117], v18 offset:16384
    ds_read_b64_tr_b16 v[118:119], v18 offset:18432
    ds_read_b64_tr_b16 v[120:121], v19 offset:16384
    ds_read_b64_tr_b16 v[122:123], v19 offset:18432
    v_mfma_f32_16x16x32_bf16 a[32:35], v[124:127], v[68:71], a[32:35]
    v_mfma_f32_16x16x32_bf16 a[36:39], v[128:131], v[68:71], a[36:39]
    v_mfma_f32_16x16x32_bf16 a[72:75], v[132:135], v[68:71], a[72:75]
    v_mfma_f32_16x16x32_bf16 a[76:79], v[136:139], v[68:71], a[76:79]
    v_mfma_f32_16x16x32_bf16 a[112:115], v[140:143], v[68:71], a[112:115]
    v_mfma_f32_16x16x32_bf16 a[116:119], v[144:147], v[68:71], a[116:119]
    v_mfma_f32_16x16x32_bf16 a[152:155], v[148:151], v[68:71], a[152:155]
    v_mfma_f32_16x16x32_bf16 a[156:159], v[152:155], v[68:71], a[156:159]
    buffer_load_dwordx4 v[68:71], v11, s[20:23], s34 offen
    s_waitcnt lgkmcnt(0)
    s_add_u32 s32, s39, 1
    s_and_b32 s32, s32, 3
    s_add_u32 s32, s32, 4
    s_mul_i32 s35, s32, 110592
    s_add_u32 s35, s35, s38
    s_mul_i32 s34, s32, 5120
    s_add_u32 s34, s34, s37
    s_add_u32 m0, s33, 16384
    s_add_u32 s36, s35, s40
    v_mfma_f32_16x16x32_bf16 a[0:3], v[92:95], v[72:75], a[0:3]
    v_mfma_f32_16x16x32_bf16 a[4:7], v[96:99], v[72:75], a[4:7]
    buffer_load_dwordx4 v6, s[8:11], s35 offen offset:0 lds
    v_mfma_f32_16x16x32_bf16 a[40:43], v[100:103], v[72:75], a[40:43]
    v_mfma_f32_16x16x32_bf16 a[44:47], v[104:107], v[72:75], a[44:47]
    v_mfma_f32_16x16x32_bf16 a[80:83], v[108:111], v[72:75], a[80:83]
    buffer_load_dwordx4 v7, s[8:11], s35 offen offset:1024 lds
    v_mfma_f32_16x16x32_bf16 a[84:87], v[112:115], v[72:75], a[84:87]
    v_mfma_f32_16x16x32_bf16 a[120:123], v[116:119], v[72:75], a[120:123]
    v_mfma_f32_16x16x32_bf16 a[124:127], v[120:123], v[72:75], a[124:127]
    buffer_load_dwordx4 v[72:75], v10, s[20:23], s34 offen offset:0
    v_mfma_f32_16x16x32_bf16 a[8:11], v[92:95], v[76:79], a[8:11]
    v_mfma_f32_16x16x32_bf16 a[12:15], v[96:99], v[76:79], a[12:15]
    buffer_load_dwordx4 v8, s[8:11], s35 offen offset:2048 lds
    v_mfma_f32_16x16x32_bf16 a[48:51], v[100:103], v[76:79], a[48:51]
    v_mfma_f32_16x16x32_bf16 a[52:55], v[104:107], v[76:79], a[52:55]
    v_mfma_f32_16x16x32_bf16 a[88:91], v[108:111], v[76:79], a[88:91]
    buffer_load_dwordx4 v9, s[8:11], s35 offen offset:3072 lds
    v_mfma_f32_16x16x32_bf16 a[92:95], v[112:115], v[76:79], a[92:95]
    v_mfma_f32_16x16x32_bf16 a[128:131], v[116:119], v[76:79], a[128:131]
    v_mfma_f32_16x16x32_bf16 a[132:135], v[120:123], v[76:79], a[132:135]
    buffer_load_dwordx4 v[76:79], v10, s[20:23], s34 offen offset:1024
    v_mfma_f32_16x16x32_bf16 a[16:19], v[92:95], v[80:83], a[16:19]
    v_mfma_f32_16x16x32_bf16 a[20:23], v[96:99], v[80:83], a[20:23]
    s_add_u32 m0, s33, 20480
    s_nop 0
    buffer_load_dwordx4 v6, s[8:11], s36 offen offset:0 lds
    v_mfma_f32_16x16x32_bf16 a[56:59], v[100:103], v[80:83], a[56:59]
    v_mfma_f32_16x16x32_bf16 a[60:63], v[104:107], v[80:83], a[60:63]
    v_mfma_f32_16x16x32_bf16 a[96:99], v[108:111], v[80:83], a[96:99]
    buffer_load_dwordx4 v7, s[8:11], s36 offen offset:1024 lds
    v_mfma_f32_16x16x32_bf16 a[100:103], v[112:115], v[80:83], a[100:103]
    v_mfma_f32_16x16x32_bf16 a[136:139], v[116:119], v[80:83], a[136:139]
    v_mfma_f32_16x16x32_bf16 a[140:143], v[120:123], v[80:83], a[140:143]
    buffer_load_dwordx4 v[80:83], v10, s[20:23], s34 offen offset:2048
    s_waitcnt vmcnt(22)
    ds_read_b64_tr_b16 v[124:125], v12 offset:0
    ds_read_b64_tr_b16 v[126:127], v12 offset:2048
    ds_read_b64_tr_b16 v[128:129], v13 offset:0
    ds_read_b64_tr_b16 v[130:131], v13 offset:2048
    ds_read_b64_tr_b16 v[132:133], v14 offset:0
    ds_read_b64_tr_b16 v[134:135], v14 offset:2048
    ds_read_b64_tr_b16 v[136:137], v15 offset:0
    ds_read_b64_tr_b16 v[138:139], v15 offset:2048
    v_mfma_f32_16x16x32_bf16 a[24:27], v[92:95], v[84:87], a[24:27]
    v_mfma_f32_16x16x32_bf16 a[28:31], v[96:99], v[84:87], a[28:31]
    buffer_load_dwordx4 v8, s[8:11], s36 offen offset:2048 lds
    v_mfma_f32_16x16x32_bf16 a[64:67], v[100:103], v[84:87], a[64:67]
    v_mfma_f32_16x16x32_bf16 a[68:71], v[104:107], v[84:87], a[68:71]
    v_mfma_f32_16x16x32_bf16 a[104:107], v[108:111], v[84:87], a[104:107]
    buffer_load_dwordx4 v9, s[8:11], s36 offen offset:3072 lds
    v_mfma_f32_16x16x32_bf16 a[108:111], v[112:115], v[84:87], a[108:111]
    v_mfma_f32_16x16x32_bf16 a[144:147], v[116:119], v[84:87], a[144:147]
    v_mfma_f32_16x16x32_bf16 a[148:151], v[120:123], v[84:87], a[148:151]
    buffer_load_dwordx4 v[84:87], v10, s[20:23], s34 offen offset:3072
    ds_read_b64_tr_b16 v[140:141], v16 offset:0
    ds_read_b64_tr_b16 v[142:143], v16 offset:2048
    ds_read_b64_tr_b16 v[144:145], v17 offset:0
    ds_read_b64_tr_b16 v[146:147], v17 offset:2048
    ds_read_b64_tr_b16 v[148:149], v18 offset:0
    ds_read_b64_tr_b16 v[150:151], v18 offset:2048
    ds_read_b64_tr_b16 v[152:153], v19 offset:0
    ds_read_b64_tr_b16 v[154:155], v19 offset:2048
    v_mfma_f32_16x16x32_bf16 a[32:35], v[92:95], v[88:91], a[32:35]
    v_mfma_f32_16x16x32_bf16 a[36:39], v[96:99], v[88:91], a[36:39]
    v_mfma_f32_16x16x32_bf16 a[72:75], v[100:103], v[88:91], a[72:75]
    v_mfma_f32_16x16x32_bf16 a[76:79], v[104:107], v[88:91], a[76:79]
    v_mfma_f32_16x16x32_bf16 a[112:115], v[108:111], v[88:91], a[112:115]
    v_mfma_f32_16x16x32_bf16 a[116:119], v[112:115], v[88:91], a[116:119]
    v_mfma_f32_16x16x32_bf16 a[152:155], v[116:119], v[88:91], a[152:155]
    v_mfma_f32_16x16x32_bf16 a[156:159], v[120:123], v[88:91], a[156:159]
    buffer_load_dwordx4 v[88:91], v11, s[20:23], s34 offen
    s_waitcnt lgkmcnt(0)
    s_add_u32 s32, s39, 2
    s_and_b32 s32, s32, 3
    s_add_u32 s32, s32, 4
    s_mul_i32 s35, s32, 110592
    s_add_u32 s35, s35, s38
    s_mul_i32 s34, s32, 5120
    s_add_u32 s34, s34, s37
    s_add_u32 m0, s33, 0
    s_add_u32 s36, s35, s40
    v_mfma_f32_16x16x32_bf16 a[0:3], v[124:127], v[32:35], a[0:3]
    v_mfma_f32_16x16x32_bf16 a[4:7], v[128:131], v[32:35], a[4:7]
    buffer_load_dwordx4 v6, s[8:11], s35 offen offset:0 lds
    v_mfma_f32_16x16x32_bf16 a[40:43], v[132:135], v[32:35], a[40:43]
    v_mfma_f32_16x16x32_bf16 a[44:47], v[136:139], v[32:35], a[44:47]
    v_mfma_f32_16x16x32_bf16 a[80:83], v[140:143], v[32:35], a[80:83]
    buffer_load_dwordx4 v7, s[8:11], s35 offen offset:1024 lds
    v_mfma_f32_16x16x32_bf16 a[84:87], v[144:147], v[32:35], a[84:87]
    v_mfma_f32_16x16x32_bf16 a[120:123], v[148:151], v[32:35], a[120:123]
    v_mfma_f32_16x16x32_bf16 a[124:127], v[152:155], v[32:35], a[124:127]
    buffer_load_dwordx4 v[32:35], v10, s[20:23], s34 offen offset:0
    v_mfma_f32_16x16x32_bf16 a[8:11], v[124:127], v[36:39], a[8:11]
    v_mfma_f32_16x16x32_bf16 a[12:15], v[128:131], v[36:39], a[12:15]
    buffer_load_dwordx4 v8, s[8:11], s35 offen offset:2048 lds
    v_mfma_f32_16x16x32_bf16 a[48:51], v[132:135], v[36:39], a[48:51]
    v_mfma_f32_16x16x32_bf16 a[52:55], v[136:139], v[36:39], a[52:55]
    v_mfma_f32_16x16x32_bf16 a[88:91], v[140:143], v[36:39], a[88:91]
    buffer_load_dwordx4 v9, s[8:11], s35 offen offset:3072 lds
    v_mfma_f32_16x16x32_bf16 a[92:95], v[144:147], v[36:39], a[92:95]
    v_mfma_f32_16x16x32_bf16 a[128:131], v[148:151], v[36:39], a[128:131]
    v_mfma_f32_16x16x32_bf16 a[132:135], v[152:155], v[36:39], a[132:135]
    buffer_load_dwordx4 v[36:39], v10, s[20:23], s34 offen offset:1024
    v_mfma_f32_16x16x32_bf16 a[16:19], v[124:127], v[40:43], a[16:19]
    v_mfma_f32_16x16x32_bf16 a[20:23], v[128:131], v[40:43], a[20:23]
    s_add_u32 m0, s33, 4096
    s_nop 0
    buffer_load_dwordx4 v6, s[8:11], s36 offen offset:0 lds
    v_mfma_f32_16x16x32_bf16 a[56:59], v[132:135], v[40:43], a[56:59]
    v_mfma_f32_16x16x32_bf16 a[60:63], v[136:139], v[40:43], a[60:63]
    v_mfma_f32_16x16x32_bf16 a[96:99], v[140:143], v[40:43], a[96:99]
    buffer_load_dwordx4 v7, s[8:11], s36 offen offset:1024 lds
    v_mfma_f32_16x16x32_bf16 a[100:103], v[144:147], v[40:43], a[100:103]
    v_mfma_f32_16x16x32_bf16 a[136:139], v[148:151], v[40:43], a[136:139]
    v_mfma_f32_16x16x32_bf16 a[140:143], v[152:155], v[40:43], a[140:143]
    buffer_load_dwordx4 v[40:43], v10, s[20:23], s34 offen offset:2048
    s_waitcnt vmcnt(22)
    ds_read_b64_tr_b16 v[92:93], v12 offset:8192
    ds_read_b64_tr_b16 v[94:95], v12 offset:10240
    ds_read_b64_tr_b16 v[96:97], v13 offset:8192
    ds_read_b64_tr_b16 v[98:99], v13 offset:10240
    ds_read_b64_tr_b16 v[100:101], v14 offset:8192
    ds_read_b64_tr_b16 v[102:103], v14 offset:10240
    ds_read_b64_tr_b16 v[104:105], v15 offset:8192
    ds_read_b64_tr_b16 v[106:107], v15 offset:10240
    v_mfma_f32_16x16x32_bf16 a[24:27], v[124:127], v[44:47], a[24:27]
    v_mfma_f32_16x16x32_bf16 a[28:31], v[128:131], v[44:47], a[28:31]
    buffer_load_dwordx4 v8, s[8:11], s36 offen offset:2048 lds
    v_mfma_f32_16x16x32_bf16 a[64:67], v[132:135], v[44:47], a[64:67]
    v_mfma_f32_16x16x32_bf16 a[68:71], v[136:139], v[44:47], a[68:71]
    v_mfma_f32_16x16x32_bf16 a[104:107], v[140:143], v[44:47], a[104:107]
    buffer_load_dwordx4 v9, s[8:11], s36 offen offset:3072 lds
    v_mfma_f32_16x16x32_bf16 a[108:111], v[144:147], v[44:47], a[108:111]
    v_mfma_f32_16x16x32_bf16 a[144:147], v[148:151], v[44:47], a[144:147]
    v_mfma_f32_16x16x32_bf16 a[148:151], v[152:155], v[44:47], a[148:151]
    buffer_load_dwordx4 v[44:47], v10, s[20:23], s34 offen offset:3072
    ds_read_b64_tr_b16 v[108:109], v16 offset:8192
    ds_read_b64_tr_b16 v[110:111], v16 offset:10240
    ds_read_b64_tr_b16 v[112:113], v17 offset:8192
    ds_read_b64_tr_b16 v[114:115], v17 offset:10240
    ds_read_b64_tr_b16 v[116:117], v18 offset:8192
    ds_read_b64_tr_b16 v[118:119], v18 offset:10240
    ds_read_b64_tr_b16 v[120:121], v19 offset:8192
    ds_read_b64_tr_b16 v[122:123], v19 offset:10240
    v_mfma_f32_16x16x32_bf16 a[32:35], v[124:127], v[48:51], a[32:35]
    v_mfma_f32_16x16x32_bf16 a[36:39], v[128:131], v[48:51], a[36:39]
    v_mfma_f32_16x16x32_bf16 a[72:75], v[132:135], v[48:51], a[72:75]
    v_mfma_f32_16x16x32_bf16 a[76:79], v[136:139], v[48:51], a[76:79]
    v_mfma_f32_16x16x32_bf16 a[112:115], v[140:143], v[48:51], a[112:115]
    v_mfma_f32_16x16x32_bf16 a[116:119], v[144:147], v[48:51], a[116:119]
    v_mfma_f32_16x16x32_bf16 a[152:155], v[148:151], v[48:51], a[152:155]
    v_mfma_f32_16x16x32_bf16 a[156:159], v[152:155], v[48:51], a[156:159]
    buffer_load_dwordx4 v[48:51], v11, s[20:23], s34 offen
    s_waitcnt lgkmcnt(0)
    s_add_u32 s32, s39, 3
    s_and_b32 s32, s32, 3
    s_add_u32 s32, s32, 4
    s_mul_i32 s35, s32, 110592
    s_add_u32 s35, s35, s38
    s_mul_i32 s34, s32, 5120
    s_add_u32 s34, s34, s37
    s_add_u32 m0, s33, 8192
    s_add_u32 s36, s35, s40
    v_mfma_f32_16x16x32_bf16 a[0:3], v[92:95], v[52:55], a[0:3]
    v_mfma_f32_16x16x32_bf16 a[4:7], v[96:99], v[52:55], a[4:7]
    buffer_load_dwordx4 v6, s[8:11], s35 offen offset:0 lds
    v_mfma_f32_16x16x32_bf16 a[40:43], v[100:103], v[52:55], a[40:43]
    v_mfma_f32_16x16x32_bf16 a[44:47], v[104:107], v[52:55], a[44:47]
    v_mfma_f32_16x16x32_bf16 a[80:83], v[108:111], v[52:55], a[80:83]
    buffer_load_dwordx4 v7, s[8:11], s35 offen offset:1024 lds
    v_mfma_f32_16x16x32_bf16 a[84:87], v[112:115], v[52:55], a[84:87]
    v_mfma_f32_16x16x32_bf16 a[120:123], v[116:119], v[52:55], a[120:123]
    v_mfma_f32_16x16x32_bf16 a[124:127], v[120:123], v[52:55], a[124:127]
    buffer_load_dwordx4 v[52:55], v10, s[20:23], s34 offen offset:0
    v_mfma_f32_16x16x32_bf16 a[8:11], v[92:95], v[56:59], a[8:11]
    v_mfma_f32_16x16x32_bf16 a[12:15], v[96:99], v[56:59], a[12:15]
    buffer_load_dwordx4 v8, s[8:11], s35 offen offset:2048 lds
    v_mfma_f32_16x16x32_bf16 a[48:51], v[100:103], v[56:59], a[48:51]
    v_mfma_f32_16x16x32_bf16 a[52:55], v[104:107], v[56:59], a[52:55]
    v_mfma_f32_16x16x32_bf16 a[88:91], v[108:111], v[56:59], a[88:91]
    buffer_load_dwordx4 v9, s[8:11], s35 offen offset:3072 lds
    v_mfma_f32_16x16x32_bf16 a[92:95], v[112:115], v[56:59], a[92:95]
    v_mfma_f32_16x16x32_bf16 a[128:131], v[116:119], v[56:59], a[128:131]
    v_mfma_f32_16x16x32_bf16 a[132:135], v[120:123], v[56:59], a[132:135]
    buffer_load_dwordx4 v[56:59], v10, s[20:23], s34 offen offset:1024
    v_mfma_f32_16x16x32_bf16 a[16:19], v[92:95], v[60:63], a[16:19]
    v_mfma_f32_16x16x32_bf16 a[20:23], v[96:99], v[60:63], a[20:23]
    s_add_u32 m0, s33, 12288
    s_nop 0
    buffer_load_dwordx4 v6, s[8:11], s36 offen offset:0 lds
    v_mfma_f32_16x16x32_bf16 a[56:59], v[100:103], v[60:63], a[56:59]
    v_mfma_f32_16x16x32_bf16 a[60:63], v[104:107], v[60:63], a[60:63]
    v_mfma_f32_16x16x32_bf16 a[96:99], v[108:111], v[60:63], a[96:99]
    buffer_load_dwordx4 v7, s[8:11], s36 offen offset:1024 lds
    v_mfma_f32_16x16x32_bf16 a[100:103], v[112:115], v[60:63], a[100:103]
    v_mfma_f32_16x16x32_bf16 a[136:139], v[116:119], v[60:63], a[136:139]
    v_mfma_f32_16x16x32_bf16 a[140:143], v[120:123], v[60:63], a[140:143]
    buffer_load_dwordx4 v[60:63], v10, s[20:23], s34 offen offset:2048
    s_waitcnt vmcnt(22)
    ds_read_b64_tr_b16 v[124:125], v12 offset:16384
    ds_read_b64_tr_b16 v[126:127], v12 offset:18432
    ds_read_b64_tr_b16 v[128:129], v13 offset:16384
    ds_read_b64_tr_b16 v[130:131], v13 offset:18432
    ds_read_b64_tr_b16 v[132:133], v14 offset:16384
    ds_read_b64_tr_b16 v[134:135], v14 offset:18432
    ds_read_b64_tr_b16 v[136:137], v15 offset:16384
    ds_read_b64_tr_b16 v[138:139], v15 offset:18432
    v_mfma_f32_16x16x32_bf16 a[24:27], v[92:95], v[64:67], a[24:27]
    v_mfma_f32_16x16x32_bf16 a[28:31], v[96:99], v[64:67], a[28:31]
    buffer_load_dwordx4 v8, s[8:11], s36 offen offset:2048 lds
    v_mfma_f32_16x16x32_bf16 a[64:67], v[100:103], v[64:67], a[64:67]
    v_mfma_f32_16x16x32_bf16 a[68:71], v[104:107], v[64:67], a[68:71]
    v_mfma_f32_16x16x32_bf16 a[104:107], v[108:111], v[64:67], a[104:107]
    buffer_load_dwordx4 v9, s[8:11], s36 offen offset:3072 lds
    v_mfma_f32_16x16x32_bf16 a[108:111], v[112:115], v[64:67], a[108:111]
    v_mfma_f32_16x16x32_bf16 a[144:147], v[116:119], v[64:67], a[144:147]
    v_mfma_f32_16x16x32_bf16 a[148:151], v[120:123], v[64:67], a[148:151]
    buffer_load_dwordx4 v[64:67], v10, s[20:23], s34 offen offset:3072
    ds_read_b64_tr_b16 v[140:141], v16 offset:16384
    ds_read_b64_tr_b16 v[142:143], v16 offset:18432
    ds_read_b64_tr_b16 v[144:145], v17 offset:16384
    ds_read_b64_tr_b16 v[146:147], v17 offset:18432
    ds_read_b64_tr_b16 v[148:149], v18 offset:16384
    ds_read_b64_tr_b16 v[150:151], v18 offset:18432
    ds_read_b64_tr_b16 v[152:153], v19 offset:16384
    ds_read_b64_tr_b16 v[154:155], v19 offset:18432
    v_mfma_f32_16x16x32_bf16 a[32:35], v[92:95], v[68:71], a[32:35]
    v_mfma_f32_16x16x32_bf16 a[36:39], v[96:99], v[68:71], a[36:39]
    v_mfma_f32_16x16x32_bf16 a[72:75], v[100:103], v[68:71], a[72:75]
    v_mfma_f32_16x16x32_bf16 a[76:79], v[104:107], v[68:71], a[76:79]
    v_mfma_f32_16x16x32_bf16 a[112:115], v[108:111], v[68:71], a[112:115]
    v_mfma_f32_16x16x32_bf16 a[116:119], v[112:115], v[68:71], a[116:119]
    v_mfma_f32_16x16x32_bf16 a[152:155], v[116:119], v[68:71], a[152:155]
    v_mfma_f32_16x16x32_bf16 a[156:159], v[120:123], v[68:71], a[156:159]
    buffer_load_dwordx4 v[68:71], v11, s[20:23], s34 offen
    s_waitcnt lgkmcnt(0)
    s_add_u32 s32, s39, 0
    s_and_b32 s32, s32, 3
    s_add_u32 s32, s32, 8
    s_mul_i32 s35, s32, 110592
    s_add_u32 s35, s35, s38
    s_mul_i32 s34, s32, 5120
    s_add_u32 s34, s34, s37
    s_add_u32 m0, s33, 16384
    s_add_u32 s36, s35, s40
    v_mfma_f32_16x16x32_bf16 a[0:3], v[124:127], v[72:75], a[0:3]
    v_mfma_f32_16x16x32_bf16 a[4:7], v[128:131], v[72:75], a[4:7]
    buffer_load_dwordx4 v6, s[8:11], s35 offen offset:0 lds
    v_mfma_f32_16x16x32_bf16 a[40:43], v[132:135], v[72:75], a[40:43]
    v_mfma_f32_16x16x32_bf16 a[44:47], v[136:139], v[72:75], a[44:47]
    v_mfma_f32_16x16x32_bf16 a[80:83], v[140:143], v[72:75], a[80:83]
    buffer_load_dwordx4 v7, s[8:11], s35 offen offset:1024 lds
    v_mfma_f32_16x16x32_bf16 a[84:87], v[144:147], v[72:75], a[84:87]
    v_mfma_f32_16x16x32_bf16 a[120:123], v[148:151], v[72:75], a[120:123]
    v_mfma_f32_16x16x32_bf16 a[124:127], v[152:155], v[72:75], a[124:127]
    buffer_load_dwordx4 v[72:75], v10, s[20:23], s34 offen offset:0
    v_mfma_f32_16x16x32_bf16 a[8:11], v[124:127], v[76:79], a[8:11]
    v_mfma_f32_16x16x32_bf16 a[12:15], v[128:131], v[76:79], a[12:15]
    buffer_load_dwordx4 v8, s[8:11], s35 offen offset:2048 lds
    v_mfma_f32_16x16x32_bf16 a[48:51], v[132:135], v[76:79], a[48:51]
    v_mfma_f32_16x16x32_bf16 a[52:55], v[136:139], v[76:79], a[52:55]
    v_mfma_f32_16x16x32_bf16 a[88:91], v[140:143], v[76:79], a[88:91]
    buffer_load_dwordx4 v9, s[8:11], s35 offen offset:3072 lds
    v_mfma_f32_16x16x32_bf16 a[92:95], v[144:147], v[76:79], a[92:95]
    v_mfma_f32_16x16x32_bf16 a[128:131], v[148:151], v[76:79], a[128:131]
    v_mfma_f32_16x16x32_bf16 a[132:135], v[152:155], v[76:79], a[132:135]
    buffer_load_dwordx4 v[76:79], v10, s[20:23], s34 offen offset:1024
    v_mfma_f32_16x16x32_bf16 a[16:19], v[124:127], v[80:83], a[16:19]
    v_mfma_f32_16x16x32_bf16 a[20:23], v[128:131], v[80:83], a[20:23]
    s_add_u32 m0, s33, 20480
    s_nop 0
    buffer_load_dwordx4 v6, s[8:11], s36 offen offset:0 lds
    v_mfma_f32_16x16x32_bf16 a[56:59], v[132:135], v[80:83], a[56:59]
    v_mfma_f32_16x16x32_bf16 a[60:63], v[136:139], v[80:83], a[60:63]
    v_mfma_f32_16x16x32_bf16 a[96:99], v[140:143], v[80:83], a[96:99]
    buffer_load_dwordx4 v7, s[8:11], s36 offen offset:1024 lds
    v_mfma_f32_16x16x32_bf16 a[100:103], v[144:147], v[80:83], a[100:103]
    v_mfma_f32_16x16x32_bf16 a[136:139], v[148:151], v[80:83], a[136:139]
    v_mfma_f32_16x16x32_bf16 a[140:143], v[152:155], v[80:83], a[140:143]
    buffer_load_dwordx4 v[80:83], v10, s[20:23], s34 offen offset:2048
    s_waitcnt vmcnt(22)
    ds_read_b64_tr_b16 v[92:93], v12 offset:0
    ds_read_b64_tr_b16 v[94:95], v12 offset:2048
    ds_read_b64_tr_b16 v[96:97], v13 offset:0
    ds_read_b64_tr_b16 v[98:99], v13 offset:2048
    ds_read_b64_tr_b16 v[100:101], v14 offset:0
    ds_read_b64_tr_b16 v[102:103], v14 offset:2048
    ds_read_b64_tr_b16 v[104:105], v15 offset:0
    ds_read_b64_tr_b16 v[106:107], v15 offset:2048
    v_mfma_f32_16x16x32_bf16 a[24:27], v[124:127], v[84:87], a[24:27]
    v_mfma_f32_16x16x32_bf16 a[28:31], v[128:131], v[84:87], a[28:31]
    buffer_load_dwordx4 v8, s[8:11], s36 offen offset:2048 lds
    v_mfma_f32_16x16x32_bf16 a[64:67], v[132:135], v[84:87], a[64:67]
    v_mfma_f32_16x16x32_bf16 a[68:71], v[136:139], v[84:87], a[68:71]
    v_mfma_f32_16x16x32_bf16 a[104:107], v[140:143], v[84:87], a[104:107]
    buffer_load_dwordx4 v9, s[8:11], s36 offen offset:3072 lds
    v_mfma_f32_16x16x32_bf16 a[108:111], v[144:147], v[84:87], a[108:111]
    v_mfma_f32_16x16x32_bf16 a[144:147], v[148:151], v[84:87], a[144:147]
    v_mfma_f32_16x16x32_bf16 a[148:151], v[152:155], v[84:87], a[148:151]
    buffer_load_dwordx4 v[84:87], v10, s[20:23], s34 offen offset:3072
    ds_read_b64_tr_b16 v[108:109], v16 offset:0
    ds_read_b64_tr_b16 v[110:111], v16 offset:2048
    ds_read_b64_tr_b16 v[112:113], v17 offset:0
    ds_read_b64_tr_b16 v[114:115], v17 offset:2048
    ds_read_b64_tr_b16 v[116:117], v18 offset:0
    ds_read_b64_tr_b16 v[118:119], v18 offset:2048
    ds_read_b64_tr_b16 v[120:121], v19 offset:0
    ds_read_b64_tr_b16 v[122:123], v19 offset:2048
    v_mfma_f32_16x16x32_bf16 a[32:35], v[124:127], v[88:91], a[32:35]
    v_mfma_f32_16x16x32_bf16 a[36:39], v[128:131], v[88:91], a[36:39]
    v_mfma_f32_16x16x32_bf16 a[72:75], v[132:135], v[88:91], a[72:75]
    v_mfma_f32_16x16x32_bf16 a[76:79], v[136:139], v[88:91], a[76:79]
    v_mfma_f32_16x16x32_bf16 a[112:115], v[140:143], v[88:91], a[112:115]
    v_mfma_f32_16x16x32_bf16 a[116:119], v[144:147], v[88:91], a[116:119]
    v_mfma_f32_16x16x32_bf16 a[152:155], v[148:151], v[88:91], a[152:155]
    v_mfma_f32_16x16x32_bf16 a[156:159], v[152:155], v[88:91], a[156:159]
    buffer_load_dwordx4 v[88:91], v11, s[20:23], s34 offen
    s_waitcnt lgkmcnt(0)
    s_add_u32 s32, s39, 1
    s_and_b32 s32, s32, 3
    s_add_u32 s32, s32, 8
    s_mul_i32 s35, s32, 110592
    s_add_u32 s35, s35, s38
    s_mul_i32 s34, s32, 5120
    s_add_u32 s34, s34, s37
    s_add_u32 m0, s33, 0
    s_add_u32 s36, s35, s40
    v_mfma_f32_16x16x32_bf16 a[0:3], v[92:95], v[32:35], a[0:3]
    v_mfma_f32_16x16x32_bf16 a[4:7], v[96:99], v[32:35], a[4:7]
    buffer_load_dwordx4 v6, s[8:11], s35 offen offset:0 lds
    v_mfma_f32_16x16x32_bf16 a[40:43], v[100:103], v[32:35], a[40:43]
    v_mfma_f32_16x16x32_bf16 a[44:47], v[104:107], v[32:35], a[44:47]
    v_mfma_f32_16x16x32_bf16 a[80:83], v[108:111], v[32:35], a[80:83]
    buffer_load_dwordx4 v7, s[8:11], s35 offen offset:1024 lds
    v_mfma_f32_16x16x32_bf16 a[84:87], v[112:115], v[32:35], a[84:87]
    v_mfma_f32_16x16x32_bf16 a[120:123], v[116:119], v[32:35], a[120:123]
    v_mfma_f32_16x16x32_bf16 a[124:127], v[120:123], v[32:35], a[124:127]
    buffer_load_dwordx4 v[32:35], v10, s[20:23], s34 offen offset:0
    v_mfma_f32_16x16x32_bf16 a[8:11], v[92:95], v[36:39], a[8:11]
    v_mfma_f32_16x16x32_bf16 a[12:15], v[96:99], v[36:39], a[12:15]
    buffer_load_dwordx4 v8, s[8:11], s35 offen offset:2048 lds
    v_mfma_f32_16x16x32_bf16 a[48:51], v[100:103], v[36:39], a[48:51]
    v_mfma_f32_16x16x32_bf16 a[52:55], v[104:107], v[36:39], a[52:55]
    v_mfma_f32_16x16x32_bf16 a[88:91], v[108:111], v[36:39], a[88:91]
    buffer_load_dwordx4 v9, s[8:11], s35 offen offset:3072 lds
    v_mfma_f32_16x16x32_bf16 a[92:95], v[112:115], v[36:39], a[92:95]
    v_mfma_f32_16x16x32_bf16 a[128:131], v[116:119], v[36:39], a[128:131]
    v_mfma_f32_16x16x32_bf16 a[132:135], v[120:123], v[36:39], a[132:135]
    buffer_load_dwordx4 v[36:39], v10, s[20:23], s34 offen offset:1024
    v_mfma_f32_16x16x32_bf16 a[16:19], v[92:95], v[40:43], a[16:19]
    v_mfma_f32_16x16x32_bf16 a[20:23], v[96:99], v[40:43], a[20:23]
    s_add_u32 m0, s33, 4096
    s_nop 0
    buffer_load_dwordx4 v6, s[8:11], s36 offen offset:0 lds
    v_mfma_f32_16x16x32_bf16 a[56:59], v[100:103], v[40:43], a[56:59]
    v_mfma_f32_16x16x32_bf16 a[60:63], v[104:107], v[40:43], a[60:63]
    v_mfma_f32_16x16x32_bf16 a[96:99], v[108:111], v[40:43], a[96:99]
    buffer_load_dwordx4 v7, s[8:11], s36 offen offset:1024 lds
    v_mfma_f32_16x16x32_bf16 a[100:103], v[112:115], v[40:43], a[100:103]
    v_mfma_f32_16x16x32_bf16 a[136:139], v[116:119], v[40:43], a[136:139]
    v_mfma_f32_16x16x32_bf16 a[140:143], v[120:123], v[40:43], a[140:143]
    buffer_load_dwordx4 v[40:43], v10, s[20:23], s34 offen offset:2048
    s_waitcnt vmcnt(22)
    ds_read_b64_tr_b16 v[124:125], v12 offset:8192
    ds_read_b64_tr_b16 v[126:127], v12 offset:10240
    ds_read_b64_tr_b16 v[128:129], v13 offset:8192
    ds_read_b64_tr_b16 v[130:131], v13 offset:10240
    ds_read_b64_tr_b16 v[132:133], v14 offset:8192
    ds_read_b64_tr_b16 v[134:135], v14 offset:10240
    ds_read_b64_tr_b16 v[136:137], v15 offset:8192
    ds_read_b64_tr_b16 v[138:139], v15 offset:10240
    v_mfma_f32_16x16x32_bf16 a[24:27], v[92:95], v[44:47], a[24:27]
    v_mfma_f32_16x16x32_bf16 a[28:31], v[96:99], v[44:47], a[28:31]
    buffer_load_dwordx4 v8, s[8:11], s36 offen offset:2048 lds
    v_mfma_f32_16x16x32_bf16 a[64:67], v[100:103], v[44:47], a[64:67]
    v_mfma_f32_16x16x32_bf16 a[68:71], v[104:107], v[44:47], a[68:71]
    v_mfma_f32_16x16x32_bf16 a[104:107], v[108:111], v[44:47], a[104:107]
    buffer_load_dwordx4 v9, s[8:11], s36 offen offset:3072 lds
    v_mfma_f32_16x16x32_bf16 a[108:111], v[112:115], v[44:47], a[108:111]
    v_mfma_f32_16x16x32_bf16 a[144:147], v[116:119], v[44:47], a[144:147]
    v_mfma_f32_16x16x32_bf16 a[148:151], v[120:123], v[44:47], a[148:151]
    buffer_load_dwordx4 v[44:47], v10, s[20:23], s34 offen offset:3072
    ds_read_b64_tr_b16 v[140:141], v16 offset:8192
    ds_read_b64_tr_b16 v[142:143], v16 offset:10240
    ds_read_b64_tr_b16 v[144:145], v17 offset:8192
    ds_read_b64_tr_b16 v[146:147], v17 offset:10240
    ds_read_b64_tr_b16 v[148:149], v18 offset:8192
    ds_read_b64_tr_b16 v[150:151], v18 offset:10240
    ds_read_b64_tr_b16 v[152:153], v19 offset:8192
    ds_read_b64_tr_b16 v[154:155], v19 offset:10240
    v_mfma_f32_16x16x32_bf16 a[32:35], v[92:95], v[48:51], a[32:35]
    v_mfma_f32_16x16x32_bf16 a[36:39], v[96:99], v[48:51], a[36:39]
    v_mfma_f32_16x16x32_bf16 a[72:75], v[100:103], v[48:51], a[72:75]
    v_mfma_f32_16x16x32_bf16 a[76:79], v[104:107], v[48:51], a[76:79]
    v_mfma_f32_16x16x32_bf16 a[112:115], v[108:111], v[48:51], a[112:115]
    v_mfma_f32_16x16x32_bf16 a[116:119], v[112:115], v[48:51], a[116:119]
    v_mfma_f32_16x16x32_bf16 a[152:155], v[116:119], v[48:51], a[152:155]
    v_mfma_f32_16x16x32_bf16 a[156:159], v[120:123], v[48:51], a[156:159]
    buffer_load_dwordx4 v[48:51], v11, s[20:23], s34 offen
    s_waitcnt lgkmcnt(0)
    s_add_u32 s32, s39, 2
    s_and_b32 s32, s32, 3
    s_add_u32 s32, s32, 8
    s_mul_i32 s35, s32, 110592
    s_add_u32 s35, s35, s38
    s_mul_i32 s34, s32, 5120
    s_add_u32 s34, s34, s37
    s_add_u32 m0, s33, 8192
    s_add_u32 s36, s35, s40
    v_mfma_f32_16x16x32_bf16 a[0:3], v[124:127], v[52:55], a[0:3]
    v_mfma_f32_16x16x32_bf16 a[4:7], v[128:131], v[52:55], a[4:7]
    buffer_load_dwordx4 v6, s[8:11], s35 offen offset:0 lds
    v_mfma_f32_16x16x32_bf16 a[40:43], v[132:135], v[52:55], a[40:43]
    v_mfma_f32_16x16x32_bf16 a[44:47], v[136:139], v[52:55], a[44:47]
    v_mfma_f32_16x16x32_bf16 a[80:83], v[140:143], v[52:55], a[80:83]
    buffer_load_dwordx4 v7, s[8:11], s35 offen offset:1024 lds
    v_mfma_f32_16x16x32_bf16 a[84:87], v[144:147], v[52:55], a[84:87]
    v_mfma_f32_16x16x32_bf16 a[120:123], v[148:151], v[52:55], a[120:123]
    v_mfma_f32_16x16x32_bf16 a[124:127], v[152:155], v[52:55], a[124:127]
    buffer_load_dwordx4 v[52:55], v10, s[20:23], s34 offen offset:0
    v_mfma_f32_16x16x32_bf16 a[8:11], v[124:127], v[56:59], a[8:11]
    v_mfma_f32_16x16x32_bf16 a[12:15], v[128:131], v[56:59], a[12:15]
    buffer_load_dwordx4 v8, s[8:11], s35 offen offset:2048 lds
    v_mfma_f32_16x16x32_bf16 a[48:51], v[132:135], v[56:59], a[48:51]
    v_mfma_f32_16x16x32_bf16 a[52:55], v[136:139], v[56:59], a[52:55]
    v_mfma_f32_16x16x32_bf16 a[88:91], v[140:143], v[56:59], a[88:91]
    buffer_load_dwordx4 v9, s[8:11], s35 offen offset:3072 lds
    v_mfma_f32_16x16x32_bf16 a[92:95], v[144:147], v[56:59], a[92:95]
    v_mfma_f32_16x16x32_bf16 a[128:131], v[148:151], v[56:59], a[128:131]
    v_mfma_f32_16x16x32_bf16 a[132:135], v[152:155], v[56:59], a[132:135]
    buffer_load_dwordx4 v[56:59], v10, s[20:23], s34 offen offset:1024
    v_mfma_f32_16x16x32_bf16 a[16:19], v[124:127], v[60:63], a[16:19]
    v_mfma_f32_16x16x32_bf16 a[20:23], v[128:131], v[60:63], a[20:23]
    s_add_u32 m0, s33, 12288
    s_nop 0
    buffer_load_dwordx4 v6, s[8:11], s36 offen offset:0 lds
    v_mfma_f32_16x16x32_bf16 a[56:59], v[132:135], v[60:63], a[56:59]
    v_mfma_f32_16x16x32_bf16 a[60:63], v[136:139], v[60:63], a[60:63]
    v_mfma_f32_16x16x32_bf16 a[96:99], v[140:143], v[60:63], a[96:99]
    buffer_load_dwordx4 v7, s[8:11], s36 offen offset:1024 lds
    v_mfma_f32_16x16x32_bf16 a[100:103], v[144:147], v[60:63], a[100:103]
    v_mfma_f32_16x16x32_bf16 a[136:139], v[148:151], v[60:63], a[136:139]
    v_mfma_f32_16x16x32_bf16 a[140:143], v[152:155], v[60:63], a[140:143]
    buffer_load_dwordx4 v[60:63], v10, s[20:23], s34 offen offset:2048
    s_waitcnt vmcnt(22)
    ds_read_b64_tr_b16 v[92:93], v12 offset:16384
    ds_read_b64_tr_b16 v[94:95], v12 offset:18432
    ds_read_b64_tr_b16 v[96:97], v13 offset:16384
    ds_read_b64_tr_b16 v[98:99], v13 offset:18432
    ds_read_b64_tr_b16 v[100:101], v14 offset:16384
    ds_read_b64_tr_b16 v[102:103], v14 offset:18432
    ds_read_b64_tr_b16 v[104:105], v15 offset:16384
    ds_read_b64_tr_b16 v[106:107], v15 offset:18432
    v_mfma_f32_16x16x32_bf16 a[24:27], v[124:127], v[64:67], a[24:27]
    v_mfma_f32_16x16x32_bf16 a[28:31], v[128:131], v[64:67], a[28:31]
    buffer_load_dwordx4 v8, s[8:11], s36 offen offset:2048 lds
    v_mfma_f32_16x16x32_bf16 a[64:67], v[132:135], v[64:67], a[64:67]
    v_mfma_f32_16x16x32_bf16 a[68:71], v[136:139], v[64:67], a[68:71]
    v_mfma_f32_16x16x32_bf16 a[104:107], v[140:143], v[64:67], a[104:107]
    buffer_load_dwordx4 v9, s[8:11], s36 offen offset:3072 lds
    v_mfma_f32_16x16x32_bf16 a[108:111], v[144:147], v[64:67], a[108:111]
    v_mfma_f32_16x16x32_bf16 a[144:147], v[148:151], v[64:67], a[144:147]
    v_mfma_f32_16x16x32_bf16 a[148:151], v[152:155], v[64:67], a[148:151]
    buffer_load_dwordx4 v[64:67], v10, s[20:23], s34 offen offset:3072
    ds_read_b64_tr_b16 v[108:109], v16 offset:16384
    ds_read_b64_tr_b16 v[110:111], v16 offset:18432
    ds_read_b64_tr_b16 v[112:113], v17 offset:16384
    ds_read_b64_tr_b16 v[114:115], v17 offset:18432
    ds_read_b64_tr_b16 v[116:117], v18 offset:16384
    ds_read_b64_tr_b16 v[118:119], v18 offset:18432
    ds_read_b64_tr_b16 v[120:121], v19 offset:16384
    ds_read_b64_tr_b16 v[122:123], v19 offset:18432
    v_mfma_f32_16x16x32_bf16 a[32:35], v[124:127], v[68:71], a[32:35]
    v_mfma_f32_16x16x32_bf16 a[36:39], v[128:131], v[68:71], a[36:39]
    v_mfma_f32_16x16x32_bf16 a[72:75], v[132:135], v[68:71], a[72:75]
    v_mfma_f32_16x16x32_bf16 a[76:79], v[136:139], v[68:71], a[76:79]
    v_mfma_f32_16x16x32_bf16 a[112:115], v[140:143], v[68:71], a[112:115]
    v_mfma_f32_16x16x32_bf16 a[116:119], v[144:147], v[68:71], a[116:119]
    v_mfma_f32_16x16x32_bf16 a[152:155], v[148:151], v[68:71], a[152:155]
    v_mfma_f32_16x16x32_bf16 a[156:159], v[152:155], v[68:71], a[156:159]
    buffer_load_dwordx4 v[68:71], v11, s[20:23], s34 offen
    s_waitcnt lgkmcnt(0)
    s_add_u32 s32, s39, 3
    s_and_b32 s32, s32, 3
    s_add_u32 s32, s32, 8
    s_mul_i32 s35, s32, 110592
    s_add_u32 s35, s35, s38
    s_mul_i32 s34, s32, 5120
    s_add_u32 s34, s34, s37
    s_add_u32 m0, s33, 16384
    s_add_u32 s36, s35, s40
    v_mfma_f32_16x16x32_bf16 a[0:3], v[92:95], v[72:75], a[0:3]
    v_mfma_f32_16x16x32_bf16 a[4:7], v[96:99], v[72:75], a[4:7]
    buffer_load_dwordx4 v6, s[8:11], s35 offen offset:0 lds
    v_mfma_f32_16x16x32_bf16 a[40:43], v[100:103], v[72:75], a[40:43]
    v_mfma_f32_16x16x32_bf16 a[44:47], v[104:107], v[72:75], a[44:47]
    v_mfma_f32_16x16x32_bf16 a[80:83], v[108:111], v[72:75], a[80:83]
    buffer_load_dwordx4 v7, s[8:11], s35 offen offset:1024 lds
    v_mfma_f32_16x16x32_bf16 a[84:87], v[112:115], v[72:75], a[84:87]
    v_mfma_f32_16x16x32_bf16 a[120:123], v[116:119], v[72:75], a[120:123]
    v_mfma_f32_16x16x32_bf16 a[124:127], v[120:123], v[72:75], a[124:127]
    buffer_load_dwordx4 v[72:75], v10, s[20:23], s34 offen offset:0
    v_mfma_f32_16x16x32_bf16 a[8:11], v[92:95], v[76:79], a[8:11]
    v_mfma_f32_16x16x32_bf16 a[12:15], v[96:99], v[76:79], a[12:15]
    buffer_load_dwordx4 v8, s[8:11], s35 offen offset:2048 lds
    v_mfma_f32_16x16x32_bf16 a[48:51], v[100:103], v[76:79], a[48:51]
    v_mfma_f32_16x16x32_bf16 a[52:55], v[104:107], v[76:79], a[52:55]
    v_mfma_f32_16x16x32_bf16 a[88:91], v[108:111], v[76:79], a[88:91]
    buffer_load_dwordx4 v9, s[8:11], s35 offen offset:3072 lds
    v_mfma_f32_16x16x32_bf16 a[92:95], v[112:115], v[76:79], a[92:95]
    v_mfma_f32_16x16x32_bf16 a[128:131], v[116:119], v[76:79], a[128:131]
    v_mfma_f32_16x16x32_bf16 a[132:135], v[120:123], v[76:79], a[132:135]
    buffer_load_dwordx4 v[76:79], v10, s[20:23], s34 offen offset:1024
    v_mfma_f32_16x16x32_bf16 a[16:19], v[92:95], v[80:83], a[16:19]
    v_mfma_f32_16x16x32_bf16 a[20:23], v[96:99], v[80:83], a[20:23]
    s_add_u32 m0, s33, 20480
    s_nop 0
    buffer_load_dwordx4 v6, s[8:11], s36 offen offset:0 lds
    v_mfma_f32_16x16x32_bf16 a[56:59], v[100:103], v[80:83], a[56:59]
    v_mfma_f32_16x16x32_bf16 a[60:63], v[104:107], v[80:83], a[60:63]
    v_mfma_f32_16x16x32_bf16 a[96:99], v[108:111], v[80:83], a[96:99]
    buffer_load_dwordx4 v7, s[8:11], s36 offen offset:1024 lds
    v_mfma_f32_16x16x32_bf16 a[100:103], v[112:115], v[80:83], a[100:103]
    v_mfma_f32_16x16x32_bf16 a[136:139], v[116:119], v[80:83], a[136:139]
    v_mfma_f32_16x16x32_bf16 a[140:143], v[120:123], v[80:83], a[140:143]
    buffer_load_dwordx4 v[80:83], v10, s[20:23], s34 offen offset:2048
    s_waitcnt vmcnt(22)
    ds_read_b64_tr_b16 v[124:125], v12 offset:0
    ds_read_b64_tr_b16 v[126:127], v12 offset:2048
    ds_read_b64_tr_b16 v[128:129], v13 offset:0
    ds_read_b64_tr_b16 v[130:131], v13 offset:2048
    ds_read_b64_tr_b16 v[132:133], v14 offset:0
    ds_read_b64_tr_b16 v[134:135], v14 offset:2048
    ds_read_b64_tr_b16 v[136:137], v15 offset:0
    ds_read_b64_tr_b16 v[138:139], v15 offset:2048
    v_mfma_f32_16x16x32_bf16 a[24:27], v[92:95], v[84:87], a[24:27]
    v_mfma_f32_16x16x32_bf16 a[28:31], v[96:99], v[84:87], a[28:31]
    buffer_load_dwordx4 v8, s[8:11], s36 offen offset:2048 lds
    v_mfma_f32_16x16x32_bf16 a[64:67], v[100:103], v[84:87], a[64:67]
    v_mfma_f32_16x16x32_bf16 a[68:71], v[104:107], v[84:87], a[68:71]
    v_mfma_f32_16x16x32_bf16 a[104:107], v[108:111], v[84:87], a[104:107]
    buffer_load_dwordx4 v9, s[8:11], s36 offen offset:3072 lds
    v_mfma_f32_16x16x32_bf16 a[108:111], v[112:115], v[84:87], a[108:111]
    v_mfma_f32_16x16x32_bf16 a[144:147], v[116:119], v[84:87], a[144:147]
    v_mfma_f32_16x16x32_bf16 a[148:151], v[120:123], v[84:87], a[148:151]
    buffer_load_dwordx4 v[84:87], v10, s[20:23], s34 offen offset:3072
    ds_read_b64_tr_b16 v[140:141], v16 offset:0
    ds_read_b64_tr_b16 v[142:143], v16 offset:2048
    ds_read_b64_tr_b16 v[144:145], v17 offset:0
    ds_read_b64_tr_b16 v[146:147], v17 offset:2048
    ds_read_b64_tr_b16 v[148:149], v18 offset:0
    ds_read_b64_tr_b16 v[150:151], v18 offset:2048
    ds_read_b64_tr_b16 v[152:153], v19 offset:0
    ds_read_b64_tr_b16 v[154:155], v19 offset:2048
    v_mfma_f32_16x16x32_bf16 a[32:35], v[92:95], v[88:91], a[32:35]
    v_mfma_f32_16x16x32_bf16 a[36:39], v[96:99], v[88:91], a[36:39]
    v_mfma_f32_16x16x32_bf16 a[72:75], v[100:103], v[88:91], a[72:75]
    v_mfma_f32_16x16x32_bf16 a[76:79], v[104:107], v[88:91], a[76:79]
    v_mfma_f32_16x16x32_bf16 a[112:115], v[108:111], v[88:91], a[112:115]
    v_mfma_f32_16x16x32_bf16 a[116:119], v[112:115], v[88:91], a[116:119]
    v_mfma_f32_16x16x32_bf16 a[152:155], v[116:119], v[88:91], a[152:155]
    v_mfma_f32_16x16x32_bf16 a[156:159], v[120:123], v[88:91], a[156:159]
    buffer_load_dwordx4 v[88:91], v11, s[20:23], s34 offen
    s_waitcnt lgkmcnt(0)
    s_add_u32 s32, s39, 0
    s_and_b32 s32, s32, 3
    s_add_u32 s32, s32, 12
    s_mul_i32 s35, s32, 110592
    s_add_u32 s35, s35, s38
    s_mul_i32 s34, s32, 5120
    s_add_u32 s34, s34, s37
    s_add_u32 m0, s33, 0
    s_add_u32 s36, s35, s40
    v_mfma_f32_16x16x32_bf16 a[0:3], v[124:127], v[32:35], a[0:3]
    v_mfma_f32_16x16x32_bf16 a[4:7], v[128:131], v[32:35], a[4:7]
    buffer_load_dwordx4 v6, s[8:11], s35 offen offset:0 lds
    v_mfma_f32_16x16x32_bf16 a[40:43], v[132:135], v[32:35], a[40:43]
    v_mfma_f32_16x16x32_bf16 a[44:47], v[136:139], v[32:35], a[44:47]
    v_mfma_f32_16x16x32_bf16 a[80:83], v[140:143], v[32:35], a[80:83]
    buffer_load_dwordx4 v7, s[8:11], s35 offen offset:1024 lds
    v_mfma_f32_16x16x32_bf16 a[84:87], v[144:147], v[32:35], a[84:87]
    v_mfma_f32_16x16x32_bf16 a[120:123], v[148:151], v[32:35], a[120:123]
    v_mfma_f32_16x16x32_bf16 a[124:127], v[152:155], v[32:35], a[124:127]
    buffer_load_dwordx4 v[32:35], v10, s[20:23], s34 offen offset:0
    v_mfma_f32_16x16x32_bf16 a[8:11], v[124:127], v[36:39], a[8:11]
    v_mfma_f32_16x16x32_bf16 a[12:15], v[128:131], v[36:39], a[12:15]
    buffer_load_dwordx4 v8, s[8:11], s35 offen offset:2048 lds
    v_mfma_f32_16x16x32_bf16 a[48:51], v[132:135], v[36:39], a[48:51]
    v_mfma_f32_16x16x32_bf16 a[52:55], v[136:139], v[36:39], a[52:55]
    v_mfma_f32_16x16x32_bf16 a[88:91], v[140:143], v[36:39], a[88:91]
    buffer_load_dwordx4 v9, s[8:11], s35 offen offset:3072 lds
    v_mfma_f32_16x16x32_bf16 a[92:95], v[144:147], v[36:39], a[92:95]
    v_mfma_f32_16x16x32_bf16 a[128:131], v[148:151], v[36:39], a[128:131]
    v_mfma_f32_16x16x32_bf16 a[132:135], v[152:155], v[36:39], a[132:135]
    buffer_load_dwordx4 v[36:39], v10, s[20:23], s34 offen offset:1024
    v_mfma_f32_16x16x32_bf16 a[16:19], v[124:127], v[40:43], a[16:19]
    v_mfma_f32_16x16x32_bf16 a[20:23], v[128:131], v[40:43], a[20:23]
    s_add_u32 m0, s33, 4096
    s_nop 0
    buffer_load_dwordx4 v6, s[8:11], s36 offen offset:0 lds
    v_mfma_f32_16x16x32_bf16 a[56:59], v[132:135], v[40:43], a[56:59]
    v_mfma_f32_16x16x32_bf16 a[60:63], v[136:139], v[40:43], a[60:63]
    v_mfma_f32_16x16x32_bf16 a[96:99], v[140:143], v[40:43], a[96:99]
    buffer_load_dwordx4 v7, s[8:11], s36 offen offset:1024 lds
    v_mfma_f32_16x16x32_bf16 a[100:103], v[144:147], v[40:43], a[100:103]
    v_mfma_f32_16x16x32_bf16 a[136:139], v[148:151], v[40:43], a[136:139]
    v_mfma_f32_16x16x32_bf16 a[140:143], v[152:155], v[40:43], a[140:143]
    buffer_load_dwordx4 v[40:43], v10, s[20:23], s34 offen offset:2048
    s_waitcnt vmcnt(22)
    ds_read_b64_tr_b16 v[92:93], v12 offset:8192
    ds_read_b64_tr_b16 v[94:95], v12 offset:10240
    ds_read_b64_tr_b16 v[96:97], v13 offset:8192
    ds_read_b64_tr_b16 v[98:99], v13 offset:10240
    ds_read_b64_tr_b16 v[100:101], v14 offset:8192
    ds_read_b64_tr_b16 v[102:103], v14 offset:10240
    ds_read_b64_tr_b16 v[104:105], v15 offset:8192
    ds_read_b64_tr_b16 v[106:107], v15 offset:10240
    v_mfma_f32_16x16x32_bf16 a[24:27], v[124:127], v[44:47], a[24:27]
    v_mfma_f32_16x16x32_bf16 a[28:31], v[128:131], v[44:47], a[28:31]
    buffer_load_dwordx4 v8, s[8:11], s36 offen offset:2048 lds
    v_mfma_f32_16x16x32_bf16 a[64:67], v[132:135], v[44:47], a[64:67]
    v_mfma_f32_16x16x32_bf16 a[68:71], v[136:139], v[44:47], a[68:71]
    v_mfma_f32_16x16x32_bf16 a[104:107], v[140:143], v[44:47], a[104:107]
    buffer_load_dwordx4 v9, s[8:11], s36 offen offset:3072 lds
    v_mfma_f32_16x16x32_bf16 a[108:111], v[144:147], v[44:47], a[108:111]
    v_mfma_f32_16x16x32_bf16 a[144:147], v[148:151], v[44:47], a[144:147]
    v_mfma_f32_16x16x32_bf16 a[148:151], v[152:155], v[44:47], a[148:151]
    buffer_load_dwordx4 v[44:47], v10, s[20:23], s34 offen offset:3072
    ds_read_b64_tr_b16 v[108:109], v16 offset:8192
    ds_read_b64_tr_b16 v[110:111], v16 offset:10240
    ds_read_b64_tr_b16 v[112:113], v17 offset:8192
    ds_read_b64_tr_b16 v[114:115], v17 offset:10240
    ds_read_b64_tr_b16 v[116:117], v18 offset:8192
    ds_read_b64_tr_b16 v[118:119], v18 offset:10240
    ds_read_b64_tr_b16 v[120:121], v19 offset:8192
    ds_read_b64_tr_b16 v[122:123], v19 offset:10240
    v_mfma_f32_16x16x32_bf16 a[32:35], v[124:127], v[48:51], a[32:35]
    v_mfma_f32_16x16x32_bf16 a[36:39], v[128:131], v[48:51], a[36:39]
    v_mfma_f32_16x16x32_bf16 a[72:75], v[132:135], v[48:51], a[72:75]
    v_mfma_f32_16x16x32_bf16 a[76:79], v[136:139], v[48:51], a[76:79]
    v_mfma_f32_16x16x32_bf16 a[112:115], v[140:143], v[48:51], a[112:115]
    v_mfma_f32_16x16x32_bf16 a[116:119], v[144:147], v[48:51], a[116:119]
    v_mfma_f32_16x16x32_bf16 a[152:155], v[148:151], v[48:51], a[152:155]
    v_mfma_f32_16x16x32_bf16 a[156:159], v[152:155], v[48:51], a[156:159]
    buffer_load_dwordx4 v[48:51], v11, s[20:23], s34 offen
    s_waitcnt lgkmcnt(0)
    s_add_u32 s32, s39, 1
    s_and_b32 s32, s32, 3
    s_add_u32 s32, s32, 12
    s_mul_i32 s35, s32, 110592
    s_add_u32 s35, s35, s38
    s_mul_i32 s34, s32, 5120
    s_add_u32 s34, s34, s37
    s_add_u32 m0, s33, 8192
    s_add_u32 s36, s35, s40
    v_mfma_f32_16x16x32_bf16 a[0:3], v[92:95], v[52:55], a[0:3]
    v_mfma_f32_16x16x32_bf16 a[4:7], v[96:99], v[52:55], a[4:7]
    buffer_load_dwordx4 v6, s[8:11], s35 offen offset:0 lds
    v_mfma_f32_16x16x32_bf16 a[40:43], v[100:103], v[52:55], a[40:43]
    v_mfma_f32_16x16x32_bf16 a[44:47], v[104:107], v[52:55], a[44:47]
    v_mfma_f32_16x16x32_bf16 a[80:83], v[108:111], v[52:55], a[80:83]
    buffer_load_dwordx4 v7, s[8:11], s35 offen offset:1024 lds
    v_mfma_f32_16x16x32_bf16 a[84:87], v[112:115], v[52:55], a[84:87]
    v_mfma_f32_16x16x32_bf16 a[120:123], v[116:119], v[52:55], a[120:123]
    v_mfma_f32_16x16x32_bf16 a[124:127], v[120:123], v[52:55], a[124:127]
    buffer_load_dwordx4 v[52:55], v10, s[20:23], s34 offen offset:0
    v_mfma_f32_16x16x32_bf16 a[8:11], v[92:95], v[56:59], a[8:11]
    v_mfma_f32_16x16x32_bf16 a[12:15], v[96:99], v[56:59], a[12:15]
    buffer_load_dwordx4 v8, s[8:11], s35 offen offset:2048 lds
    v_mfma_f32_16x16x32_bf16 a[48:51], v[100:103], v[56:59], a[48:51]
    v_mfma_f32_16x16x32_bf16 a[52:55], v[104:107], v[56:59], a[52:55]
    v_mfma_f32_16x16x32_bf16 a[88:91], v[108:111], v[56:59], a[88:91]
    buffer_load_dwordx4 v9, s[8:11], s35 offen offset:3072 lds
    v_mfma_f32_16x16x32_bf16 a[92:95], v[112:115], v[56:59], a[92:95]
    v_mfma_f32_16x16x32_bf16 a[128:131], v[116:119], v[56:59], a[128:131]
    v_mfma_f32_16x16x32_bf16 a[132:135], v[120:123], v[56:59], a[132:135]
    buffer_load_dwordx4 v[56:59], v10, s[20:23], s34 offen offset:1024
    v_mfma_f32_16x16x32_bf16 a[16:19], v[92:95], v[60:63], a[16:19]
    v_mfma_f32_16x16x32_bf16 a[20:23], v[96:99], v[60:63], a[20:23]
    s_add_u32 m0, s33, 12288
    s_nop 0
    buffer_load_dwordx4 v6, s[8:11], s36 offen offset:0 lds
    v_mfma_f32_16x16x32_bf16 a[56:59], v[100:103], v[60:63], a[56:59]
    v_mfma_f32_16x16x32_bf16 a[60:63], v[104:107], v[60:63], a[60:63]
    v_mfma_f32_16x16x32_bf16 a[96:99], v[108:111], v[60:63], a[96:99]
    buffer_load_dwordx4 v7, s[8:11], s36 offen offset:1024 lds
    v_mfma_f32_16x16x32_bf16 a[100:103], v[112:115], v[60:63], a[100:103]
    v_mfma_f32_16x16x32_bf16 a[136:139], v[116:119], v[60:63], a[136:139]
    v_mfma_f32_16x16x32_bf16 a[140:143], v[120:123], v[60:63], a[140:143]
    buffer_load_dwordx4 v[60:63], v10, s[20:23], s34 offen offset:2048
    s_waitcnt vmcnt(22)
    ds_read_b64_tr_b16 v[124:125], v12 offset:16384
    ds_read_b64_tr_b16 v[126:127], v12 offset:18432
    ds_read_b64_tr_b16 v[128:129], v13 offset:16384
    ds_read_b64_tr_b16 v[130:131], v13 offset:18432
    ds_read_b64_tr_b16 v[132:133], v14 offset:16384
    ds_read_b64_tr_b16 v[134:135], v14 offset:18432
    ds_read_b64_tr_b16 v[136:137], v15 offset:16384
    ds_read_b64_tr_b16 v[138:139], v15 offset:18432
    v_mfma_f32_16x16x32_bf16 a[24:27], v[92:95], v[64:67], a[24:27]
    v_mfma_f32_16x16x32_bf16 a[28:31], v[96:99], v[64:67], a[28:31]
    buffer_load_dwordx4 v8, s[8:11], s36 offen offset:2048 lds
    v_mfma_f32_16x16x32_bf16 a[64:67], v[100:103], v[64:67], a[64:67]
    v_mfma_f32_16x16x32_bf16 a[68:71], v[104:107], v[64:67], a[68:71]
    v_mfma_f32_16x16x32_bf16 a[104:107], v[108:111], v[64:67], a[104:107]
    buffer_load_dwordx4 v9, s[8:11], s36 offen offset:3072 lds
    v_mfma_f32_16x16x32_bf16 a[108:111], v[112:115], v[64:67], a[108:111]
    v_mfma_f32_16x16x32_bf16 a[144:147], v[116:119], v[64:67], a[144:147]
    v_mfma_f32_16x16x32_bf16 a[148:151], v[120:123], v[64:67], a[148:151]
    buffer_load_dwordx4 v[64:67], v10, s[20:23], s34 offen offset:3072
    ds_read_b64_tr_b16 v[140:141], v16 offset:16384
    ds_read_b64_tr_b16 v[142:143], v16 offset:18432
    ds_read_b64_tr_b16 v[144:145], v17 offset:16384
    ds_read_b64_tr_b16 v[146:147], v17 offset:18432
    ds_read_b64_tr_b16 v[148:149], v18 offset:16384
    ds_read_b64_tr_b16 v[150:151], v18 offset:18432
    ds_read_b64_tr_b16 v[152:153], v19 offset:16384
    ds_read_b64_tr_b16 v[154:155], v19 offset:18432
    v_mfma_f32_16x16x32_bf16 a[32:35], v[92:95], v[68:71], a[32:35]
    v_mfma_f32_16x16x32_bf16 a[36:39], v[96:99], v[68:71], a[36:39]
    v_mfma_f32_16x16x32_bf16 a[72:75], v[100:103], v[68:71], a[72:75]
    v_mfma_f32_16x16x32_bf16 a[76:79], v[104:107], v[68:71], a[76:79]
    v_mfma_f32_16x16x32_bf16 a[112:115], v[108:111], v[68:71], a[112:115]
    v_mfma_f32_16x16x32_bf16 a[116:119], v[112:115], v[68:71], a[116:119]
    v_mfma_f32_16x16x32_bf16 a[152:155], v[116:119], v[68:71], a[152:155]
    v_mfma_f32_16x16x32_bf16 a[156:159], v[120:123], v[68:71], a[156:159]
    buffer_load_dwordx4 v[68:71], v11, s[20:23], s34 offen
    s_waitcnt lgkmcnt(0)
    s_add_u32 s32, s39, 2
    s_and_b32 s32, s32, 3
    s_add_u32 s32, s32, 12
    s_mul_i32 s35, s32, 110592
    s_add_u32 s35, s35, s38
    s_mul_i32 s34, s32, 5120
    s_add_u32 s34, s34, s37
    s_add_u32 m0, s33, 16384
    s_add_u32 s36, s35, s40
    v_mfma_f32_16x16x32_bf16 a[0:3], v[124:127], v[72:75], a[0:3]
    v_mfma_f32_16x16x32_bf16 a[4:7], v[128:131], v[72:75], a[4:7]
    buffer_load_dwordx4 v6, s[8:11], s35 offen offset:0 lds
    v_mfma_f32_16x16x32_bf16 a[40:43], v[132:135], v[72:75], a[40:43]
    v_mfma_f32_16x16x32_bf16 a[44:47], v[136:139], v[72:75], a[44:47]
    v_mfma_f32_16x16x32_bf16 a[80:83], v[140:143], v[72:75], a[80:83]
    buffer_load_dwordx4 v7, s[8:11], s35 offen offset:1024 lds
    v_mfma_f32_16x16x32_bf16 a[84:87], v[144:147], v[72:75], a[84:87]
    v_mfma_f32_16x16x32_bf16 a[120:123], v[148:151], v[72:75], a[120:123]
    v_mfma_f32_16x16x32_bf16 a[124:127], v[152:155], v[72:75], a[124:127]
    buffer_load_dwordx4 v[72:75], v10, s[20:23], s34 offen offset:0
    v_mfma_f32_16x16x32_bf16 a[8:11], v[124:127], v[76:79], a[8:11]
    v_mfma_f32_16x16x32_bf16 a[12:15], v[128:131], v[76:79], a[12:15]
    buffer_load_dwordx4 v8, s[8:11], s35 offen offset:2048 lds
    v_mfma_f32_16x16x32_bf16 a[48:51], v[132:135], v[76:79], a[48:51]
    v_mfma_f32_16x16x32_bf16 a[52:55], v[136:139], v[76:79], a[52:55]
    v_mfma_f32_16x16x32_bf16 a[88:91], v[140:143], v[76:79], a[88:91]
    buffer_load_dwordx4 v9, s[8:11], s35 offen offset:3072 lds
    v_mfma_f32_16x16x32_bf16 a[92:95], v[144:147], v[76:79], a[92:95]
    v_mfma_f32_16x16x32_bf16 a[128:131], v[148:151], v[76:79], a[128:131]
    v_mfma_f32_16x16x32_bf16 a[132:135], v[152:155], v[76:79], a[132:135]
    buffer_load_dwordx4 v[76:79], v10, s[20:23], s34 offen offset:1024
    v_mfma_f32_16x16x32_bf16 a[16:19], v[124:127], v[80:83], a[16:19]
    v_mfma_f32_16x16x32_bf16 a[20:23], v[128:131], v[80:83], a[20:23]
    s_add_u32 m0, s33, 20480
    s_nop 0
    buffer_load_dwordx4 v6, s[8:11], s36 offen offset:0 lds
    v_mfma_f32_16x16x32_bf16 a[56:59], v[132:135], v[80:83], a[56:59]
    v_mfma_f32_16x16x32_bf16 a[60:63], v[136:139], v[80:83], a[60:63]
    v_mfma_f32_16x16x32_bf16 a[96:99], v[140:143], v[80:83], a[96:99]
    buffer_load_dwordx4 v7, s[8:11], s36 offen offset:1024 lds
    v_mfma_f32_16x16x32_bf16 a[100:103], v[144:147], v[80:83], a[100:103]
    v_mfma_f32_16x16x32_bf16 a[136:139], v[148:151], v[80:83], a[136:139]
    v_mfma_f32_16x16x32_bf16 a[140:143], v[152:155], v[80:83], a[140:143]
    buffer_load_dwordx4 v[80:83], v10, s[20:23], s34 offen offset:2048
    s_waitcnt vmcnt(22)
    ds_read_b64_tr_b16 v[92:93], v12 offset:0
    ds_read_b64_tr_b16 v[94:95], v12 offset:2048
    ds_read_b64_tr_b16 v[96:97], v13 offset:0
    ds_read_b64_tr_b16 v[98:99], v13 offset:2048
    ds_read_b64_tr_b16 v[100:101], v14 offset:0
    ds_read_b64_tr_b16 v[102:103], v14 offset:2048
    ds_read_b64_tr_b16 v[104:105], v15 offset:0
    ds_read_b64_tr_b16 v[106:107], v15 offset:2048
    v_mfma_f32_16x16x32_bf16 a[24:27], v[124:127], v[84:87], a[24:27]
    v_mfma_f32_16x16x32_bf16 a[28:31], v[128:131], v[84:87], a[28:31]
    buffer_load_dwordx4 v8, s[8:11], s36 offen offset:2048 lds
    v_mfma_f32_16x16x32_bf16 a[64:67], v[132:135], v[84:87], a[64:67]
    v_mfma_f32_16x16x32_bf16 a[68:71], v[136:139], v[84:87], a[68:71]
    v_mfma_f32_16x16x32_bf16 a[104:107], v[140:143], v[84:87], a[104:107]
    buffer_load_dwordx4 v9, s[8:11], s36 offen offset:3072 lds
    v_mfma_f32_16x16x32_bf16 a[108:111], v[144:147], v[84:87], a[108:111]
    v_mfma_f32_16x16x32_bf16 a[144:147], v[148:151], v[84:87], a[144:147]
    v_mfma_f32_16x16x32_bf16 a[148:151], v[152:155], v[84:87], a[148:151]
    buffer_load_dwordx4 v[84:87], v10, s[20:23], s34 offen offset:3072
    ds_read_b64_tr_b16 v[108:109], v16 offset:0
    ds_read_b64_tr_b16 v[110:111], v16 offset:2048
    ds_read_b64_tr_b16 v[112:113], v17 offset:0
    ds_read_b64_tr_b16 v[114:115], v17 offset:2048
    ds_read_b64_tr_b16 v[116:117], v18 offset:0
    ds_read_b64_tr_b16 v[118:119], v18 offset:2048
    ds_read_b64_tr_b16 v[120:121], v19 offset:0
    ds_read_b64_tr_b16 v[122:123], v19 offset:2048
    v_mfma_f32_16x16x32_bf16 a[32:35], v[124:127], v[88:91], a[32:35]
    v_mfma_f32_16x16x32_bf16 a[36:39], v[128:131], v[88:91], a[36:39]
    v_mfma_f32_16x16x32_bf16 a[72:75], v[132:135], v[88:91], a[72:75]
    v_mfma_f32_16x16x32_bf16 a[76:79], v[136:139], v[88:91], a[76:79]
    v_mfma_f32_16x16x32_bf16 a[112:115], v[140:143], v[88:91], a[112:115]
    v_mfma_f32_16x16x32_bf16 a[116:119], v[144:147], v[88:91], a[116:119]
    v_mfma_f32_16x16x32_bf16 a[152:155], v[148:151], v[88:91], a[152:155]
    v_mfma_f32_16x16x32_bf16 a[156:159], v[152:155], v[88:91], a[156:159]
    buffer_load_dwordx4 v[88:91], v11, s[20:23], s34 offen
    s_waitcnt lgkmcnt(0)
    s_add_u32 s32, s39, 3
    s_and_b32 s32, s32, 3
    s_add_u32 s32, s32, 12
    s_mul_i32 s35, s32, 110592
    s_add_u32 s35, s35, s38
    s_mul_i32 s34, s32, 5120
    s_add_u32 s34, s34, s37
    s_add_u32 m0, s33, 0
    s_add_u32 s36, s35, s40
    v_mfma_f32_16x16x32_bf16 a[0:3], v[92:95], v[32:35], a[0:3]
    v_mfma_f32_16x16x32_bf16 a[4:7], v[96:99], v[32:35], a[4:7]
    buffer_load_dwordx4 v6, s[8:11], s35 offen offset:0 lds
    v_mfma_f32_16x16x32_bf16 a[40:43], v[100:103], v[32:35], a[40:43]
    v_mfma_f32_16x16x32_bf16 a[44:47], v[104:107], v[32:35], a[44:47]
    v_mfma_f32_16x16x32_bf16 a[80:83], v[108:111], v[32:35], a[80:83]
    buffer_load_dwordx4 v7, s[8:11], s35 offen offset:1024 lds
    v_mfma_f32_16x16x32_bf16 a[84:87], v[112:115], v[32:35], a[84:87]
    v_mfma_f32_16x16x32_bf16 a[120:123], v[116:119], v[32:35], a[120:123]
    v_mfma_f32_16x16x32_bf16 a[124:127], v[120:123], v[32:35], a[124:127]
    buffer_load_dwordx4 v[32:35], v10, s[20:23], s34 offen offset:0
    v_mfma_f32_16x16x32_bf16 a[8:11], v[92:95], v[36:39], a[8:11]
    v_mfma_f32_16x16x32_bf16 a[12:15], v[96:99], v[36:39], a[12:15]
    buffer_load_dwordx4 v8, s[8:11], s35 offen offset:2048 lds
    v_mfma_f32_16x16x32_bf16 a[48:51], v[100:103], v[36:39], a[48:51]
    v_mfma_f32_16x16x32_bf16 a[52:55], v[104:107], v[36:39], a[52:55]
    v_mfma_f32_16x16x32_bf16 a[88:91], v[108:111], v[36:39], a[88:91]
    buffer_load_dwordx4 v9, s[8:11], s35 offen offset:3072 lds
    v_mfma_f32_16x16x32_bf16 a[92:95], v[112:115], v[36:39], a[92:95]
    v_mfma_f32_16x16x32_bf16 a[128:131], v[116:119], v[36:39], a[128:131]
    v_mfma_f32_16x16x32_bf16 a[132:135], v[120:123], v[36:39], a[132:135]
    buffer_load_dwordx4 v[36:39], v10, s[20:23], s34 offen offset:1024
    v_mfma_f32_16x16x32_bf16 a[16:19], v[92:95], v[40:43], a[16:19]
    v_mfma_f32_16x16x32_bf16 a[20:23], v[96:99], v[40:43], a[20:23]
    s_add_u32 m0, s33, 4096
    s_nop 0
    buffer_load_dwordx4 v6, s[8:11], s36 offen offset:0 lds
    v_mfma_f32_16x16x32_bf16 a[56:59], v[100:103], v[40:43], a[56:59]
    v_mfma_f32_16x16x32_bf16 a[60:63], v[104:107], v[40:43], a[60:63]
    v_mfma_f32_16x16x32_bf16 a[96:99], v[108:111], v[40:43], a[96:99]
    buffer_load_dwordx4 v7, s[8:11], s36 offen offset:1024 lds
    v_mfma_f32_16x16x32_bf16 a[100:103], v[112:115], v[40:43], a[100:103]
    v_mfma_f32_16x16x32_bf16 a[136:139], v[116:119], v[40:43], a[136:139]
    v_mfma_f32_16x16x32_bf16 a[140:143], v[120:123], v[40:43], a[140:143]
    buffer_load_dwordx4 v[40:43], v10, s[20:23], s34 offen offset:2048
    s_waitcnt vmcnt(22)
    ds_read_b64_tr_b16 v[124:125], v12 offset:8192
    ds_read_b64_tr_b16 v[126:127], v12 offset:10240
    ds_read_b64_tr_b16 v[128:129], v13 offset:8192
    ds_read_b64_tr_b16 v[130:131], v13 offset:10240
    ds_read_b64_tr_b16 v[132:133], v14 offset:8192
    ds_read_b64_tr_b16 v[134:135], v14 offset:10240
    ds_read_b64_tr_b16 v[136:137], v15 offset:8192
    ds_read_b64_tr_b16 v[138:139], v15 offset:10240
    v_mfma_f32_16x16x32_bf16 a[24:27], v[92:95], v[44:47], a[24:27]
    v_mfma_f32_16x16x32_bf16 a[28:31], v[96:99], v[44:47], a[28:31]
    buffer_load_dwordx4 v8, s[8:11], s36 offen offset:2048 lds
    v_mfma_f32_16x16x32_bf16 a[64:67], v[100:103], v[44:47], a[64:67]
    v_mfma_f32_16x16x32_bf16 a[68:71], v[104:107], v[44:47], a[68:71]
    v_mfma_f32_16x16x32_bf16 a[104:107], v[108:111], v[44:47], a[104:107]
    buffer_load_dwordx4 v9, s[8:11], s36 offen offset:3072 lds
    v_mfma_f32_16x16x32_bf16 a[108:111], v[112:115], v[44:47], a[108:111]
    v_mfma_f32_16x16x32_bf16 a[144:147], v[116:119], v[44:47], a[144:147]
    v_mfma_f32_16x16x32_bf16 a[148:151], v[120:123], v[44:47], a[148:151]
    buffer_load_dwordx4 v[44:47], v10, s[20:23], s34 offen offset:3072
    ds_read_b64_tr_b16 v[140:141], v16 offset:8192
    ds_read_b64_tr_b16 v[142:143], v16 offset:10240
    ds_read_b64_tr_b16 v[144:145], v17 offset:8192
    ds_read_b64_tr_b16 v[146:147], v17 offset:10240
    ds_read_b64_tr_b16 v[148:149], v18 offset:8192
    ds_read_b64_tr_b16 v[150:151], v18 offset:10240
    ds_read_b64_tr_b16 v[152:153], v19 offset:8192
    ds_read_b64_tr_b16 v[154:155], v19 offset:10240
    v_mfma_f32_16x16x32_bf16 a[32:35], v[92:95], v[48:51], a[32:35]
    v_mfma_f32_16x16x32_bf16 a[36:39], v[96:99], v[48:51], a[36:39]
    v_mfma_f32_16x16x32_bf16 a[72:75], v[100:103], v[48:51], a[72:75]
    v_mfma_f32_16x16x32_bf16 a[76:79], v[104:107], v[48:51], a[76:79]
    v_mfma_f32_16x16x32_bf16 a[112:115], v[108:111], v[48:51], a[112:115]
    v_mfma_f32_16x16x32_bf16 a[116:119], v[112:115], v[48:51], a[116:119]
    v_mfma_f32_16x16x32_bf16 a[152:155], v[116:119], v[48:51], a[152:155]
    v_mfma_f32_16x16x32_bf16 a[156:159], v[120:123], v[48:51], a[156:159]
    buffer_load_dwordx4 v[48:51], v11, s[20:23], s34 offen
    s_waitcnt lgkmcnt(0)
    v_mfma_f32_16x16x32_bf16 a[0:3], v[124:127], v[52:55], a[0:3]
    v_mfma_f32_16x16x32_bf16 a[4:7], v[128:131], v[52:55], a[4:7]
    v_mfma_f32_16x16x32_bf16 a[40:43], v[132:135], v[52:55], a[40:43]
    v_mfma_f32_16x16x32_bf16 a[44:47], v[136:139], v[52:55], a[44:47]
    v_mfma_f32_16x16x32_bf16 a[80:83], v[140:143], v[52:55], a[80:83]
    v_mfma_f32_16x16x32_bf16 a[84:87], v[144:147], v[52:55], a[84:87]
    v_mfma_f32_16x16x32_bf16 a[120:123], v[148:151], v[52:55], a[120:123]
    v_mfma_f32_16x16x32_bf16 a[124:127], v[152:155], v[52:55], a[124:127]
    v_mfma_f32_16x16x32_bf16 a[8:11], v[124:127], v[56:59], a[8:11]
    v_mfma_f32_16x16x32_bf16 a[12:15], v[128:131], v[56:59], a[12:15]
    v_mfma_f32_16x16x32_bf16 a[48:51], v[132:135], v[56:59], a[48:51]
    v_mfma_f32_16x16x32_bf16 a[52:55], v[136:139], v[56:59], a[52:55]
    v_mfma_f32_16x16x32_bf16 a[88:91], v[140:143], v[56:59], a[88:91]
    v_mfma_f32_16x16x32_bf16 a[92:95], v[144:147], v[56:59], a[92:95]
    v_mfma_f32_16x16x32_bf16 a[128:131], v[148:151], v[56:59], a[128:131]
    v_mfma_f32_16x16x32_bf16 a[132:135], v[152:155], v[56:59], a[132:135]
    v_mfma_f32_16x16x32_bf16 a[16:19], v[124:127], v[60:63], a[16:19]
    v_mfma_f32_16x16x32_bf16 a[20:23], v[128:131], v[60:63], a[20:23]
    v_mfma_f32_16x16x32_bf16 a[56:59], v[132:135], v[60:63], a[56:59]
    v_mfma_f32_16x16x32_bf16 a[60:63], v[136:139], v[60:63], a[60:63]
    v_mfma_f32_16x16x32_bf16 a[96:99], v[140:143], v[60:63], a[96:99]
    v_mfma_f32_16x16x32_bf16 a[100:103], v[144:147], v[60:63], a[100:103]
    v_mfma_f32_16x16x32_bf16 a[136:139], v[148:151], v[60:63], a[136:139]
    v_mfma_f32_16x16x32_bf16 a[140:143], v[152:155], v[60:63], a[140:143]
    s_waitcnt vmcnt(13)
    ds_read_b64_tr_b16 v[92:93], v12 offset:16384
    ds_read_b64_tr_b16 v[94:95], v12 offset:18432
    ds_read_b64_tr_b16 v[96:97], v13 offset:16384
    ds_read_b64_tr_b16 v[98:99], v13 offset:18432
    ds_read_b64_tr_b16 v[100:101], v14 offset:16384
    ds_read_b64_tr_b16 v[102:103], v14 offset:18432
    ds_read_b64_tr_b16 v[104:105], v15 offset:16384
    ds_read_b64_tr_b16 v[106:107], v15 offset:18432
    v_mfma_f32_16x16x32_bf16 a[24:27], v[124:127], v[64:67], a[24:27]
    v_mfma_f32_16x16x32_bf16 a[28:31], v[128:131], v[64:67], a[28:31]
    v_mfma_f32_16x16x32_bf16 a[64:67], v[132:135], v[64:67], a[64:67]
    v_mfma_f32_16x16x32_bf16 a[68:71], v[136:139], v[64:67], a[68:71]
    v_mfma_f32_16x16x32_bf16 a[104:107], v[140:143], v[64:67], a[104:107]
    v_mfma_f32_16x16x32_bf16 a[108:111], v[144:147], v[64:67], a[108:111]
    v_mfma_f32_16x16x32_bf16 a[144:147], v[148:151], v[64:67], a[144:147]
    v_mfma_f32_16x16x32_bf16 a[148:151], v[152:155], v[64:67], a[148:151]
    ds_read_b64_tr_b16 v[108:109], v16 offset:16384
    ds_read_b64_tr_b16 v[110:111], v16 offset:18432
    ds_read_b64_tr_b16 v[112:113], v17 offset:16384
    ds_read_b64_tr_b16 v[114:115], v17 offset:18432
    ds_read_b64_tr_b16 v[116:117], v18 offset:16384
    ds_read_b64_tr_b16 v[118:119], v18 offset:18432
    ds_read_b64_tr_b16 v[120:121], v19 offset:16384
    ds_read_b64_tr_b16 v[122:123], v19 offset:18432
    v_mfma_f32_16x16x32_bf16 a[32:35], v[124:127], v[68:71], a[32:35]
    v_mfma_f32_16x16x32_bf16 a[36:39], v[128:131], v[68:71], a[36:39]
    v_mfma_f32_16x16x32_bf16 a[72:75], v[132:135], v[68:71], a[72:75]
    v_mfma_f32_16x16x32_bf16 a[76:79], v[136:139], v[68:71], a[76:79]
    v_mfma_f32_16x16x32_bf16 a[112:115], v[140:143], v[68:71], a[112:115]
    v_mfma_f32_16x16x32_bf16 a[116:119], v[144:147], v[68:71], a[116:119]
    v_mfma_f32_16x16x32_bf16 a[152:155], v[148:151], v[68:71], a[152:155]
    v_mfma_f32_16x16x32_bf16 a[156:159], v[152:155], v[68:71], a[156:159]
    s_waitcnt lgkmcnt(0)
    v_lshrrev_b32 v26, 5, v1
    v_lshlrev_b32 v26, 12, v26
    v_and_b32 v27, 31, v1
    v_lshl_add_u32 v26, v27, 4, v26
    s_lshl_b32 s29, s26, 2
    s_add_u32 s29, s29, s24
    s_mul_i32 s29, s29, 6
    s_add_u32 s29, s29, 1056
    s_lshl_b32 s29, s29, 12
    s_lshl_b32 s30, s25, 9
    s_add_u32 s29, s29, s30
    buffer_load_dwordx4 a[160:163], v26, s[12:15], s29 offen
    s_add_u32 s29, s29, 8192
    buffer_load_dwordx4 a[160:163], v26, s[12:15], s29 offen
    s_add_u32 s29, s29, 8192
    buffer_load_dwordx4 a[160:163], v26, s[12:15], s29 offen
    s_add_u32 s29, s29, 8192
    v_mfma_f32_16x16x32_bf16 a[0:3], v[92:95], v[72:75], a[0:3]
    v_mfma_f32_16x16x32_bf16 a[4:7], v[96:99], v[72:75], a[4:7]
    v_mfma_f32_16x16x32_bf16 a[40:43], v[100:103], v[72:75], a[40:43]
    v_mfma_f32_16x16x32_bf16 a[44:47], v[104:107], v[72:75], a[44:47]
    v_mfma_f32_16x16x32_bf16 a[80:83], v[108:111], v[72:75], a[80:83]
    v_mfma_f32_16x16x32_bf16 a[84:87], v[112:115], v[72:75], a[84:87]
    v_mfma_f32_16x16x32_bf16 a[120:123], v[116:119], v[72:75], a[120:123]
    v_mfma_f32_16x16x32_bf16 a[124:127], v[120:123], v[72:75], a[124:127]
    v_mfma_f32_16x16x32_bf16 a[8:11], v[92:95], v[76:79], a[8:11]
    v_mfma_f32_16x16x32_bf16 a[12:15], v[96:99], v[76:79], a[12:15]
    v_mfma_f32_16x16x32_bf16 a[48:51], v[100:103], v[76:79], a[48:51]
    v_mfma_f32_16x16x32_bf16 a[52:55], v[104:107], v[76:79], a[52:55]
    v_mfma_f32_16x16x32_bf16 a[88:91], v[108:111], v[76:79], a[88:91]
    v_mfma_f32_16x16x32_bf16 a[92:95], v[112:115], v[76:79], a[92:95]
    v_mfma_f32_16x16x32_bf16 a[128:131], v[116:119], v[76:79], a[128:131]
    v_mfma_f32_16x16x32_bf16 a[132:135], v[120:123], v[76:79], a[132:135]
    v_mfma_f32_16x16x32_bf16 a[16:19], v[92:95], v[80:83], a[16:19]
    v_mfma_f32_16x16x32_bf16 a[20:23], v[96:99], v[80:83], a[20:23]
    v_mfma_f32_16x16x32_bf16 a[56:59], v[100:103], v[80:83], a[56:59]
    v_mfma_f32_16x16x32_bf16 a[60:63], v[104:107], v[80:83], a[60:63]
    v_mfma_f32_16x16x32_bf16 a[96:99], v[108:111], v[80:83], a[96:99]
    v_mfma_f32_16x16x32_bf16 a[100:103], v[112:115], v[80:83], a[100:103]
    v_mfma_f32_16x16x32_bf16 a[136:139], v[116:119], v[80:83], a[136:139]
    v_mfma_f32_16x16x32_bf16 a[140:143], v[120:123], v[80:83], a[140:143]
    s_waitcnt vmcnt(3)
    ds_read_b64_tr_b16 v[124:125], v12 offset:0
    ds_read_b64_tr_b16 v[126:127], v12 offset:2048
    ds_read_b64_tr_b16 v[128:129], v13 offset:0
    ds_read_b64_tr_b16 v[130:131], v13 offset:2048
    ds_read_b64_tr_b16 v[132:133], v14 offset:0
    ds_read_b64_tr_b16 v[134:135], v14 offset:2048
    ds_read_b64_tr_b16 v[136:137], v15 offset:0
    ds_read_b64_tr_b16 v[138:139], v15 offset:2048
    v_mfma_f32_16x16x32_bf16 a[24:27], v[92:95], v[84:87], a[24:27]
    v_mfma_f32_16x16x32_bf16 a[28:31], v[96:99], v[84:87], a[28:31]
    v_mfma_f32_16x16x32_bf16 a[64:67], v[100:103], v[84:87], a[64:67]
    v_mfma_f32_16x16x32_bf16 a[68:71], v[104:107], v[84:87], a[68:71]
    v_mfma_f32_16x16x32_bf16 a[104:107], v[108:111], v[84:87], a[104:107]
    v_mfma_f32_16x16x32_bf16 a[108:111], v[112:115], v[84:87], a[108:111]
    v_mfma_f32_16x16x32_bf16 a[144:147], v[116:119], v[84:87], a[144:147]
    v_mfma_f32_16x16x32_bf16 a[148:151], v[120:123], v[84:87], a[148:151]
    ds_read_b64_tr_b16 v[140:141], v16 offset:0
    ds_read_b64_tr_b16 v[142:143], v16 offset:2048
    ds_read_b64_tr_b16 v[144:145], v17 offset:0
    ds_read_b64_tr_b16 v[146:147], v17 offset:2048
    ds_read_b64_tr_b16 v[148:149], v18 offset:0
    ds_read_b64_tr_b16 v[150:151], v18 offset:2048
    ds_read_b64_tr_b16 v[152:153], v19 offset:0
    ds_read_b64_tr_b16 v[154:155], v19 offset:2048
    v_mfma_f32_16x16x32_bf16 a[32:35], v[92:95], v[88:91], a[32:35]
    v_mfma_f32_16x16x32_bf16 a[36:39], v[96:99], v[88:91], a[36:39]
    v_mfma_f32_16x16x32_bf16 a[72:75], v[100:103], v[88:91], a[72:75]
    v_mfma_f32_16x16x32_bf16 a[76:79], v[104:107], v[88:91], a[76:79]
    v_mfma_f32_16x16x32_bf16 a[112:115], v[108:111], v[88:91], a[112:115]
    v_mfma_f32_16x16x32_bf16 a[116:119], v[112:115], v[88:91], a[116:119]
    v_mfma_f32_16x16x32_bf16 a[152:155], v[116:119], v[88:91], a[152:155]
    v_mfma_f32_16x16x32_bf16 a[156:159], v[120:123], v[88:91], a[156:159]
    s_waitcnt lgkmcnt(0)
    v_add_u32 v4, s33, v10
    v_mfma_f32_16x16x32_bf16 a[40:43], v[132:135], v[32:35], a[40:43]
    v_mfma_f32_16x16x32_bf16 a[48:51], v[132:135], v[36:39], a[48:51]
    v_mfma_f32_16x16x32_bf16 a[56:59], v[132:135], v[40:43], a[56:59]
    v_mfma_f32_16x16x32_bf16 a[64:67], v[132:135], v[44:47], a[64:67]
    v_mfma_f32_16x16x32_bf16 a[72:75], v[132:135], v[48:51], a[72:75]
    v_mfma_f32_16x16x32_bf16 a[44:47], v[136:139], v[32:35], a[44:47]
    v_mfma_f32_16x16x32_bf16 a[52:55], v[136:139], v[36:39], a[52:55]
    s_nop 1
    ds_write_b128 v4, a[40:43] offset:0
    v_mfma_f32_16x16x32_bf16 a[60:63], v[136:139], v[40:43], a[60:63]
    ds_write_b128 v4, a[48:51] offset:2048
    v_mfma_f32_16x16x32_bf16 a[68:71], v[136:139], v[44:47], a[68:71]
    ds_write_b128 v4, a[56:59] offset:4096
    v_mfma_f32_16x16x32_bf16 a[76:79], v[136:139], v[48:51], a[76:79]
    ds_write_b128 v4, a[64:67] offset:6144
    v_mfma_f32_16x16x32_bf16 a[80:83], v[140:143], v[32:35], a[80:83]
    ds_write_b128 v4, a[72:75] offset:8192
    v_mfma_f32_16x16x32_bf16 a[88:91], v[140:143], v[36:39], a[88:91]
    ds_write_b128 v4, a[44:47] offset:1024
    v_mfma_f32_16x16x32_bf16 a[96:99], v[140:143], v[40:43], a[96:99]
    ds_write_b128 v4, a[52:55] offset:3072
    v_mfma_f32_16x16x32_bf16 a[104:107], v[140:143], v[44:47], a[104:107]
    ds_write_b128 v4, a[60:63] offset:5120
    v_mfma_f32_16x16x32_bf16 a[112:115], v[140:143], v[48:51], a[112:115]
    ds_write_b128 v4, a[68:71] offset:7168
    v_mfma_f32_16x16x32_bf16 a[84:87], v[144:147], v[32:35], a[84:87]
    ds_write_b128 v4, a[76:79] offset:9216
    v_mfma_f32_16x16x32_bf16 a[92:95], v[144:147], v[36:39], a[92:95]
    ds_write_b128 v4, a[80:83] offset:10240
    v_mfma_f32_16x16x32_bf16 a[100:103], v[144:147], v[40:43], a[100:103]
    ds_write_b128 v4, a[88:91] offset:12288
    v_mfma_f32_16x16x32_bf16 a[108:111], v[144:147], v[44:47], a[108:111]
    ds_write_b128 v4, a[96:99] offset:14336
    v_mfma_f32_16x16x32_bf16 a[116:119], v[144:147], v[48:51], a[116:119]
    ds_write_b128 v4, a[104:107] offset:16384
    v_mfma_f32_16x16x32_bf16 a[120:123], v[148:151], v[32:35], a[120:123]
    ds_write_b128 v4, a[112:115] offset:18432
    v_mfma_f32_16x16x32_bf16 a[128:131], v[148:151], v[36:39], a[128:131]
    ds_write_b128 v4, a[84:87] offset:11264
    v_mfma_f32_16x16x32_bf16 a[136:139], v[148:151], v[40:43], a[136:139]
    ds_write_b128 v4, a[92:95] offset:13312
    v_mfma_f32_16x16x32_bf16 a[144:147], v[148:151], v[44:47], a[144:147]
    ds_write_b128 v4, a[100:103] offset:15360
    v_mfma_f32_16x16x32_bf16 a[152:155], v[148:151], v[48:51], a[152:155]
    ds_write_b128 v4, a[108:111] offset:17408
    v_mfma_f32_16x16x32_bf16 a[124:127], v[152:155], v[32:35], a[124:127]
    ds_write_b128 v4, a[116:119] offset:19456
    v_mfma_f32_16x16x32_bf16 a[132:135], v[152:155], v[36:39], a[132:135]
    ds_write_b128 v4, a[120:123] offset:20480
    v_mfma_f32_16x16x32_bf16 a[140:143], v[152:155], v[40:43], a[140:143]
    ds_write_b128 v4, a[128:131] offset:22528
    v_mfma_f32_16x16x32_bf16 a[148:151], v[152:155], v[44:47], a[148:151]
    ds_write_b128 v4, a[136:139] offset:24576
    v_mfma_f32_16x16x32_bf16 a[156:159], v[152:155], v[48:51], a[156:159]
    ds_write_b128 v4, a[144:147] offset:26624
    v_mfma_f32_16x16x32_bf16 a[0:3], v[124:127], v[32:35], a[0:3]
    ds_write_b128 v4, a[152:155] offset:28672
    v_mfma_f32_16x16x32_bf16 a[8:11], v[124:127], v[36:39], a[8:11]
    ds_write_b128 v4, a[124:127] offset:21504
    v_mfma_f32_16x16x32_bf16 a[16:19], v[124:127], v[40:43], a[16:19]
    ds_write_b128 v4, a[132:135] offset:23552
    v_mfma_f32_16x16x32_bf16 a[24:27], v[124:127], v[44:47], a[24:27]
    ds_write_b128 v4, a[140:143] offset:25600
    v_mfma_f32_16x16x32_bf16 a[32:35], v[124:127], v[48:51], a[32:35]
    ds_write_b128 v4, a[148:151] offset:27648
    v_mfma_f32_16x16x32_bf16 a[4:7], v[128:131], v[32:35], a[4:7]
    ds_write_b128 v4, a[156:159] offset:29696
    v_mfma_f32_16x16x32_bf16 a[12:15], v[128:131], v[36:39], a[12:15]
    v_mfma_f32_16x16x32_bf16 a[20:23], v[128:131], v[40:43], a[20:23]
    v_mfma_f32_16x16x32_bf16 a[28:31], v[128:131], v[44:47], a[28:31]
    v_mfma_f32_16x16x32_bf16 a[36:39], v[128:131], v[48:51], a[36:39]
K1_uepi:
    s_sub_u32 s29, s24, 1
    s_and_b32 s29, s29, 3
    s_mul_i32 s29, s29, 30720
    s_add_u32 s29, s29, 0
    v_add_u32 v13, s29, v10
    s_sub_u32 s29, s24, 2
    s_and_b32 s29, s29, 3
    s_mul_i32 s29, s29, 30720
    s_add_u32 s29, s29, 10240
    v_add_u32 v14, s29, v10
    s_sub_u32 s29, s24, 3
    s_and_b32 s29, s29, 3
    s_mul_i32 s29, s29, 30720
    s_add_u32 s29, s29, 20480
    v_add_u32 v15, s29, v10
    v_accvgpr_read_b32 v32, a0
    v_accvgpr_read_b32 v33, a1
    v_accvgpr_read_b32 v34, a2
    v_accvgpr_read_b32 v35, a3
    v_accvgpr_read_b32 v36, a4
    v_accvgpr_read_b32 v37, a5
    v_accvgpr_read_b32 v38, a6
    v_accvgpr_read_b32 v39, a7
    v_accvgpr_read_b32 v40, a8
    v_accvgpr_read_b32 v41, a9
    v_accvgpr_read_b32 v42, a10
    v_accvgpr_read_b32 v43, a11
    v_accvgpr_read_b32 v44, a12
    v_accvgpr_read_b32 v45, a13
    v_accvgpr_read_b32 v46, a14
    v_accvgpr_read_b32 v47, a15
    v_accvgpr_read_b32 v48, a16
    v_accvgpr_read_b32 v49, a17
    v_accvgpr_read_b32 v50, a18
    v_accvgpr_read_b32 v51, a19
    v_accvgpr_read_b32 v52, a20
    v_accvgpr_read_b32 v53, a21
    v_accvgpr_read_b32 v54, a22
    v_accvgpr_read_b32 v55, a23
    v_accvgpr_read_b32 v56, a24
    v_accvgpr_read_b32 v57, a25
    v_accvgpr_read_b32 v58, a26
    v_accvgpr_read_b32 v59, a27
    v_accvgpr_read_b32 v60, a28
    v_accvgpr_read_b32 v61, a29
    v_accvgpr_read_b32 v62, a30
    v_accvgpr_read_b32 v63, a31
    v_accvgpr_read_b32 v64, a32
    v_accvgpr_read_b32 v65, a33
    v_accvgpr_read_b32 v66, a34
    v_accvgpr_read_b32 v67, a35
    v_accvgpr_read_b32 v68, a36
    v_accvgpr_read_b32 v69, a37
    v_accvgpr_read_b32 v70, a38
    v_accvgpr_read_b32 v71, a39
    v_lshlrev_b32 v192, 16, v22
    v_and_b32 v193, 0xffff0000, v22
    v_lshlrev_b32 v194, 16, v23
    v_and_b32 v195, 0xffff0000, v23
    v_lshlrev_b32 v196, 16, v24
    v_and_b32 v197, 0xffff0000, v24
    v_lshlrev_b32 v198, 16, v25
    v_and_b32 v199, 0xffff0000, v25
    v_pk_add_f32 v[32:33], v[32:33], v[192:193]
    v_pk_add_f32 v[34:35], v[34:35], v[194:195]
    v_pk_add_f32 v[36:37], v[36:37], v[196:197]
    v_pk_add_f32 v[38:39], v[38:39], v[198:199]
    v_pk_add_f32 v[40:41], v[40:41], v[192:193]
    v_pk_add_f32 v[42:43], v[42:43], v[194:195]
    v_pk_add_f32 v[44:45], v[44:45], v[196:197]
    v_pk_add_f32 v[46:47], v[46:47], v[198:199]
    v_pk_add_f32 v[48:49], v[48:49], v[192:193]
    v_pk_add_f32 v[50:51], v[50:51], v[194:195]
    v_pk_add_f32 v[52:53], v[52:53], v[196:197]
    v_pk_add_f32 v[54:55], v[54:55], v[198:199]
    v_pk_add_f32 v[56:57], v[56:57], v[192:193]
    v_pk_add_f32 v[58:59], v[58:59], v[194:195]
    v_pk_add_f32 v[60:61], v[60:61], v[196:197]
    v_pk_add_f32 v[62:63], v[62:63], v[198:199]
    v_pk_add_f32 v[64:65], v[64:65], v[192:193]
    v_pk_add_f32 v[66:67], v[66:67], v[194:195]
    v_pk_add_f32 v[68:69], v[68:69], v[196:197]
    v_pk_add_f32 v[70:71], v[70:71], v[198:199]
    s_lshl_b32 s30, s27, 2
    s_add_u32 s30, s30, s24
    s_mul_i32 s29, s28, 54
    s_add_u32 s29, s29, s30
    s_mul_i32 s29, s29, 5120
    s_add_u32 s29, s29, 11309056
    v_mov_b32 v200, 0xc0135761
    v_mov_b32 v201, 0xbdd2d3e8
    v_mov_b32 v202, 1.0
    s_waitcnt lgkmcnt(0)
    s_cbranch_execz K1_uepi_nb
    s_barrier
K1_uepi_nb:
    s_cmp_ge_u32 s30, 54
    s_cbranch_scc1 K1_udone
    ds_read_b128 v[72:75], v13 offset:0
    ds_read_b128 v[76:79], v13 offset:1024
    ds_read_b128 v[112:115], v14 offset:0
    ds_read_b128 v[116:119], v14 offset:1024
    ds_read_b128 v[152:155], v15 offset:0
    ds_read_b128 v[156:159], v15 offset:1024
    ds_read_b128 v[80:83], v13 offset:2048
    ds_read_b128 v[84:87], v13 offset:3072
    ds_read_b128 v[120:123], v14 offset:2048
    ds_read_b128 v[124:127], v14 offset:3072
    ds_read_b128 v[160:163], v15 offset:2048
    ds_read_b128 v[164:167], v15 offset:3072
    ds_read_b128 v[88:91], v13 offset:4096
    ds_read_b128 v[92:95], v13 offset:5120
    ds_read_b128 v[128:131], v14 offset:4096
    ds_read_b128 v[132:135], v14 offset:5120
    ds_read_b128 v[168:171], v15 offset:4096
    ds_read_b128 v[172:175], v15 offset:5120
    s_waitcnt lgkmcnt(12)
    v_pk_add_f32 v[72:73], v[72:73], v[112:113]
    v_pk_add_f32 v[74:75], v[74:75], v[114:115]
    v_pk_add_f32 v[76:77], v[76:77], v[116:117]
    v_pk_add_f32 v[78:79], v[78:79], v[118:119]
    v_pk_add_f32 v[32:33], v[32:33], v[152:153]
    v_pk_add_f32 v[34:35], v[34:35], v[154:155]
    v_pk_add_f32 v[36:37], v[36:37], v[156:157]
    v_pk_add_f32 v[38:39], v[38:39], v[158:159]
    v_pk_add_f32 v[32:33], v[32:33], v[72:73]
    v_pk_add_f32 v[34:35], v[34:35], v[74:75]
    v_pk_add_f32 v[36:37], v[36:37], v[76:77]
    v_pk_add_f32 v[38:39], v[38:39], v[78:79]
    v_pk_mul_f32 v[204:205], v[32:33], v[32:33]
    v_pk_mul_f32 v[206:207], v[34:35], v[34:35]
    v_pk_mul_f32 v[208:209], v[36:37], v[36:37]
    v_pk_mul_f32 v[210:211], v[38:39], v[38:39]
    v_pk_fma_f32 v[204:205], v[204:205], v[200:201], v[200:201] op_sel:[0,1,0] op_sel_hi:[1,1,0]
    v_pk_fma_f32 v[206:207], v[206:207], v[200:201], v[200:201] op_sel:[0,1,0] op_sel_hi:[1,1,0]
    v_pk_fma_f32 v[208:209], v[208:209], v[200:201], v[200:201] op_sel:[0,1,0] op_sel_hi:[1,1,0]
    v_pk_fma_f32 v[210:211], v[210:211], v[200:201], v[200:201] op_sel:[0,1,0] op_sel_hi:[1,1,0]
    v_pk_mul_f32 v[204:205], v[204:205], v[32:33]
    v_pk_mul_f32 v[206:207], v[206:207], v[34:35]
    v_pk_mul_f32 v[208:209], v[208:209], v[36:37]
    v_pk_mul_f32 v[210:211], v[210:211], v[38:39]
    v_exp_f32 v204, v204
    v_exp_f32 v205, v205
    v_exp_f32 v206, v206
    v_exp_f32 v207, v207
    v_exp_f32 v208, v208
    v_exp_f32 v209, v209
    v_exp_f32 v210, v210
    v_exp_f32 v211, v211
    v_pk_add_f32 v[204:205], v[204:205], v[202:203] op_sel:[0,0] op_sel_hi:[1,0]
    v_pk_add_f32 v[206:207], v[206:207], v[202:203] op_sel:[0,0] op_sel_hi:[1,0]
    v_pk_add_f32 v[208:209], v[208:209], v[202:203] op_sel:[0,0] op_sel_hi:[1,0]
    v_pk_add_f32 v[210:211], v[210:211], v[202:203] op_sel:[0,0] op_sel_hi:[1,0]
    v_rcp_f32 v204, v204
    v_rcp_f32 v205, v205
    v_rcp_f32 v206, v206
    v_rcp_f32 v207, v207
    v_rcp_f32 v208, v208
    v_rcp_f32 v209, v209
    v_rcp_f32 v210, v210
    v_rcp_f32 v211, v211
    v_pk_mul_f32 v[32:33], v[32:33], v[204:205]
    v_pk_mul_f32 v[34:35], v[34:35], v[206:207]
    v_pk_mul_f32 v[36:37], v[36:37], v[208:209]
    v_pk_mul_f32 v[38:39], v[38:39], v[210:211]
    v_cvt_pk_bf16_f32 v32, v32, v33
    v_cvt_pk_bf16_f32 v33, v34, v35
    v_cvt_pk_bf16_f32 v34, v36, v37
    v_cvt_pk_bf16_f32 v35, v38, v39
    s_cbranch_execz U_ns_10
    buffer_store_dwordx4 v[32:35], v10, s[20:23], s29 offen offset:0 sc1
U_ns_10:
    ds_read_b128 v[96:99], v13 offset:6144
    ds_read_b128 v[100:103], v13 offset:7168
    ds_read_b128 v[136:139], v14 offset:6144
    ds_read_b128 v[140:143], v14 offset:7168
    ds_read_b128 v[176:179], v15 offset:6144
    ds_read_b128 v[180:183], v15 offset:7168
    s_waitcnt lgkmcnt(12)
    v_pk_add_f32 v[80:81], v[80:81], v[120:121]
    v_pk_add_f32 v[82:83], v[82:83], v[122:123]
    v_pk_add_f32 v[84:85], v[84:85], v[124:125]
    v_pk_add_f32 v[86:87], v[86:87], v[126:127]
    v_pk_add_f32 v[40:41], v[40:41], v[160:161]
    v_pk_add_f32 v[42:43], v[42:43], v[162:163]
    v_pk_add_f32 v[44:45], v[44:45], v[164:165]
    v_pk_add_f32 v[46:47], v[46:47], v[166:167]
    v_pk_add_f32 v[40:41], v[40:41], v[80:81]
    v_pk_add_f32 v[42:43], v[42:43], v[82:83]
    v_pk_add_f32 v[44:45], v[44:45], v[84:85]
    v_pk_add_f32 v[46:47], v[46:47], v[86:87]
    v_pk_mul_f32 v[204:205], v[40:41], v[40:41]
    v_pk_mul_f32 v[206:207], v[42:43], v[42:43]
    v_pk_mul_f32 v[208:209], v[44:45], v[44:45]
    v_pk_mul_f32 v[210:211], v[46:47], v[46:47]
    v_pk_fma_f32 v[204:205], v[204:205], v[200:201], v[200:201] op_sel:[0,1,0] op_sel_hi:[1,1,0]
    v_pk_fma_f32 v[206:207], v[206:207], v[200:201], v[200:201] op_sel:[0,1,0] op_sel_hi:[1,1,0]
    v_pk_fma_f32 v[208:209], v[208:209], v[200:201], v[200:201] op_sel:[0,1,0] op_sel_hi:[1,1,0]
    v_pk_fma_f32 v[210:211], v[210:211], v[200:201], v[200:201] op_sel:[0,1,0] op_sel_hi:[1,1,0]
    v_pk_mul_f32 v[204:205], v[204:205], v[40:41]
    v_pk_mul_f32 v[206:207], v[206:207], v[42:43]
    v_pk_mul_f32 v[208:209], v[208:209], v[44:45]
    v_pk_mul_f32 v[210:211], v[210:211], v[46:47]
    v_exp_f32 v204, v204
    v_exp_f32 v205, v205
    v_exp_f32 v206, v206
    v_exp_f32 v207, v207
    v_exp_f32 v208, v208
    v_exp_f32 v209, v209
    v_exp_f32 v210, v210
    v_exp_f32 v211, v211
    v_pk_add_f32 v[204:205], v[204:205], v[202:203] op_sel:[0,0] op_sel_hi:[1,0]
    v_pk_add_f32 v[206:207], v[206:207], v[202:203] op_sel:[0,0] op_sel_hi:[1,0]
    v_pk_add_f32 v[208:209], v[208:209], v[202:203] op_sel:[0,0] op_sel_hi:[1,0]
    v_pk_add_f32 v[210:211], v[210:211], v[202:203] op_sel:[0,0] op_sel_hi:[1,0]
    v_rcp_f32 v204, v204
    v_rcp_f32 v205, v205
    v_rcp_f32 v206, v206
    v_rcp_f32 v207, v207
    v_rcp_f32 v208, v208
    v_rcp_f32 v209, v209
    v_rcp_f32 v210, v210
    v_rcp_f32 v211, v211
    v_pk_mul_f32 v[40:41], v[40:41], v[204:205]
    v_pk_mul_f32 v[42:43], v[42:43], v[206:207]
    v_pk_mul_f32 v[44:45], v[44:45], v[208:209]
    v_pk_mul_f32 v[46:47], v[46:47], v[210:211]
    v_cvt_pk_bf16_f32 v40, v40, v41
    v_cvt_pk_bf16_f32 v41, v42, v43
    v_cvt_pk_bf16_f32 v42, v44, v45
    v_cvt_pk_bf16_f32 v43, v46, v47
    s_cbranch_execz U_ns_11
    buffer_store_dwordx4 v[40:43], v10, s[20:23], s29 offen offset:1024 sc1
U_ns_11:
    ds_read_b128 v[104:107], v13 offset:8192
    ds_read_b128 v[108:111], v13 offset:9216
    ds_read_b128 v[144:147], v14 offset:8192
    ds_read_b128 v[148:151], v14 offset:9216
    ds_read_b128 v[184:187], v15 offset:8192
    ds_read_b128 v[188:191], v15 offset:9216
    s_waitcnt lgkmcnt(12)
    v_pk_add_f32 v[88:89], v[88:89], v[128:129]
    v_pk_add_f32 v[90:91], v[90:91], v[130:131]
    v_pk_add_f32 v[92:93], v[92:93], v[132:133]
    v_pk_add_f32 v[94:95], v[94:95], v[134:135]
    v_pk_add_f32 v[48:49], v[48:49], v[168:169]
    v_pk_add_f32 v[50:51], v[50:51], v[170:171]
    v_pk_add_f32 v[52:53], v[52:53], v[172:173]
    v_pk_add_f32 v[54:55], v[54:55], v[174:175]
    v_pk_add_f32 v[48:49], v[48:49], v[88:89]
    v_pk_add_f32 v[50:51], v[50:51], v[90:91]
    v_pk_add_f32 v[52:53], v[52:53], v[92:93]
    v_pk_add_f32 v[54:55], v[54:55], v[94:95]
    v_pk_mul_f32 v[204:205], v[48:49], v[48:49]
    v_pk_mul_f32 v[206:207], v[50:51], v[50:51]
    v_pk_mul_f32 v[208:209], v[52:53], v[52:53]
    v_pk_mul_f32 v[210:211], v[54:55], v[54:55]
    v_pk_fma_f32 v[204:205], v[204:205], v[200:201], v[200:201] op_sel:[0,1,0] op_sel_hi:[1,1,0]
    v_pk_fma_f32 v[206:207], v[206:207], v[200:201], v[200:201] op_sel:[0,1,0] op_sel_hi:[1,1,0]
    v_pk_fma_f32 v[208:209], v[208:209], v[200:201], v[200:201] op_sel:[0,1,0] op_sel_hi:[1,1,0]
    v_pk_fma_f32 v[210:211], v[210:211], v[200:201], v[200:201] op_sel:[0,1,0] op_sel_hi:[1,1,0]
    v_pk_mul_f32 v[204:205], v[204:205], v[48:49]
    v_pk_mul_f32 v[206:207], v[206:207], v[50:51]
    v_pk_mul_f32 v[208:209], v[208:209], v[52:53]
    v_pk_mul_f32 v[210:211], v[210:211], v[54:55]
    v_exp_f32 v204, v204
    v_exp_f32 v205, v205
    v_exp_f32 v206, v206
    v_exp_f32 v207, v207
    v_exp_f32 v208, v208
    v_exp_f32 v209, v209
    v_exp_f32 v210, v210
    v_exp_f32 v211, v211
    v_pk_add_f32 v[204:205], v[204:205], v[202:203] op_sel:[0,0] op_sel_hi:[1,0]
    v_pk_add_f32 v[206:207], v[206:207], v[202:203] op_sel:[0,0] op_sel_hi:[1,0]
    v_pk_add_f32 v[208:209], v[208:209], v[202:203] op_sel:[0,0] op_sel_hi:[1,0]
    v_pk_add_f32 v[210:211], v[210:211], v[202:203] op_sel:[0,0] op_sel_hi:[1,0]
    v_rcp_f32 v204, v204
    v_rcp_f32 v205, v205
    v_rcp_f32 v206, v206
    v_rcp_f32 v207, v207
    v_rcp_f32 v208, v208
    v_rcp_f32 v209, v209
    v_rcp_f32 v210, v210
    v_rcp_f32 v211, v211
    v_pk_mul_f32 v[48:49], v[48:49], v[204:205]
    v_pk_mul_f32 v[50:51], v[50:51], v[206:207]
    v_pk_mul_f32 v[52:53], v[52:53], v[208:209]
    v_pk_mul_f32 v[54:55], v[54:55], v[210:211]
    v_cvt_pk_bf16_f32 v48, v48, v49
    v_cvt_pk_bf16_f32 v49, v50, v51
    v_cvt_pk_bf16_f32 v50, v52, v53
    v_cvt_pk_bf16_f32 v51, v54, v55
    s_cbranch_execz U_ns_12
    buffer_store_dwordx4 v[48:51], v10, s[20:23], s29 offen offset:2048 sc1
U_ns_12:
    s_waitcnt lgkmcnt(6)
    v_pk_add_f32 v[96:97], v[96:97], v[136:137]
    v_pk_add_f32 v[98:99], v[98:99], v[138:139]
    v_pk_add_f32 v[100:101], v[100:101], v[140:141]
    v_pk_add_f32 v[102:103], v[102:103], v[142:143]
    v_pk_add_f32 v[56:57], v[56:57], v[176:177]
    v_pk_add_f32 v[58:59], v[58:59], v[178:179]
    v_pk_add_f32 v[60:61], v[60:61], v[180:181]
    v_pk_add_f32 v[62:63], v[62:63], v[182:183]
    v_pk_add_f32 v[56:57], v[56:57], v[96:97]
    v_pk_add_f32 v[58:59], v[58:59], v[98:99]
    v_pk_add_f32 v[60:61], v[60:61], v[100:101]
    v_pk_add_f32 v[62:63], v[62:63], v[102:103]
    v_pk_mul_f32 v[204:205], v[56:57], v[56:57]
    v_pk_mul_f32 v[206:207], v[58:59], v[58:59]
    v_pk_mul_f32 v[208:209], v[60:61], v[60:61]
    v_pk_mul_f32 v[210:211], v[62:63], v[62:63]
    v_pk_fma_f32 v[204:205], v[204:205], v[200:201], v[200:201] op_sel:[0,1,0] op_sel_hi:[1,1,0]
    v_pk_fma_f32 v[206:207], v[206:207], v[200:201], v[200:201] op_sel:[0,1,0] op_sel_hi:[1,1,0]
    v_pk_fma_f32 v[208:209], v[208:209], v[200:201], v[200:201] op_sel:[0,1,0] op_sel_hi:[1,1,0]
    v_pk_fma_f32 v[210:211], v[210:211], v[200:201], v[200:201] op_sel:[0,1,0] op_sel_hi:[1,1,0]
    v_pk_mul_f32 v[204:205], v[204:205], v[56:57]
    v_pk_mul_f32 v[206:207], v[206:207], v[58:59]
    v_pk_mul_f32 v[208:209], v[208:209], v[60:61]
    v_pk_mul_f32 v[210:211], v[210:211], v[62:63]
    v_exp_f32 v204, v204
    v_exp_f32 v205, v205
    v_exp_f32 v206, v206
    v_exp_f32 v207, v207
    v_exp_f32 v208, v208
    v_exp_f32 v209, v209
    v_exp_f32 v210, v210
    v_exp_f32 v211, v211
    v_pk_add_f32 v[204:205], v[204:205], v[202:203] op_sel:[0,0] op_sel_hi:[1,0]
    v_pk_add_f32 v[206:207], v[206:207], v[202:203] op_sel:[0,0] op_sel_hi:[1,0]
    v_pk_add_f32 v[208:209], v[208:209], v[202:203] op_sel:[0,0] op_sel_hi:[1,0]
    v_pk_add_f32 v[210:211], v[210:211], v[202:203] op_sel:[0,0] op_sel_hi:[1,0]
    v_rcp_f32 v204, v204
    v_rcp_f32 v205, v205
    v_rcp_f32 v206, v206
    v_rcp_f32 v207, v207
    v_rcp_f32 v208, v208
    v_rcp_f32 v209, v209
    v_rcp_f32 v210, v210
    v_rcp_f32 v211, v211
    v_pk_mul_f32 v[56:57], v[56:57], v[204:205]
    v_pk_mul_f32 v[58:59], v[58:59], v[206:207]
    v_pk_mul_f32 v[60:61], v[60:61], v[208:209]
    v_pk_mul_f32 v[62:63], v[62:63], v[210:211]
    v_cvt_pk_bf16_f32 v56, v56, v57
    v_cvt_pk_bf16_f32 v57, v58, v59
    v_cvt_pk_bf16_f32 v58, v60, v61
    v_cvt_pk_bf16_f32 v59, v62, v63
    s_cbranch_execz U_ns_13
    buffer_store_dwordx4 v[56:59], v10, s[20:23], s29 offen offset:3072 sc1
U_ns_13:
    s_waitcnt lgkmcnt(0)
    v_pk_add_f32 v[104:105], v[104:105], v[144:145]
    v_pk_add_f32 v[106:107], v[106:107], v[146:147]
    v_pk_add_f32 v[108:109], v[108:109], v[148:149]
    v_pk_add_f32 v[110:111], v[110:111], v[150:151]
    v_pk_add_f32 v[64:65], v[64:65], v[184:185]
    v_pk_add_f32 v[66:67], v[66:67], v[186:187]
    v_pk_add_f32 v[68:69], v[68:69], v[188:189]
    v_pk_add_f32 v[70:71], v[70:71], v[190:191]
    v_pk_add_f32 v[64:65], v[64:65], v[104:105]
    v_pk_add_f32 v[66:67], v[66:67], v[106:107]
    v_pk_add_f32 v[68:69], v[68:69], v[108:109]
    v_pk_add_f32 v[70:71], v[70:71], v[110:111]
    v_pk_mul_f32 v[204:205], v[64:65], v[64:65]
    v_pk_mul_f32 v[206:207], v[66:67], v[66:67]
    v_pk_mul_f32 v[208:209], v[68:69], v[68:69]
    v_pk_mul_f32 v[210:211], v[70:71], v[70:71]
    v_pk_fma_f32 v[204:205], v[204:205], v[200:201], v[200:201] op_sel:[0,1,0] op_sel_hi:[1,1,0]
    v_pk_fma_f32 v[206:207], v[206:207], v[200:201], v[200:201] op_sel:[0,1,0] op_sel_hi:[1,1,0]
    v_pk_fma_f32 v[208:209], v[208:209], v[200:201], v[200:201] op_sel:[0,1,0] op_sel_hi:[1,1,0]
    v_pk_fma_f32 v[210:211], v[210:211], v[200:201], v[200:201] op_sel:[0,1,0] op_sel_hi:[1,1,0]
    v_pk_mul_f32 v[204:205], v[204:205], v[64:65]
    v_pk_mul_f32 v[206:207], v[206:207], v[66:67]
    v_pk_mul_f32 v[208:209], v[208:209], v[68:69]
    v_pk_mul_f32 v[210:211], v[210:211], v[70:71]
    v_exp_f32 v204, v204
    v_exp_f32 v205, v205
    v_exp_f32 v206, v206
    v_exp_f32 v207, v207
    v_exp_f32 v208, v208
    v_exp_f32 v209, v209
    v_exp_f32 v210, v210
    v_exp_f32 v211, v211
    v_pk_add_f32 v[204:205], v[204:205], v[202:203] op_sel:[0,0] op_sel_hi:[1,0]
    v_pk_add_f32 v[206:207], v[206:207], v[202:203] op_sel:[0,0] op_sel_hi:[1,0]
    v_pk_add_f32 v[208:209], v[208:209], v[202:203] op_sel:[0,0] op_sel_hi:[1,0]
    v_pk_add_f32 v[210:211], v[210:211], v[202:203] op_sel:[0,0] op_sel_hi:[1,0]
    v_rcp_f32 v204, v204
    v_rcp_f32 v205, v205
    v_rcp_f32 v206, v206
    v_rcp_f32 v207, v207
    v_rcp_f32 v208, v208
    v_rcp_f32 v209, v209
    v_rcp_f32 v210, v210
    v_rcp_f32 v211, v211
    v_pk_mul_f32 v[64:65], v[64:65], v[204:205]
    v_pk_mul_f32 v[66:67], v[66:67], v[206:207]
    v_pk_mul_f32 v[68:69], v[68:69], v[208:209]
    v_pk_mul_f32 v[70:71], v[70:71], v[210:211]
    v_cvt_pk_bf16_f32 v64, v64, v65
    v_cvt_pk_bf16_f32 v65, v66, v67
    v_cvt_pk_bf16_f32 v66, v68, v69
    v_cvt_pk_bf16_f32 v67, v70, v71
    s_cbranch_execz U_ns_14
    buffer_store_dwordx4 v[64:67], v11, s[20:23], s29 offen sc1
U_ns_14:
K1_udone:
    s_lshl_b32 s41, s28, 6
    s_add_u32 s41, s41, s27
    s_lshl_b32 s41, s41, 2
    s_add_u32 s41, s41, 7981056
    s_mov_b32 s85, 3
    s_branch K1_fin1
K1_fin:
    s_mov_b32 s85, 0
K1_fin1:
    s_mov_b32 s72, 0
    s_mov_b32 s73, 0
    s_mov_b32 s84, 0
K1_fin2:
    s_mov_b64 exec, -1
    s_mov_b32 s7, s41
    s_branch K2_body
K1_pf:
    s_waitcnt lgkmcnt(0)
    s_mov_b32 s20, s86
    s_mov_b32 s21, s87
    s_mov_b32 s22, 16961536
    s_mov_b32 s23, 0x20000
    s_mov_b32 s8, s74
    s_mov_b32 s9, s75
    s_mov_b32 s10, 7077888
    s_mov_b32 s11, 0x20000
    s_mov_b32 s16, s76
    s_mov_b32 s17, s77
    s_mov_b32 s18, 3456
    s_mov_b32 s19, 0x20000
    s_mov_b32 s12, s78
    s_mov_b32 s13, s79
    s_mov_b32 s14, 7077888
    s_mov_b32 s15, 0x20000
    s_sub_u32 s31, s26, 28
    s_lshl_b32 s31, s31, 2
    s_add_u32 s31, s31, s24
    v_lshlrev_b32 v6, 4, v1
    s_and_b32 s29, s25, 3
    s_mul_i32 s29, s29, 7
    s_and_b32 s29, s29, 30
    s_lshl_b32 s29, s29, 7
    s_add_u32 s30, s31, 256
    s_mul_i32 s30, s30, 3456
    s_add_u32 s29, s29, s30
    s_mov_b32 s30, 0
K1_pfa:
    s_add_u32 s27, s29, 0
    buffer_load_dwordx4 v[8:11], v6, s[8:11], s27 offen
    s_add_u32 s27, s29, 1769472
    buffer_load_dwordx4 v[8:11], v6, s[8:11], s27 offen
    s_add_u32 s27, s29, 3538944
    buffer_load_dwordx4 v[8:11], v6, s[8:11], s27 offen
    s_add_u32 s27, s29, 5308416
    buffer_load_dwordx4 v[8:11], v6, s[8:11], s27 offen
    s_add_u32 s29, s29, 55296
    s_add_u32 s30, s30, 1
    s_waitcnt vmcnt(12)
    s_cmp_lt_u32 s30, 16
    s_cbranch_scc1 K1_pfa
    v_lshrrev_b32 v6, 5, v1
    v_lshlrev_b32 v6, 12, v6
    v_and_b32 v4, 31, v1
    v_lshl_add_u32 v6, v4, 4, v6
    s_lshl_b32 s29, s25, 9
    s_lshl_b32 s30, s31, 13
    s_add_u32 s29, s29, s30
    s_mov_b32 s30, 0
K1_pfl:
    buffer_load_dwordx4 v[8:11], v6, s[12:15], s29 offen
    s_add_u32 s29, s29, 131072
    s_add_u32 s30, s30, 1
    s_waitcnt vmcnt(16)
    s_cmp_lt_u32 s30, 33
    s_cbranch_scc1 K1_pfl
    s_mov_b32 s41, 2130706432
    s_waitcnt vmcnt(0)
    s_branch K1_fin
K1_att:
    s_lshr_b32 s27, s25, 1
    s_lshl_b32 s27, s27, 3
    s_lshr_b32 s30, s26, 2
    s_add_u32 s27, s27, s30
    s_and_b32 s28, s25, 1
    s_lshl_b32 s28, s28, 2
    s_and_b32 s29, s26, 3
    s_add_u32 s28, s28, s29
    s_lshl_b32 s33, s27, 2
    s_add_u32 s33, s33, s24
    s_mul_i32 s33, s33, 40960
    s_add_u32 s37, s33, 2621440
    s_mul_i32 s34, s28, 307200
    s_add_u32 s34, s34, 5242880
    v_lshlrev_b32 v6, 4, v1
    v_add_u32 v7, 20480, v6
    s_lshr_b32 s29, s24, 1
    s_mul_i32 s36, s29, 15360
    s_and_b32 s29, s24, 1
    s_mul_i32 s29, s29, 5120
    s_add_u32 s36, s36, s29
    s_add_u32 s36, s36, s34
    s_add_u32 s36, s36, 6144
    s_mul_i32 s38, s24, 5120
    s_add_u32 s38, s38, 1024
    s_mul_i32 s39, s24, 15360
    s_add_u32 s39, s39, s34
    s_add_u32 s39, s39, 1024
    s_waitcnt lgkmcnt(0)
    s_mov_b32 s20, s86
    s_mov_b32 s21, s87
    s_mov_b32 s22, 16961536
    s_mov_b32 s23, 0x20000
    s_mov_b32 s8, s74
    s_mov_b32 s9, s75
    s_mov_b32 s10, 7077888
    s_mov_b32 s11, 0x20000
    s_mov_b32 s16, s76
    s_mov_b32 s17, s77
    s_mov_b32 s18, 3456
    s_mov_b32 s19, 0x20000
    s_mov_b32 s12, s78
    s_mov_b32 s13, s79
    s_mov_b32 s14, 7077888
    s_mov_b32 s15, 0x20000
    s_add_u32 m0, s38, -1024
    s_sub_u32 s31, s36, 1024
    buffer_load_dwordx4 v6, s[20:23], s31 offen lds
    s_add_u32 m0, s38, 0
    s_nop 0
    buffer_load_dwordx4 v6, s[20:23], s36 offen offset:0 lds
    buffer_load_dwordx4 v6, s[20:23], s36 offen offset:1024 lds
    buffer_load_dwordx4 v6, s[20:23], s36 offen offset:2048 lds
    buffer_load_dwordx4 v6, s[20:23], s36 offen offset:3072 lds
    s_add_u32 s36, s36, 30720
    buffer_load_dwordx4 a[0:3], v6, s[20:23], s37 offen offset:0
    buffer_load_dwordx4 a[4:7], v7, s[20:23], s37 offen offset:0
    buffer_load_dwordx4 a[8:11], v6, s[20:23], s37 offen offset:1024
    buffer_load_dwordx4 a[12:15], v7, s[20:23], s37 offen offset:1024
    s_add_u32 s37, s37, 2048
    s_add_u32 m0, s38, 19456
    s_sub_u32 s31, s36, 1024
    buffer_load_dwordx4 v6, s[20:23], s31 offen lds
    s_add_u32 m0, s38, 20480
    s_nop 0
    buffer_load_dwordx4 v6, s[20:23], s36 offen offset:0 lds
    buffer_load_dwordx4 v6, s[20:23], s36 offen offset:1024 lds
    buffer_load_dwordx4 v6, s[20:23], s36 offen offset:2048 lds
    buffer_load_dwordx4 v6, s[20:23], s36 offen offset:3072 lds
    s_add_u32 s36, s36, 30720
    buffer_load_dwordx4 a[16:19], v6, s[20:23], s37 offen offset:0
    buffer_load_dwordx4 a[20:23], v7, s[20:23], s37 offen offset:0
    buffer_load_dwordx4 a[24:27], v6, s[20:23], s37 offen offset:1024
    buffer_load_dwordx4 a[28:31], v7, s[20:23], s37 offen offset:1024
    s_add_u32 s37, s37, 2048
    s_mov_b32 s35, 0x3fb8aa3b
    s_getpc_b64 s[42:43]
K1a_pc:
    s_add_u32 s46, s42, K1a_sm1-K1a_pc
    s_addc_u32 s47, s43, 0
    s_add_u32 s48, s42, K1a_sm2-K1a_pc
    s_addc_u32 s49, s43, 0
    s_add_u32 s42, s42, K1a_sm-K1a_pc
    s_addc_u32 s43, s43, 0
    v_add_u32 v8, 65536, v6
    v_add_u32 v9, 131072, v6
    s_waitcnt vmcnt(9)
    s_barrier
    ds_read_b128 v[96:99], v6 offset:0
    ds_read_b128 v[100:103], v6 offset:1024
    ds_read_b128 v[104:107], v6 offset:2048
    ds_read_b128 v[108:111], v6 offset:3072
    ds_read_b128 v[112:115], v6 offset:4096
    s_waitcnt lgkmcnt(3)
    v_mfma_f32_16x16x32_bf16 v[16:19], v[96:99], a[0:3], 0
    v_mfma_f32_16x16x32_bf16 v[36:39], v[96:99], a[4:7], 0
    ds_read_b128 v[116:119], v6 offset:5120
    v_mfma_f32_16x16x32_bf16 v[20:23], v[100:103], a[0:3], 0
    v_mfma_f32_16x16x32_bf16 v[40:43], v[100:103], a[4:7], 0
    s_add_u32 m0, s38, 39936
    s_sub_u32 s31, s36, 1024
    buffer_load_dwordx4 v6, s[20:23], s31 offen lds
    s_add_u32 m0, s38, 40960
    ds_read_b128 v[120:123], v6 offset:6144
    s_waitcnt lgkmcnt(3)
    v_mfma_f32_16x16x32_bf16 v[24:27], v[104:107], a[0:3], 0
    v_mfma_f32_16x16x32_bf16 v[44:47], v[104:107], a[4:7], 0
    ds_read_b128 v[124:127], v6 offset:7168
    v_mfma_f32_16x16x32_bf16 v[28:31], v[108:111], a[0:3], 0
    v_mfma_f32_16x16x32_bf16 v[48:51], v[108:111], a[4:7], 0
    buffer_load_dwordx4 v6, s[20:23], s36 offen offset:0 lds
    ds_read_b128 v[96:99], v6 offset:8192
    s_waitcnt lgkmcnt(3)
    v_mfma_f32_16x16x32_bf16 v[32:35], v[112:115], a[0:3], 0
    v_mfma_f32_16x16x32_bf16 v[52:55], v[112:115], a[4:7], 0
    ds_read_b128 v[100:103], v6 offset:9216
    v_mfma_f32_16x16x32_bf16 v[56:59], v[116:119], a[0:3], 0
    v_mfma_f32_16x16x32_bf16 v[76:79], v[116:119], a[4:7], 0
    buffer_load_dwordx4 v6, s[20:23], s36 offen offset:1024 lds
    ds_read_b128 v[104:107], v6 offset:10240
    s_waitcnt lgkmcnt(3)
    v_mfma_f32_16x16x32_bf16 v[60:63], v[120:123], a[0:3], 0
    v_mfma_f32_16x16x32_bf16 v[80:83], v[120:123], a[4:7], 0
    ds_read_b128 v[108:111], v6 offset:11264
    v_mfma_f32_16x16x32_bf16 v[64:67], v[124:127], a[0:3], 0
    v_mfma_f32_16x16x32_bf16 v[84:87], v[124:127], a[4:7], 0
    buffer_load_dwordx4 v6, s[20:23], s36 offen offset:2048 lds
    ds_read_b128 v[112:115], v6 offset:12288
    s_waitcnt lgkmcnt(3)
    v_mfma_f32_16x16x32_bf16 v[68:71], v[96:99], a[0:3], 0
    v_mfma_f32_16x16x32_bf16 v[88:91], v[96:99], a[4:7], 0
    ds_read_b128 v[116:119], v6 offset:13312
    v_mfma_f32_16x16x32_bf16 v[72:75], v[100:103], a[0:3], 0
    v_mfma_f32_16x16x32_bf16 v[92:95], v[100:103], a[4:7], 0
    buffer_load_dwordx4 v6, s[20:23], s36 offen offset:3072 lds
    s_add_u32 s36, s36, 30720
    ds_read_b128 v[120:123], v6 offset:14336
    s_waitcnt lgkmcnt(3)
    v_mfma_f32_16x16x32_bf16 v[16:19], v[104:107], a[8:11], v[16:19]
    v_mfma_f32_16x16x32_bf16 v[36:39], v[104:107], a[12:15], v[36:39]
    ds_read_b128 v[124:127], v6 offset:15360
    v_mfma_f32_16x16x32_bf16 v[20:23], v[108:111], a[8:11], v[20:23]
    v_mfma_f32_16x16x32_bf16 v[40:43], v[108:111], a[12:15], v[40:43]
    buffer_load_dwordx4 a[32:35], v6, s[20:23], s37 offen offset:0
    ds_read_b128 v[96:99], v6 offset:16384
    s_waitcnt lgkmcnt(3)
    v_mfma_f32_16x16x32_bf16 v[24:27], v[112:115], a[8:11], v[24:27]
    v_mfma_f32_16x16x32_bf16 v[44:47], v[112:115], a[12:15], v[44:47]
    ds_read_b128 v[100:103], v6 offset:17408
    v_mfma_f32_16x16x32_bf16 v[28:31], v[116:119], a[8:11], v[28:31]
    v_mfma_f32_16x16x32_bf16 v[48:51], v[116:119], a[12:15], v[48:51]
    buffer_load_dwordx4 a[36:39], v7, s[20:23], s37 offen offset:0
    ds_read_b128 v[104:107], v6 offset:18432
    s_waitcnt lgkmcnt(3)
    v_mfma_f32_16x16x32_bf16 v[32:35], v[120:123], a[8:11], v[32:35]
    v_mfma_f32_16x16x32_bf16 v[52:55], v[120:123], a[12:15], v[52:55]
    ds_read_b128 v[108:111], v6 offset:19456
    v_mfma_f32_16x16x32_bf16 v[56:59], v[124:127], a[8:11], v[56:59]
    v_mfma_f32_16x16x32_bf16 v[76:79], v[124:127], a[12:15], v[76:79]
    buffer_load_dwordx4 a[40:43], v6, s[20:23], s37 offen offset:1024
    buffer_load_dwordx4 a[44:47], v7, s[20:23], s37 offen offset:1024
    s_add_u32 s37, s37, 2048
    s_waitcnt vmcnt(9)
    s_barrier
    ds_read_b128 v[112:115], v6 offset:20480
    s_waitcnt lgkmcnt(3)
    v_mfma_f32_16x16x32_bf16 v[60:63], v[96:99], a[8:11], v[60:63]
    v_mfma_f32_16x16x32_bf16 v[80:83], v[96:99], a[12:15], v[80:83]
    ds_read_b128 v[116:119], v6 offset:21504
    v_mfma_f32_16x16x32_bf16 v[64:67], v[100:103], a[8:11], v[64:67]
    v_mfma_f32_16x16x32_bf16 v[84:87], v[100:103], a[12:15], v[84:87]
    s_add_u32 m0, s38, 60416
    s_sub_u32 s31, s36, 1024
    buffer_load_dwordx4 v6, s[20:23], s31 offen lds
    s_add_u32 m0, s38, 61440
    ds_read_b128 v[120:123], v6 offset:22528
    s_waitcnt lgkmcnt(3)
    v_mfma_f32_16x16x32_bf16 v[68:71], v[104:107], a[8:11], v[68:71]
    v_mfma_f32_16x16x32_bf16 v[88:91], v[104:107], a[12:15], v[88:91]
    ds_read_b128 v[124:127], v6 offset:23552
    v_mfma_f32_16x16x32_bf16 v[72:75], v[108:111], a[8:11], v[72:75]
    v_mfma_f32_16x16x32_bf16 v[92:95], v[108:111], a[12:15], v[92:95]
    buffer_load_dwordx4 v6, s[20:23], s36 offen offset:0 lds
    ds_read_b128 v[96:99], v6 offset:24576
    s_waitcnt lgkmcnt(3)
    v_mfma_f32_16x16x32_bf16 v[16:19], v[112:115], a[16:19], v[16:19]
    v_mfma_f32_16x16x32_bf16 v[36:39], v[112:115], a[20:23], v[36:39]
    ds_read_b128 v[100:103], v6 offset:25600
    v_mfma_f32_16x16x32_bf16 v[20:23], v[116:119], a[16:19], v[20:23]
    v_mfma_f32_16x16x32_bf16 v[40:43], v[116:119], a[20:23], v[40:43]
    buffer_load_dwordx4 v6, s[20:23], s36 offen offset:1024 lds
    ds_read_b128 v[104:107], v6 offset:26624
    s_waitcnt lgkmcnt(3)
    v_mfma_f32_16x16x32_bf16 v[24:27], v[120:123], a[16:19], v[24:27]
    v_mfma_f32_16x16x32_bf16 v[44:47], v[120:123], a[20:23], v[44:47]
    ds_read_b128 v[108:111], v6 offset:27648
    v_mfma_f32_16x16x32_bf16 v[28:31], v[124:127], a[16:19], v[28:31]
    v_mfma_f32_16x16x32_bf16 v[48:51], v[124:127], a[20:23], v[48:51]
    buffer_load_dwordx4 v6, s[20:23], s36 offen offset:2048 lds
    ds_read_b128 v[112:115], v6 offset:28672
    s_waitcnt lgkmcnt(3)
    v_mfma_f32_16x16x32_bf16 v[32:35], v[96:99], a[16:19], v[32:35]
    v_mfma_f32_16x16x32_bf16 v[52:55], v[96:99], a[20:23], v[52:55]
    ds_read_b128 v[116:119], v6 offset:29696
    v_mfma_f32_16x16x32_bf16 v[56:59], v[100:103], a[16:19], v[56:59]
    v_mfma_f32_16x16x32_bf16 v[76:79], v[100:103], a[20:23], v[76:79]
    buffer_load_dwordx4 v6, s[20:23], s36 offen offset:3072 lds
    s_add_u32 s36, s36, 30720
    ds_read_b128 v[120:123], v6 offset:30720
    s_waitcnt lgkmcnt(3)
    v_mfma_f32_16x16x32_bf16 v[60:63], v[104:107], a[16:19], v[60:63]
    v_mfma_f32_16x16x32_bf16 v[80:83], v[104:107], a[20:23], v[80:83]
    ds_read_b128 v[124:127], v6 offset:31744
    v_mfma_f32_16x16x32_bf16 v[64:67], v[108:111], a[16:19], v[64:67]
    v_mfma_f32_16x16x32_bf16 v[84:87], v[108:111], a[20:23], v[84:87]
    buffer_load_dwordx4 a[48:51], v6, s[20:23], s37 offen offset:0
    ds_read_b128 v[96:99], v6 offset:32768
    s_waitcnt lgkmcnt(3)
    v_mfma_f32_16x16x32_bf16 v[68:71], v[112:115], a[16:19], v[68:71]
    v_mfma_f32_16x16x32_bf16 v[88:91], v[112:115], a[20:23], v[88:91]
    ds_read_b128 v[100:103], v6 offset:33792
    v_mfma_f32_16x16x32_bf16 v[72:75], v[116:119], a[16:19], v[72:75]
    v_mfma_f32_16x16x32_bf16 v[92:95], v[116:119], a[20:23], v[92:95]
    buffer_load_dwordx4 a[52:55], v7, s[20:23], s37 offen offset:0
    ds_read_b128 v[104:107], v6 offset:34816
    s_waitcnt lgkmcnt(3)
    v_mfma_f32_16x16x32_bf16 v[16:19], v[120:123], a[24:27], v[16:19]
    v_mfma_f32_16x16x32_bf16 v[36:39], v[120:123], a[28:31], v[36:39]
    ds_read_b128 v[108:111], v6 offset:35840
    v_mfma_f32_16x16x32_bf16 v[20:23], v[124:127], a[24:27], v[20:23]
    v_mfma_f32_16x16x32_bf16 v[40:43], v[124:127], a[28:31], v[40:43]
    buffer_load_dwordx4 a[56:59], v6, s[20:23], s37 offen offset:1024
    ds_read_b128 v[112:115], v6 offset:36864
    s_waitcnt lgkmcnt(3)
    v_mfma_f32_16x16x32_bf16 v[24:27], v[96:99], a[24:27], v[24:27]
    v_mfma_f32_16x16x32_bf16 v[44:47], v[96:99], a[28:31], v[44:47]
    ds_read_b128 v[116:119], v6 offset:37888
    v_mfma_f32_16x16x32_bf16 v[28:31], v[100:103], a[24:27], v[28:31]
    v_mfma_f32_16x16x32_bf16 v[48:51], v[100:103], a[28:31], v[48:51]
    buffer_load_dwordx4 a[60:63], v7, s[20:23], s37 offen offset:1024
    s_add_u32 s37, s37, 2048
    ds_read_b128 v[120:123], v6 offset:38912
    s_waitcnt lgkmcnt(3)
    v_mfma_f32_16x16x32_bf16 v[32:35], v[104:107], a[24:27], v[32:35]
    v_mfma_f32_16x16x32_bf16 v[52:55], v[104:107], a[28:31], v[52:55]
    ds_read_b128 v[124:127], v6 offset:39936
    v_mfma_f32_16x16x32_bf16 v[56:59], v[108:111], a[24:27], v[56:59]
    v_mfma_f32_16x16x32_bf16 v[76:79], v[108:111], a[28:31], v[76:79]
    s_waitcnt vmcnt(9)
    s_barrier
    ds_read_b128 v[96:99], v6 offset:40960
    s_waitcnt lgkmcnt(3)
    v_mfma_f32_16x16x32_bf16 v[60:63], v[112:115], a[24:27], v[60:63]
    v_mfma_f32_16x16x32_bf16 v[80:83], v[112:115], a[28:31], v[80:83]
    ds_read_b128 v[100:103], v6 offset:41984
    v_mfma_f32_16x16x32_bf16 v[64:67], v[116:119], a[24:27], v[64:67]
    v_mfma_f32_16x16x32_bf16 v[84:87], v[116:119], a[28:31], v[84:87]
    s_add_u32 m0, s38, -1024
    s_sub_u32 s31, s36, 1024
    buffer_load_dwordx4 v6, s[20:23], s31 offen lds
    s_add_u32 m0, s38, 0
    ds_read_b128 v[104:107], v6 offset:43008
    s_waitcnt lgkmcnt(3)
    v_mfma_f32_16x16x32_bf16 v[68:71], v[120:123], a[24:27], v[68:71]
    v_mfma_f32_16x16x32_bf16 v[88:91], v[120:123], a[28:31], v[88:91]
    ds_read_b128 v[108:111], v6 offset:44032
    v_mfma_f32_16x16x32_bf16 v[72:75], v[124:127], a[24:27], v[72:75]
    v_mfma_f32_16x16x32_bf16 v[92:95], v[124:127], a[28:31], v[92:95]
    buffer_load_dwordx4 v6, s[20:23], s36 offen offset:0 lds
    ds_read_b128 v[112:115], v6 offset:45056
    s_waitcnt lgkmcnt(3)
    v_mfma_f32_16x16x32_bf16 v[16:19], v[96:99], a[32:35], v[16:19]
    v_mfma_f32_16x16x32_bf16 v[36:39], v[96:99], a[36:39], v[36:39]
    ds_read_b128 v[116:119], v6 offset:46080
    v_mfma_f32_16x16x32_bf16 v[20:23], v[100:103], a[32:35], v[20:23]
    v_mfma_f32_16x16x32_bf16 v[40:43], v[100:103], a[36:39], v[40:43]
    buffer_load_dwordx4 v6, s[20:23], s36 offen offset:1024 lds
    ds_read_b128 v[120:123], v6 offset:47104
    s_waitcnt lgkmcnt(3)
    v_mfma_f32_16x16x32_bf16 v[24:27], v[104:107], a[32:35], v[24:27]
    v_mfma_f32_16x16x32_bf16 v[44:47], v[104:107], a[36:39], v[44:47]
    ds_read_b128 v[124:127], v6 offset:48128
    v_mfma_f32_16x16x32_bf16 v[28:31], v[108:111], a[32:35], v[28:31]
    v_mfma_f32_16x16x32_bf16 v[48:51], v[108:111], a[36:39], v[48:51]
    buffer_load_dwordx4 v6, s[20:23], s36 offen offset:2048 lds
    ds_read_b128 v[96:99], v6 offset:49152
    s_waitcnt lgkmcnt(3)
    v_mfma_f32_16x16x32_bf16 v[32:35], v[112:115], a[32:35], v[32:35]
    v_mfma_f32_16x16x32_bf16 v[52:55], v[112:115], a[36:39], v[52:55]
    ds_read_b128 v[100:103], v6 offset:50176
    v_mfma_f32_16x16x32_bf16 v[56:59], v[116:119], a[32:35], v[56:59]
    v_mfma_f32_16x16x32_bf16 v[76:79], v[116:119], a[36:39], v[76:79]
    buffer_load_dwordx4 v6, s[20:23], s36 offen offset:3072 lds
    s_add_u32 s36, s36, 30720
    ds_read_b128 v[104:107], v6 offset:51200
    s_waitcnt lgkmcnt(3)
    v_mfma_f32_16x16x32_bf16 v[60:63], v[120:123], a[32:35], v[60:63]
    v_mfma_f32_16x16x32_bf16 v[80:83], v[120:123], a[36:39], v[80:83]
    ds_read_b128 v[108:111], v6 offset:52224
    v_mfma_f32_16x16x32_bf16 v[64:67], v[124:127], a[32:35], v[64:67]
    v_mfma_f32_16x16x32_bf16 v[84:87], v[124:127], a[36:39], v[84:87]
    buffer_load_dwordx4 a[64:67], v6, s[20:23], s37 offen offset:0
    ds_read_b128 v[112:115], v6 offset:53248
    s_waitcnt lgkmcnt(3)
    v_mfma_f32_16x16x32_bf16 v[68:71], v[96:99], a[32:35], v[68:71]
    v_mfma_f32_16x16x32_bf16 v[88:91], v[96:99], a[36:39], v[88:91]
    ds_read_b128 v[116:119], v6 offset:54272
    v_mfma_f32_16x16x32_bf16 v[72:75], v[100:103], a[32:35], v[72:75]
    v_mfma_f32_16x16x32_bf16 v[92:95], v[100:103], a[36:39], v[92:95]
    buffer_load_dwordx4 a[68:71], v7, s[20:23], s37 offen offset:0
    ds_read_b128 v[120:123], v6 offset:55296
    s_waitcnt lgkmcnt(3)
    v_mfma_f32_16x16x32_bf16 v[16:19], v[104:107], a[40:43], v[16:19]
    v_mfma_f32_16x16x32_bf16 v[36:39], v[104:107], a[44:47], v[36:39]
    ds_read_b128 v[124:127], v6 offset:56320
    v_mfma_f32_16x16x32_bf16 v[20:23], v[108:111], a[40:43], v[20:23]
    v_mfma_f32_16x16x32_bf16 v[40:43], v[108:111], a[44:47], v[40:43]
    buffer_load_dwordx4 a[72:75], v6, s[20:23], s37 offen offset:1024
    ds_read_b128 v[96:99], v6 offset:57344
    s_waitcnt lgkmcnt(3)
    v_mfma_f32_16x16x32_bf16 v[24:27], v[112:115], a[40:43], v[24:27]
    v_mfma_f32_16x16x32_bf16 v[44:47], v[112:115], a[44:47], v[44:47]
    ds_read_b128 v[100:103], v6 offset:58368
    v_mfma_f32_16x16x32_bf16 v[28:31], v[116:119], a[40:43], v[28:31]
    v_mfma_f32_16x16x32_bf16 v[48:51], v[116:119], a[44:47], v[48:51]
    buffer_load_dwordx4 a[76:79], v7, s[20:23], s37 offen offset:1024
    s_add_u32 s37, s37, 2048
    ds_read_b128 v[104:107], v6 offset:59392
    s_waitcnt lgkmcnt(3)
    v_mfma_f32_16x16x32_bf16 v[32:35], v[120:123], a[40:43], v[32:35]
    v_mfma_f32_16x16x32_bf16 v[52:55], v[120:123], a[44:47], v[52:55]
    ds_read_b128 v[108:111], v6 offset:60416
    v_mfma_f32_16x16x32_bf16 v[56:59], v[124:127], a[40:43], v[56:59]
    v_mfma_f32_16x16x32_bf16 v[76:79], v[124:127], a[44:47], v[76:79]
    s_waitcnt vmcnt(9)
    s_barrier
    ds_read_b128 v[112:115], v6 offset:61440
    s_waitcnt lgkmcnt(3)
    v_mfma_f32_16x16x32_bf16 v[60:63], v[96:99], a[40:43], v[60:63]
    v_mfma_f32_16x16x32_bf16 v[80:83], v[96:99], a[44:47], v[80:83]
    ds_read_b128 v[116:119], v6 offset:62464
    v_mfma_f32_16x16x32_bf16 v[64:67], v[100:103], a[40:43], v[64:67]
    v_mfma_f32_16x16x32_bf16 v[84:87], v[100:103], a[44:47], v[84:87]
    s_add_u32 m0, s38, 19456
    s_sub_u32 s31, s36, 1024
    buffer_load_dwordx4 v6, s[20:23], s31 offen lds
    s_add_u32 m0, s38, 20480
    ds_read_b128 v[120:123], v6 offset:63488
    s_waitcnt lgkmcnt(3)
    v_mfma_f32_16x16x32_bf16 v[68:71], v[104:107], a[40:43], v[68:71]
    v_mfma_f32_16x16x32_bf16 v[88:91], v[104:107], a[44:47], v[88:91]
    ds_read_b128 v[124:127], v6 offset:64512
    v_mfma_f32_16x16x32_bf16 v[72:75], v[108:111], a[40:43], v[72:75]
    v_mfma_f32_16x16x32_bf16 v[92:95], v[108:111], a[44:47], v[92:95]
    buffer_load_dwordx4 v6, s[20:23], s36 offen offset:0 lds
    ds_read_b128 v[96:99], v8 offset:0
    s_waitcnt lgkmcnt(3)
    v_mfma_f32_16x16x32_bf16 v[16:19], v[112:115], a[48:51], v[16:19]
    v_mfma_f32_16x16x32_bf16 v[36:39], v[112:115], a[52:55], v[36:39]
    ds_read_b128 v[100:103], v8 offset:1024
    v_mfma_f32_16x16x32_bf16 v[20:23], v[116:119], a[48:51], v[20:23]
    v_mfma_f32_16x16x32_bf16 v[40:43], v[116:119], a[52:55], v[40:43]
    buffer_load_dwordx4 v6, s[20:23], s36 offen offset:1024 lds
    ds_read_b128 v[104:107], v8 offset:2048
    s_waitcnt lgkmcnt(3)
    v_mfma_f32_16x16x32_bf16 v[24:27], v[120:123], a[48:51], v[24:27]
    v_mfma_f32_16x16x32_bf16 v[44:47], v[120:123], a[52:55], v[44:47]
    ds_read_b128 v[108:111], v8 offset:3072
    v_mfma_f32_16x16x32_bf16 v[28:31], v[124:127], a[48:51], v[28:31]
    v_mfma_f32_16x16x32_bf16 v[48:51], v[124:127], a[52:55], v[48:51]
    buffer_load_dwordx4 v6, s[20:23], s36 offen offset:2048 lds
    ds_read_b128 v[112:115], v8 offset:4096
    s_waitcnt lgkmcnt(3)
    v_mfma_f32_16x16x32_bf16 v[32:35], v[96:99], a[48:51], v[32:35]
    v_mfma_f32_16x16x32_bf16 v[52:55], v[96:99], a[52:55], v[52:55]
    ds_read_b128 v[116:119], v8 offset:5120
    v_mfma_f32_16x16x32_bf16 v[56:59], v[100:103], a[48:51], v[56:59]
    v_mfma_f32_16x16x32_bf16 v[76:79], v[100:103], a[52:55], v[76:79]
    buffer_load_dwordx4 v6, s[20:23], s36 offen offset:3072 lds
    s_add_u32 s36, s36, 30720
    ds_read_b128 v[120:123], v8 offset:6144
    s_waitcnt lgkmcnt(3)
    v_mfma_f32_16x16x32_bf16 v[60:63], v[104:107], a[48:51], v[60:63]
    v_mfma_f32_16x16x32_bf16 v[80:83], v[104:107], a[52:55], v[80:83]
    ds_read_b128 v[124:127], v8 offset:7168
    v_mfma_f32_16x16x32_bf16 v[64:67], v[108:111], a[48:51], v[64:67]
    v_mfma_f32_16x16x32_bf16 v[84:87], v[108:111], a[52:55], v[84:87]
    buffer_load_dwordx4 a[80:83], v6, s[20:23], s37 offen offset:0
    ds_read_b128 v[96:99], v8 offset:8192
    s_waitcnt lgkmcnt(3)
    v_mfma_f32_16x16x32_bf16 v[68:71], v[112:115], a[48:51], v[68:71]
    v_mfma_f32_16x16x32_bf16 v[88:91], v[112:115], a[52:55], v[88:91]
    ds_read_b128 v[100:103], v8 offset:9216
    v_mfma_f32_16x16x32_bf16 v[72:75], v[116:119], a[48:51], v[72:75]
    v_mfma_f32_16x16x32_bf16 v[92:95], v[116:119], a[52:55], v[92:95]
    buffer_load_dwordx4 a[84:87], v7, s[20:23], s37 offen offset:0
    ds_read_b128 v[104:107], v8 offset:10240
    s_waitcnt lgkmcnt(3)
    v_mfma_f32_16x16x32_bf16 v[16:19], v[120:123], a[56:59], v[16:19]
    v_mfma_f32_16x16x32_bf16 v[36:39], v[120:123], a[60:63], v[36:39]
    ds_read_b128 v[108:111], v8 offset:11264
    v_mfma_f32_16x16x32_bf16 v[20:23], v[124:127], a[56:59], v[20:23]
    v_mfma_f32_16x16x32_bf16 v[40:43], v[124:127], a[60:63], v[40:43]
    buffer_load_dwordx4 a[88:91], v6, s[20:23], s37 offen offset:1024
    ds_read_b128 v[112:115], v8 offset:12288
    s_waitcnt lgkmcnt(3)
    v_mfma_f32_16x16x32_bf16 v[24:27], v[96:99], a[56:59], v[24:27]
    v_mfma_f32_16x16x32_bf16 v[44:47], v[96:99], a[60:63], v[44:47]
    ds_read_b128 v[116:119], v8 offset:13312
    v_mfma_f32_16x16x32_bf16 v[28:31], v[100:103], a[56:59], v[28:31]
    v_mfma_f32_16x16x32_bf16 v[48:51], v[100:103], a[60:63], v[48:51]
    buffer_load_dwordx4 a[92:95], v7, s[20:23], s37 offen offset:1024
    s_add_u32 s37, s37, 2048
    ds_read_b128 v[120:123], v8 offset:14336
    s_waitcnt lgkmcnt(3)
    v_mfma_f32_16x16x32_bf16 v[32:35], v[104:107], a[56:59], v[32:35]
    v_mfma_f32_16x16x32_bf16 v[52:55], v[104:107], a[60:63], v[52:55]
    ds_read_b128 v[124:127], v8 offset:15360
    v_mfma_f32_16x16x32_bf16 v[56:59], v[108:111], a[56:59], v[56:59]
    v_mfma_f32_16x16x32_bf16 v[76:79], v[108:111], a[60:63], v[76:79]
    s_waitcnt vmcnt(9)
    s_barrier
    ds_read_b128 v[96:99], v6 offset:0
    s_waitcnt lgkmcnt(3)
    v_mfma_f32_16x16x32_bf16 v[60:63], v[112:115], a[56:59], v[60:63]
    v_mfma_f32_16x16x32_bf16 v[80:83], v[112:115], a[60:63], v[80:83]
    ds_read_b128 v[100:103], v6 offset:1024
    v_mfma_f32_16x16x32_bf16 v[64:67], v[116:119], a[56:59], v[64:67]
    v_mfma_f32_16x16x32_bf16 v[84:87], v[116:119], a[60:63], v[84:87]
    s_add_u32 m0, s38, 39936
    s_sub_u32 s31, s36, 1024
    buffer_load_dwordx4 v6, s[20:23], s31 offen lds
    s_add_u32 m0, s38, 40960
    ds_read_b128 v[104:107], v6 offset:2048
    s_waitcnt lgkmcnt(3)
    v_mfma_f32_16x16x32_bf16 v[68:71], v[120:123], a[56:59], v[68:71]
    v_mfma_f32_16x16x32_bf16 v[88:91], v[120:123], a[60:63], v[88:91]
    ds_read_b128 v[108:111], v6 offset:3072
    v_mfma_f32_16x16x32_bf16 v[72:75], v[124:127], a[56:59], v[72:75]
    v_mfma_f32_16x16x32_bf16 v[92:95], v[124:127], a[60:63], v[92:95]
    buffer_load_dwordx4 v6, s[20:23], s36 offen offset:0 lds
    ds_read_b128 v[112:115], v6 offset:4096
    s_waitcnt lgkmcnt(3)
    v_mfma_f32_16x16x32_bf16 v[16:19], v[96:99], a[64:67], v[16:19]
    v_mfma_f32_16x16x32_bf16 v[36:39], v[96:99], a[68:71], v[36:39]
    ds_read_b128 v[116:119], v6 offset:5120
    v_mfma_f32_16x16x32_bf16 v[20:23], v[100:103], a[64:67], v[20:23]
    v_mfma_f32_16x16x32_bf16 v[40:43], v[100:103], a[68:71], v[40:43]
    buffer_load_dwordx4 v6, s[20:23], s36 offen offset:1024 lds
    ds_read_b128 v[120:123], v6 offset:6144
    s_waitcnt lgkmcnt(3)
    v_mfma_f32_16x16x32_bf16 v[24:27], v[104:107], a[64:67], v[24:27]
    v_mfma_f32_16x16x32_bf16 v[44:47], v[104:107], a[68:71], v[44:47]
    ds_read_b128 v[124:127], v6 offset:7168
    v_mfma_f32_16x16x32_bf16 v[28:31], v[108:111], a[64:67], v[28:31]
    v_mfma_f32_16x16x32_bf16 v[48:51], v[108:111], a[68:71], v[48:51]
    buffer_load_dwordx4 v6, s[20:23], s36 offen offset:2048 lds
    ds_read_b128 v[96:99], v6 offset:8192
    s_waitcnt lgkmcnt(3)
    v_mfma_f32_16x16x32_bf16 v[32:35], v[112:115], a[64:67], v[32:35]
    v_mfma_f32_16x16x32_bf16 v[52:55], v[112:115], a[68:71], v[52:55]
    ds_read_b128 v[100:103], v6 offset:9216
    v_mfma_f32_16x16x32_bf16 v[56:59], v[116:119], a[64:67], v[56:59]
    v_mfma_f32_16x16x32_bf16 v[76:79], v[116:119], a[68:71], v[76:79]
    buffer_load_dwordx4 v6, s[20:23], s36 offen offset:3072 lds
    s_add_u32 s36, s36, 30720
    ds_read_b128 v[104:107], v6 offset:10240
    s_waitcnt lgkmcnt(3)
    v_mfma_f32_16x16x32_bf16 v[60:63], v[120:123], a[64:67], v[60:63]
    v_mfma_f32_16x16x32_bf16 v[80:83], v[120:123], a[68:71], v[80:83]
    ds_read_b128 v[108:111], v6 offset:11264
    v_mfma_f32_16x16x32_bf16 v[64:67], v[124:127], a[64:67], v[64:67]
    v_mfma_f32_16x16x32_bf16 v[84:87], v[124:127], a[68:71], v[84:87]
    buffer_load_dwordx4 a[96:99], v6, s[20:23], s37 offen offset:0
    ds_read_b128 v[112:115], v6 offset:12288
    s_waitcnt lgkmcnt(3)
    v_mfma_f32_16x16x32_bf16 v[68:71], v[96:99], a[64:67], v[68:71]
    v_mfma_f32_16x16x32_bf16 v[88:91], v[96:99], a[68:71], v[88:91]
    ds_read_b128 v[116:119], v6 offset:13312
    v_mfma_f32_16x16x32_bf16 v[72:75], v[100:103], a[64:67], v[72:75]
    v_mfma_f32_16x16x32_bf16 v[92:95], v[100:103], a[68:71], v[92:95]
    buffer_load_dwordx4 a[100:103], v7, s[20:23], s37 offen offset:0
    ds_read_b128 v[120:123], v6 offset:14336
    s_waitcnt lgkmcnt(3)
    v_mfma_f32_16x16x32_bf16 v[16:19], v[104:107], a[72:75], v[16:19]
    v_mfma_f32_16x16x32_bf16 v[36:39], v[104:107], a[76:79], v[36:39]
    ds_read_b128 v[124:127], v6 offset:15360
    v_mfma_f32_16x16x32_bf16 v[20:23], v[108:111], a[72:75], v[20:23]
    v_mfma_f32_16x16x32_bf16 v[40:43], v[108:111], a[76:79], v[40:43]
    buffer_load_dwordx4 a[104:107], v6, s[20:23], s37 offen offset:1024
    ds_read_b128 v[96:99], v6 offset:16384
    s_waitcnt lgkmcnt(3)
    v_mfma_f32_16x16x32_bf16 v[24:27], v[112:115], a[72:75], v[24:27]
    v_mfma_f32_16x16x32_bf16 v[44:47], v[112:115], a[76:79], v[44:47]
    ds_read_b128 v[100:103], v6 offset:17408
    v_mfma_f32_16x16x32_bf16 v[28:31], v[116:119], a[72:75], v[28:31]
    v_mfma_f32_16x16x32_bf16 v[48:51], v[116:119], a[76:79], v[48:51]
    buffer_load_dwordx4 a[108:111], v7, s[20:23], s37 offen offset:1024
    s_add_u32 s37, s37, 2048
    ds_read_b128 v[104:107], v6 offset:18432
    s_waitcnt lgkmcnt(3)
    v_mfma_f32_16x16x32_bf16 v[32:35], v[120:123], a[72:75], v[32:35]
    v_mfma_f32_16x16x32_bf16 v[52:55], v[120:123], a[76:79], v[52:55]
    ds_read_b128 v[108:111], v6 offset:19456
    v_mfma_f32_16x16x32_bf16 v[56:59], v[124:127], a[72:75], v[56:59]
    v_mfma_f32_16x16x32_bf16 v[76:79], v[124:127], a[76:79], v[76:79]
    s_waitcnt vmcnt(9)
    s_barrier
    ds_read_b128 v[112:115], v6 offset:20480
    s_waitcnt lgkmcnt(3)
    v_mfma_f32_16x16x32_bf16 v[60:63], v[96:99], a[72:75], v[60:63]
    v_mfma_f32_16x16x32_bf16 v[80:83], v[96:99], a[76:79], v[80:83]
    ds_read_b128 v[116:119], v6 offset:21504
    v_mfma_f32_16x16x32_bf16 v[64:67], v[100:103], a[72:75], v[64:67]
    v_mfma_f32_16x16x32_bf16 v[84:87], v[100:103], a[76:79], v[84:87]
    s_add_u32 m0, s38, 60416
    s_sub_u32 s31, s36, 1024
    buffer_load_dwordx4 v6, s[20:23], s31 offen lds
    s_add_u32 m0, s38, 61440
    ds_read_b128 v[120:123], v6 offset:22528
    s_waitcnt lgkmcnt(3)
    v_mfma_f32_16x16x32_bf16 v[68:71], v[104:107], a[72:75], v[68:71]
    v_mfma_f32_16x16x32_bf16 v[88:91], v[104:107], a[76:79], v[88:91]
    ds_read_b128 v[124:127], v6 offset:23552
    v_mfma_f32_16x16x32_bf16 v[72:75], v[108:111], a[72:75], v[72:75]
    v_mfma_f32_16x16x32_bf16 v[92:95], v[108:111], a[76:79], v[92:95]
    buffer_load_dwordx4 v6, s[20:23], s36 offen offset:0 lds
    ds_read_b128 v[96:99], v6 offset:24576
    s_waitcnt lgkmcnt(3)
    v_mfma_f32_16x16x32_bf16 v[16:19], v[112:115], a[80:83], v[16:19]
    v_mfma_f32_16x16x32_bf16 v[36:39], v[112:115], a[84:87], v[36:39]
    ds_read_b128 v[100:103], v6 offset:25600
    v_mfma_f32_16x16x32_bf16 v[20:23], v[116:119], a[80:83], v[20:23]
    v_mfma_f32_16x16x32_bf16 v[40:43], v[116:119], a[84:87], v[40:43]
    buffer_load_dwordx4 v6, s[20:23], s36 offen offset:1024 lds
    ds_read_b128 v[104:107], v6 offset:26624
    s_waitcnt lgkmcnt(3)
    v_mfma_f32_16x16x32_bf16 v[24:27], v[120:123], a[80:83], v[24:27]
    v_mfma_f32_16x16x32_bf16 v[44:47], v[120:123], a[84:87], v[44:47]
    ds_read_b128 v[108:111], v6 offset:27648
    v_mfma_f32_16x16x32_bf16 v[28:31], v[124:127], a[80:83], v[28:31]
    v_mfma_f32_16x16x32_bf16 v[48:51], v[124:127], a[84:87], v[48:51]
    buffer_load_dwordx4 v6, s[20:23], s36 offen offset:2048 lds
    ds_read_b128 v[112:115], v6 offset:28672
    s_waitcnt lgkmcnt(3)
    v_mfma_f32_16x16x32_bf16 v[32:35], v[96:99], a[80:83], v[32:35]
    v_mfma_f32_16x16x32_bf16 v[52:55], v[96:99], a[84:87], v[52:55]
    ds_read_b128 v[116:119], v6 offset:29696
    v_mfma_f32_16x16x32_bf16 v[56:59], v[100:103], a[80:83], v[56:59]
    v_mfma_f32_16x16x32_bf16 v[76:79], v[100:103], a[84:87], v[76:79]
    buffer_load_dwordx4 v6, s[20:23], s36 offen offset:3072 lds
    s_add_u32 s36, s36, 30720
    ds_read_b128 v[120:123], v6 offset:30720
    s_waitcnt lgkmcnt(3)
    v_mfma_f32_16x16x32_bf16 v[60:63], v[104:107], a[80:83], v[60:63]
    v_mfma_f32_16x16x32_bf16 v[80:83], v[104:107], a[84:87], v[80:83]
    ds_read_b128 v[124:127], v6 offset:31744
    v_mfma_f32_16x16x32_bf16 v[64:67], v[108:111], a[80:83], v[64:67]
    v_mfma_f32_16x16x32_bf16 v[84:87], v[108:111], a[84:87], v[84:87]
    buffer_load_dwordx4 a[112:115], v6, s[20:23], s37 offen offset:0
    ds_read_b128 v[96:99], v6 offset:32768
    s_waitcnt lgkmcnt(3)
    v_mfma_f32_16x16x32_bf16 v[68:71], v[112:115], a[80:83], v[68:71]
    v_mfma_f32_16x16x32_bf16 v[88:91], v[112:115], a[84:87], v[88:91]
    ds_read_b128 v[100:103], v6 offset:33792
    v_mfma_f32_16x16x32_bf16 v[72:75], v[116:119], a[80:83], v[72:75]
    v_mfma_f32_16x16x32_bf16 v[92:95], v[116:119], a[84:87], v[92:95]
    buffer_load_dwordx4 a[116:119], v7, s[20:23], s37 offen offset:0
    ds_read_b128 v[104:107], v6 offset:34816
    s_waitcnt lgkmcnt(3)
    v_mfma_f32_16x16x32_bf16 v[16:19], v[120:123], a[88:91], v[16:19]
    v_mfma_f32_16x16x32_bf16 v[36:39], v[120:123], a[92:95], v[36:39]
    ds_read_b128 v[108:111], v6 offset:35840
    v_mfma_f32_16x16x32_bf16 v[20:23], v[124:127], a[88:91], v[20:23]
    v_mfma_f32_16x16x32_bf16 v[40:43], v[124:127], a[92:95], v[40:43]
    buffer_load_dwordx4 a[120:123], v6, s[20:23], s37 offen offset:1024
    ds_read_b128 v[112:115], v6 offset:36864
    s_waitcnt lgkmcnt(3)
    v_mfma_f32_16x16x32_bf16 v[24:27], v[96:99], a[88:91], v[24:27]
    v_mfma_f32_16x16x32_bf16 v[44:47], v[96:99], a[92:95], v[44:47]
    ds_read_b128 v[116:119], v6 offset:37888
    v_mfma_f32_16x16x32_bf16 v[28:31], v[100:103], a[88:91], v[28:31]
    v_mfma_f32_16x16x32_bf16 v[48:51], v[100:103], a[92:95], v[48:51]
    buffer_load_dwordx4 a[124:127], v7, s[20:23], s37 offen offset:1024
    s_add_u32 s37, s37, 2048
    ds_read_b128 v[120:123], v6 offset:38912
    s_waitcnt lgkmcnt(3)
    v_mfma_f32_16x16x32_bf16 v[32:35], v[104:107], a[88:91], v[32:35]
    v_mfma_f32_16x16x32_bf16 v[52:55], v[104:107], a[92:95], v[52:55]
    ds_read_b128 v[124:127], v6 offset:39936
    v_mfma_f32_16x16x32_bf16 v[56:59], v[108:111], a[88:91], v[56:59]
    v_mfma_f32_16x16x32_bf16 v[76:79], v[108:111], a[92:95], v[76:79]
    s_waitcnt vmcnt(9)
    s_barrier
    ds_read_b128 v[96:99], v6 offset:40960
    s_waitcnt lgkmcnt(3)
    v_mfma_f32_16x16x32_bf16 v[60:63], v[112:115], a[88:91], v[60:63]
    v_mfma_f32_16x16x32_bf16 v[80:83], v[112:115], a[92:95], v[80:83]
    ds_read_b128 v[100:103], v6 offset:41984
    v_mfma_f32_16x16x32_bf16 v[64:67], v[116:119], a[88:91], v[64:67]
    v_mfma_f32_16x16x32_bf16 v[84:87], v[116:119], a[92:95], v[84:87]
    s_add_u32 m0, s38, -1024
    s_sub_u32 s31, s36, 1024
    buffer_load_dwordx4 v6, s[20:23], s31 offen lds
    s_add_u32 m0, s38, 0
    ds_read_b128 v[104:107], v6 offset:43008
    s_waitcnt lgkmcnt(3)
    v_mfma_f32_16x16x32_bf16 v[68:71], v[120:123], a[88:91], v[68:71]
    v_mfma_f32_16x16x32_bf16 v[88:91], v[120:123], a[92:95], v[88:91]
    ds_read_b128 v[108:111], v6 offset:44032
    v_mfma_f32_16x16x32_bf16 v[72:75], v[124:127], a[88:91], v[72:75]
    v_mfma_f32_16x16x32_bf16 v[92:95], v[124:127], a[92:95], v[92:95]
    buffer_load_dwordx4 v6, s[20:23], s36 offen offset:0 lds
    ds_read_b128 v[112:115], v6 offset:45056
    s_waitcnt lgkmcnt(3)
    v_mfma_f32_16x16x32_bf16 v[16:19], v[96:99], a[96:99], v[16:19]
    v_mfma_f32_16x16x32_bf16 v[36:39], v[96:99], a[100:103], v[36:39]
    ds_read_b128 v[116:119], v6 offset:46080
    v_mfma_f32_16x16x32_bf16 v[20:23], v[100:103], a[96:99], v[20:23]
    v_mfma_f32_16x16x32_bf16 v[40:43], v[100:103], a[100:103], v[40:43]
    buffer_load_dwordx4 v6, s[20:23], s36 offen offset:1024 lds
    ds_read_b128 v[120:123], v6 offset:47104
    s_waitcnt lgkmcnt(3)
    v_mfma_f32_16x16x32_bf16 v[24:27], v[104:107], a[96:99], v[24:27]
    v_mfma_f32_16x16x32_bf16 v[44:47], v[104:107], a[100:103], v[44:47]
    ds_read_b128 v[124:127], v6 offset:48128
    v_mfma_f32_16x16x32_bf16 v[28:31], v[108:111], a[96:99], v[28:31]
    v_mfma_f32_16x16x32_bf16 v[48:51], v[108:111], a[100:103], v[48:51]
    buffer_load_dwordx4 v6, s[20:23], s36 offen offset:2048 lds
    ds_read_b128 v[96:99], v6 offset:49152
    s_waitcnt lgkmcnt(3)
    v_mfma_f32_16x16x32_bf16 v[32:35], v[112:115], a[96:99], v[32:35]
    v_mfma_f32_16x16x32_bf16 v[52:55], v[112:115], a[100:103], v[52:55]
    ds_read_b128 v[100:103], v6 offset:50176
    v_mfma_f32_16x16x32_bf16 v[56:59], v[116:119], a[96:99], v[56:59]
    v_mfma_f32_16x16x32_bf16 v[76:79], v[116:119], a[100:103], v[76:79]
    buffer_load_dwordx4 v6, s[20:23], s36 offen offset:3072 lds
    s_add_u32 s36, s36, 30720
    ds_read_b128 v[104:107], v6 offset:51200
    s_waitcnt lgkmcnt(3)
    v_mfma_f32_16x16x32_bf16 v[60:63], v[120:123], a[96:99], v[60:63]
    v_mfma_f32_16x16x32_bf16 v[80:83], v[120:123], a[100:103], v[80:83]
    ds_read_b128 v[108:111], v6 offset:52224
    v_mfma_f32_16x16x32_bf16 v[64:67], v[124:127], a[96:99], v[64:67]
    v_mfma_f32_16x16x32_bf16 v[84:87], v[124:127], a[100:103], v[84:87]
    buffer_load_dwordx4 a[128:131], v6, s[20:23], s37 offen offset:0
    ds_read_b128 v[112:115], v6 offset:53248
    s_waitcnt lgkmcnt(3)
    v_mfma_f32_16x16x32_bf16 v[68:71], v[96:99], a[96:99], v[68:71]
    v_mfma_f32_16x16x32_bf16 v[88:91], v[96:99], a[100:103], v[88:91]
    ds_read_b128 v[116:119], v6 offset:54272
    v_mfma_f32_16x16x32_bf16 v[72:75], v[100:103], a[96:99], v[72:75]
    v_mfma_f32_16x16x32_bf16 v[92:95], v[100:103], a[100:103], v[92:95]
    buffer_load_dwordx4 a[132:135], v7, s[20:23], s37 offen offset:0
    ds_read_b128 v[120:123], v6 offset:55296
    s_waitcnt lgkmcnt(3)
    v_mfma_f32_16x16x32_bf16 v[16:19], v[104:107], a[104:107], v[16:19]
    v_mfma_f32_16x16x32_bf16 v[36:39], v[104:107], a[108:111], v[36:39]
    ds_read_b128 v[124:127], v6 offset:56320
    v_mfma_f32_16x16x32_bf16 v[20:23], v[108:111], a[104:107], v[20:23]
    v_mfma_f32_16x16x32_bf16 v[40:43], v[108:111], a[108:111], v[40:43]
    buffer_load_dwordx4 a[136:139], v6, s[20:23], s37 offen offset:1024
    ds_read_b128 v[96:99], v6 offset:57344
    s_waitcnt lgkmcnt(3)
    v_mfma_f32_16x16x32_bf16 v[24:27], v[112:115], a[104:107], v[24:27]
    v_mfma_f32_16x16x32_bf16 v[44:47], v[112:115], a[108:111], v[44:47]
    ds_read_b128 v[100:103], v6 offset:58368
    v_mfma_f32_16x16x32_bf16 v[28:31], v[116:119], a[104:107], v[28:31]
    v_mfma_f32_16x16x32_bf16 v[48:51], v[116:119], a[108:111], v[48:51]
    buffer_load_dwordx4 a[140:143], v7, s[20:23], s37 offen offset:1024
    s_add_u32 s37, s37, 2048
    ds_read_b128 v[104:107], v6 offset:59392
    s_waitcnt lgkmcnt(3)
    v_mfma_f32_16x16x32_bf16 v[32:35], v[120:123], a[104:107], v[32:35]
    v_mfma_f32_16x16x32_bf16 v[52:55], v[120:123], a[108:111], v[52:55]
    ds_read_b128 v[108:111], v6 offset:60416
    v_mfma_f32_16x16x32_bf16 v[56:59], v[124:127], a[104:107], v[56:59]
    v_mfma_f32_16x16x32_bf16 v[76:79], v[124:127], a[108:111], v[76:79]
    s_waitcnt vmcnt(9)
    s_barrier
    ds_read_b128 v[112:115], v6 offset:61440
    s_waitcnt lgkmcnt(3)
    v_mfma_f32_16x16x32_bf16 v[60:63], v[96:99], a[104:107], v[60:63]
    v_mfma_f32_16x16x32_bf16 v[80:83], v[96:99], a[108:111], v[80:83]
    ds_read_b128 v[116:119], v6 offset:62464
    v_mfma_f32_16x16x32_bf16 v[64:67], v[100:103], a[104:107], v[64:67]
    v_mfma_f32_16x16x32_bf16 v[84:87], v[100:103], a[108:111], v[84:87]
    s_add_u32 m0, s38, 19456
    s_sub_u32 s31, s36, 1024
    buffer_load_dwordx4 v6, s[20:23], s31 offen lds
    s_add_u32 m0, s38, 20480
    ds_read_b128 v[120:123], v6 offset:63488
    s_waitcnt lgkmcnt(3)
    v_mfma_f32_16x16x32_bf16 v[68:71], v[104:107], a[104:107], v[68:71]
    v_mfma_f32_16x16x32_bf16 v[88:91], v[104:107], a[108:111], v[88:91]
    ds_read_b128 v[124:127], v6 offset:64512
    v_mfma_f32_16x16x32_bf16 v[72:75], v[108:111], a[104:107], v[72:75]
    v_mfma_f32_16x16x32_bf16 v[92:95], v[108:111], a[108:111], v[92:95]
    buffer_load_dwordx4 v6, s[20:23], s36 offen offset:0 lds
    ds_read_b128 v[96:99], v8 offset:0
    s_waitcnt lgkmcnt(3)
    v_mfma_f32_16x16x32_bf16 v[16:19], v[112:115], a[112:115], v[16:19]
    v_mfma_f32_16x16x32_bf16 v[36:39], v[112:115], a[116:119], v[36:39]
    ds_read_b128 v[100:103], v8 offset:1024
    v_mfma_f32_16x16x32_bf16 v[20:23], v[116:119], a[112:115], v[20:23]
    v_mfma_f32_16x16x32_bf16 v[40:43], v[116:119], a[116:119], v[40:43]
    buffer_load_dwordx4 v6, s[20:23], s36 offen offset:1024 lds
    ds_read_b128 v[104:107], v8 offset:2048
    s_waitcnt lgkmcnt(3)
    v_mfma_f32_16x16x32_bf16 v[24:27], v[120:123], a[112:115], v[24:27]
    v_mfma_f32_16x16x32_bf16 v[44:47], v[120:123], a[116:119], v[44:47]
    ds_read_b128 v[108:111], v8 offset:3072
    v_mfma_f32_16x16x32_bf16 v[28:31], v[124:127], a[112:115], v[28:31]
    v_mfma_f32_16x16x32_bf16 v[48:51], v[124:127], a[116:119], v[48:51]
    buffer_load_dwordx4 v6, s[20:23], s36 offen offset:2048 lds
    ds_read_b128 v[112:115], v8 offset:4096
    s_waitcnt lgkmcnt(3)
    v_mfma_f32_16x16x32_bf16 v[32:35], v[96:99], a[112:115], v[32:35]
    v_mfma_f32_16x16x32_bf16 v[52:55], v[96:99], a[116:119], v[52:55]
    ds_read_b128 v[116:119], v8 offset:5120
    v_mfma_f32_16x16x32_bf16 v[56:59], v[100:103], a[112:115], v[56:59]
    v_mfma_f32_16x16x32_bf16 v[76:79], v[100:103], a[116:119], v[76:79]
    buffer_load_dwordx4 v6, s[20:23], s36 offen offset:3072 lds
    s_add_u32 s36, s36, 30720
    ds_read_b128 v[120:123], v8 offset:6144
    s_waitcnt lgkmcnt(3)
    v_mfma_f32_16x16x32_bf16 v[60:63], v[104:107], a[112:115], v[60:63]
    v_mfma_f32_16x16x32_bf16 v[80:83], v[104:107], a[116:119], v[80:83]
    ds_read_b128 v[124:127], v8 offset:7168
    v_mfma_f32_16x16x32_bf16 v[64:67], v[108:111], a[112:115], v[64:67]
    v_mfma_f32_16x16x32_bf16 v[84:87], v[108:111], a[116:119], v[84:87]
    buffer_load_dwordx4 a[144:147], v6, s[20:23], s37 offen offset:0
    ds_read_b128 v[96:99], v8 offset:8192
    s_waitcnt lgkmcnt(3)
    v_mfma_f32_16x16x32_bf16 v[68:71], v[112:115], a[112:115], v[68:71]
    v_mfma_f32_16x16x32_bf16 v[88:91], v[112:115], a[116:119], v[88:91]
    ds_read_b128 v[100:103], v8 offset:9216
    v_mfma_f32_16x16x32_bf16 v[72:75], v[116:119], a[112:115], v[72:75]
    v_mfma_f32_16x16x32_bf16 v[92:95], v[116:119], a[116:119], v[92:95]
    buffer_load_dwordx4 a[148:151], v7, s[20:23], s37 offen offset:0
    ds_read_b128 v[104:107], v8 offset:10240
    s_waitcnt lgkmcnt(3)
    v_mfma_f32_16x16x32_bf16 v[16:19], v[120:123], a[120:123], v[16:19]
    v_mfma_f32_16x16x32_bf16 v[36:39], v[120:123], a[124:127], v[36:39]
    ds_read_b128 v[108:111], v8 offset:11264
    v_mfma_f32_16x16x32_bf16 v[20:23], v[124:127], a[120:123], v[20:23]
    v_mfma_f32_16x16x32_bf16 v[40:43], v[124:127], a[124:127], v[40:43]
    buffer_load_dwordx4 a[152:155], v6, s[20:23], s37 offen offset:1024
    ds_read_b128 v[112:115], v8 offset:12288
    s_waitcnt lgkmcnt(3)
    v_mfma_f32_16x16x32_bf16 v[24:27], v[96:99], a[120:123], v[24:27]
    v_mfma_f32_16x16x32_bf16 v[44:47], v[96:99], a[124:127], v[44:47]
    ds_read_b128 v[116:119], v8 offset:13312
    v_mfma_f32_16x16x32_bf16 v[28:31], v[100:103], a[120:123], v[28:31]
    v_mfma_f32_16x16x32_bf16 v[48:51], v[100:103], a[124:127], v[48:51]
    buffer_load_dwordx4 a[156:159], v7, s[20:23], s37 offen offset:1024
    s_add_u32 s37, s37, 2048
    ds_read_b128 v[120:123], v8 offset:14336
    s_waitcnt lgkmcnt(3)
    v_mfma_f32_16x16x32_bf16 v[32:35], v[104:107], a[120:123], v[32:35]
    v_mfma_f32_16x16x32_bf16 v[52:55], v[104:107], a[124:127], v[52:55]
    ds_read_b128 v[124:127], v8 offset:15360
    v_mfma_f32_16x16x32_bf16 v[56:59], v[108:111], a[120:123], v[56:59]
    v_mfma_f32_16x16x32_bf16 v[76:79], v[108:111], a[124:127], v[76:79]
    s_waitcnt vmcnt(9)
    s_barrier
    ds_read_b128 v[96:99], v6 offset:0
    s_waitcnt lgkmcnt(3)
    v_mfma_f32_16x16x32_bf16 v[60:63], v[112:115], a[120:123], v[60:63]
    v_mfma_f32_16x16x32_bf16 v[80:83], v[112:115], a[124:127], v[80:83]
    ds_read_b128 v[100:103], v6 offset:1024
    v_mfma_f32_16x16x32_bf16 v[64:67], v[116:119], a[120:123], v[64:67]
    v_mfma_f32_16x16x32_bf16 v[84:87], v[116:119], a[124:127], v[84:87]
    s_add_u32 m0, s38, 80896
    s_sub_u32 s31, s39, 1024
    buffer_load_dwordx4 v6, s[20:23], s31 offen lds
    s_add_u32 m0, s38, 81920
    ds_read_b128 v[104:107], v6 offset:2048
    s_waitcnt lgkmcnt(3)
    v_mfma_f32_16x16x32_bf16 v[68:71], v[120:123], a[120:123], v[68:71]
    v_mfma_f32_16x16x32_bf16 v[88:91], v[120:123], a[124:127], v[88:91]
    ds_read_b128 v[108:111], v6 offset:3072
    v_mfma_f32_16x16x32_bf16 v[72:75], v[124:127], a[120:123], v[72:75]
    v_mfma_f32_16x16x32_bf16 v[92:95], v[124:127], a[124:127], v[92:95]
    buffer_load_dwordx4 v6, s[20:23], s39 offen offset:0 lds
    ds_read_b128 v[112:115], v6 offset:4096
    s_waitcnt lgkmcnt(3)
    v_mfma_f32_16x16x32_bf16 v[16:19], v[96:99], a[128:131], v[16:19]
    v_mfma_f32_16x16x32_bf16 v[36:39], v[96:99], a[132:135], v[36:39]
    ds_read_b128 v[116:119], v6 offset:5120
    v_mfma_f32_16x16x32_bf16 v[20:23], v[100:103], a[128:131], v[20:23]
    v_mfma_f32_16x16x32_bf16 v[40:43], v[100:103], a[132:135], v[40:43]
    buffer_load_dwordx4 v6, s[20:23], s39 offen offset:1024 lds
    ds_read_b128 v[120:123], v6 offset:6144
    s_waitcnt lgkmcnt(3)
    v_mfma_f32_16x16x32_bf16 v[24:27], v[104:107], a[128:131], v[24:27]
    v_mfma_f32_16x16x32_bf16 v[44:47], v[104:107], a[132:135], v[44:47]
    ds_read_b128 v[124:127], v6 offset:7168
    v_mfma_f32_16x16x32_bf16 v[28:31], v[108:111], a[128:131], v[28:31]
    v_mfma_f32_16x16x32_bf16 v[48:51], v[108:111], a[132:135], v[48:51]
    buffer_load_dwordx4 v6, s[20:23], s39 offen offset:2048 lds
    ds_read_b128 v[96:99], v6 offset:8192
    s_waitcnt lgkmcnt(3)
    v_mfma_f32_16x16x32_bf16 v[32:35], v[112:115], a[128:131], v[32:35]
    v_mfma_f32_16x16x32_bf16 v[52:55], v[112:115], a[132:135], v[52:55]
    ds_read_b128 v[100:103], v6 offset:9216
    v_mfma_f32_16x16x32_bf16 v[56:59], v[116:119], a[128:131], v[56:59]
    v_mfma_f32_16x16x32_bf16 v[76:79], v[116:119], a[132:135], v[76:79]
    buffer_load_dwordx4 v6, s[20:23], s39 offen offset:3072 lds
    s_add_u32 s39, s39, 61440
    ds_read_b128 v[104:107], v6 offset:10240
    s_waitcnt lgkmcnt(3)
    v_mfma_f32_16x16x32_bf16 v[60:63], v[120:123], a[128:131], v[60:63]
    v_mfma_f32_16x16x32_bf16 v[80:83], v[120:123], a[132:135], v[80:83]
    ds_read_b128 v[108:111], v6 offset:11264
    v_mfma_f32_16x16x32_bf16 v[64:67], v[124:127], a[128:131], v[64:67]
    v_mfma_f32_16x16x32_bf16 v[84:87], v[124:127], a[132:135], v[84:87]
    s_add_u32 m0, s38, 101376
    s_sub_u32 s31, s39, 1024
    buffer_load_dwordx4 v6, s[20:23], s31 offen lds
    s_add_u32 m0, s38, 102400
    ds_read_b128 v[112:115], v6 offset:12288
    s_waitcnt lgkmcnt(3)
    v_mfma_f32_16x16x32_bf16 v[68:71], v[96:99], a[128:131], v[68:71]
    v_mfma_f32_16x16x32_bf16 v[88:91], v[96:99], a[132:135], v[88:91]
    ds_read_b128 v[116:119], v6 offset:13312
    v_mfma_f32_16x16x32_bf16 v[72:75], v[100:103], a[128:131], v[72:75]
    v_mfma_f32_16x16x32_bf16 v[92:95], v[100:103], a[132:135], v[92:95]
    buffer_load_dwordx4 v6, s[20:23], s39 offen offset:0 lds
    ds_read_b128 v[120:123], v6 offset:14336
    s_waitcnt lgkmcnt(3)
    v_mfma_f32_16x16x32_bf16 v[16:19], v[104:107], a[136:139], v[16:19]
    v_mfma_f32_16x16x32_bf16 v[36:39], v[104:107], a[140:143], v[36:39]
    ds_read_b128 v[124:127], v6 offset:15360
    v_mfma_f32_16x16x32_bf16 v[20:23], v[108:111], a[136:139], v[20:23]
    v_mfma_f32_16x16x32_bf16 v[40:43], v[108:111], a[140:143], v[40:43]
    buffer_load_dwordx4 v6, s[20:23], s39 offen offset:1024 lds
    ds_read_b128 v[96:99], v6 offset:16384
    s_waitcnt lgkmcnt(3)
    v_mfma_f32_16x16x32_bf16 v[24:27], v[112:115], a[136:139], v[24:27]
    v_mfma_f32_16x16x32_bf16 v[44:47], v[112:115], a[140:143], v[44:47]
    ds_read_b128 v[100:103], v6 offset:17408
    v_mfma_f32_16x16x32_bf16 v[28:31], v[116:119], a[136:139], v[28:31]
    v_mfma_f32_16x16x32_bf16 v[48:51], v[116:119], a[140:143], v[48:51]
    buffer_load_dwordx4 v6, s[20:23], s39 offen offset:2048 lds
    ds_read_b128 v[104:107], v6 offset:18432
    s_waitcnt lgkmcnt(3)
    v_mfma_f32_16x16x32_bf16 v[32:35], v[120:123], a[136:139], v[32:35]
    v_mfma_f32_16x16x32_bf16 v[52:55], v[120:123], a[140:143], v[52:55]
    ds_read_b128 v[108:111], v6 offset:19456
    v_mfma_f32_16x16x32_bf16 v[56:59], v[124:127], a[136:139], v[56:59]
    v_mfma_f32_16x16x32_bf16 v[76:79], v[124:127], a[140:143], v[76:79]
    buffer_load_dwordx4 v6, s[20:23], s39 offen offset:3072 lds
    s_add_u32 s39, s39, 61440
    s_waitcnt vmcnt(10)
    s_barrier
    ds_read_b128 v[112:115], v6 offset:20480
    s_waitcnt lgkmcnt(3)
    v_mfma_f32_16x16x32_bf16 v[60:63], v[96:99], a[136:139], v[60:63]
    v_mfma_f32_16x16x32_bf16 v[80:83], v[96:99], a[140:143], v[80:83]
    ds_read_b128 v[116:119], v6 offset:21504
    v_mfma_f32_16x16x32_bf16 v[64:67], v[100:103], a[136:139], v[64:67]
    v_mfma_f32_16x16x32_bf16 v[84:87], v[100:103], a[140:143], v[84:87]
    s_add_u32 m0, s38, 121856
    s_sub_u32 s31, s39, 1024
    buffer_load_dwordx4 v6, s[20:23], s31 offen lds
    s_add_u32 m0, s38, 122880
    ds_read_b128 v[120:123], v6 offset:22528
    s_waitcnt lgkmcnt(3)
    v_mfma_f32_16x16x32_bf16 v[68:71], v[104:107], a[136:139], v[68:71]
    v_mfma_f32_16x16x32_bf16 v[88:91], v[104:107], a[140:143], v[88:91]
    ds_read_b128 v[124:127], v6 offset:23552
    v_mfma_f32_16x16x32_bf16 v[72:75], v[108:111], a[136:139], v[72:75]
    v_mfma_f32_16x16x32_bf16 v[92:95], v[108:111], a[140:143], v[92:95]
    buffer_load_dwordx4 v6, s[20:23], s39 offen offset:0 lds
    ds_read_b128 v[96:99], v6 offset:24576
    s_waitcnt lgkmcnt(3)
    v_mfma_f32_16x16x32_bf16 v[16:19], v[112:115], a[144:147], v[16:19]
    v_mfma_f32_16x16x32_bf16 v[36:39], v[112:115], a[148:151], v[36:39]
    ds_read_b128 v[100:103], v6 offset:25600
    v_mfma_f32_16x16x32_bf16 v[20:23], v[116:119], a[144:147], v[20:23]
    v_mfma_f32_16x16x32_bf16 v[40:43], v[116:119], a[148:151], v[40:43]
    buffer_load_dwordx4 v6, s[20:23], s39 offen offset:1024 lds
    ds_read_b128 v[104:107], v6 offset:26624
    s_waitcnt lgkmcnt(3)
    v_mfma_f32_16x16x32_bf16 v[24:27], v[120:123], a[144:147], v[24:27]
    v_mfma_f32_16x16x32_bf16 v[44:47], v[120:123], a[148:151], v[44:47]
    ds_read_b128 v[108:111], v6 offset:27648
    v_mfma_f32_16x16x32_bf16 v[28:31], v[124:127], a[144:147], v[28:31]
    v_mfma_f32_16x16x32_bf16 v[48:51], v[124:127], a[148:151], v[48:51]
    buffer_load_dwordx4 v6, s[20:23], s39 offen offset:2048 lds
    ds_read_b128 v[112:115], v6 offset:28672
    s_waitcnt lgkmcnt(3)
    v_mfma_f32_16x16x32_bf16 v[32:35], v[96:99], a[144:147], v[32:35]
    v_mfma_f32_16x16x32_bf16 v[52:55], v[96:99], a[148:151], v[52:55]
    ds_read_b128 v[116:119], v6 offset:29696
    v_mfma_f32_16x16x32_bf16 v[56:59], v[100:103], a[144:147], v[56:59]
    v_mfma_f32_16x16x32_bf16 v[76:79], v[100:103], a[148:151], v[76:79]
    buffer_load_dwordx4 v6, s[20:23], s39 offen offset:3072 lds
    s_add_u32 s39, s39, 61440
    ds_read_b128 v[120:123], v6 offset:30720
    s_waitcnt lgkmcnt(3)
    v_mfma_f32_16x16x32_bf16 v[60:63], v[104:107], a[144:147], v[60:63]
    v_mfma_f32_16x16x32_bf16 v[80:83], v[104:107], a[148:151], v[80:83]
    ds_read_b128 v[124:127], v6 offset:31744
    v_mfma_f32_16x16x32_bf16 v[64:67], v[108:111], a[144:147], v[64:67]
    v_mfma_f32_16x16x32_bf16 v[84:87], v[108:111], a[148:151], v[84:87]
    s_add_u32 m0, s38, 142336
    s_sub_u32 s31, s39, 1024
    buffer_load_dwordx4 v6, s[20:23], s31 offen lds
    s_add_u32 m0, s38, 143360
    ds_read_b128 v[96:99], v6 offset:32768
    s_waitcnt lgkmcnt(3)
    v_mfma_f32_16x16x32_bf16 v[68:71], v[112:115], a[144:147], v[68:71]
    v_mfma_f32_16x16x32_bf16 v[88:91], v[112:115], a[148:151], v[88:91]
    ds_read_b128 v[100:103], v6 offset:33792
    v_mfma_f32_16x16x32_bf16 v[72:75], v[116:119], a[144:147], v[72:75]
    v_mfma_f32_16x16x32_bf16 v[92:95], v[116:119], a[148:151], v[92:95]
    buffer_load_dwordx4 v6, s[20:23], s39 offen offset:0 lds
    ds_read_b128 v[104:107], v6 offset:34816
    s_waitcnt lgkmcnt(3)
    v_mfma_f32_16x16x32_bf16 v[16:19], v[120:123], a[152:155], v[16:19]
    v_mfma_f32_16x16x32_bf16 v[36:39], v[120:123], a[156:159], v[36:39]
    ds_read_b128 v[108:111], v6 offset:35840
    v_mfma_f32_16x16x32_bf16 v[20:23], v[124:127], a[152:155], v[20:23]
    v_mfma_f32_16x16x32_bf16 v[40:43], v[124:127], a[156:159], v[40:43]
    buffer_load_dwordx4 v6, s[20:23], s39 offen offset:1024 lds
    ds_read_b128 v[112:115], v6 offset:36864
    s_waitcnt lgkmcnt(3)
    v_mfma_f32_16x16x32_bf16 v[24:27], v[96:99], a[152:155], v[24:27]
    v_mfma_f32_16x16x32_bf16 v[44:47], v[96:99], a[156:159], v[44:47]
    ds_read_b128 v[116:119], v6 offset:37888
    v_mfma_f32_16x16x32_bf16 v[28:31], v[100:103], a[152:155], v[28:31]
    v_mfma_f32_16x16x32_bf16 v[48:51], v[100:103], a[156:159], v[48:51]
    buffer_load_dwordx4 v6, s[20:23], s39 offen offset:2048 lds
    ds_read_b128 v[120:123], v6 offset:38912
    s_waitcnt lgkmcnt(3)
    v_mfma_f32_16x16x32_bf16 v[32:35], v[104:107], a[152:155], v[32:35]
    v_mfma_f32_16x16x32_bf16 v[52:55], v[104:107], a[156:159], v[52:55]
    ds_read_b128 v[124:127], v6 offset:39936
    v_mfma_f32_16x16x32_bf16 v[56:59], v[108:111], a[152:155], v[56:59]
    v_mfma_f32_16x16x32_bf16 v[76:79], v[108:111], a[156:159], v[76:79]
    buffer_load_dwordx4 v6, s[20:23], s39 offen offset:3072 lds
    s_add_u32 s39, s39, 61440
    s_waitcnt lgkmcnt(2)
    v_mfma_f32_16x16x32_bf16 v[60:63], v[112:115], a[152:155], v[60:63]
    v_mfma_f32_16x16x32_bf16 v[80:83], v[112:115], a[156:159], v[80:83]
    v_mfma_f32_16x16x32_bf16 v[64:67], v[116:119], a[152:155], v[64:67]
    v_mfma_f32_16x16x32_bf16 v[84:87], v[116:119], a[156:159], v[84:87]
    s_waitcnt lgkmcnt(0)
    v_mfma_f32_16x16x32_bf16 v[68:71], v[120:123], a[152:155], v[68:71]
    v_mfma_f32_16x16x32_bf16 v[88:91], v[120:123], a[156:159], v[88:91]
    v_mfma_f32_16x16x32_bf16 v[72:75], v[124:127], a[152:155], v[72:75]
    v_mfma_f32_16x16x32_bf16 v[92:95], v[124:127], a[156:159], v[92:95]
    v_lshrrev_b32 v4, 5, v1
    v_lshlrev_b32 v4, 12, v4
    v_and_b32 v5, 31, v1
    v_lshl_add_u32 v4, v5, 4, v4
    s_mul_i32 s29, s26, 54
    s_mul_i32 s30, s24, 14
    s_add_u32 s29, s29, s30
    s_lshl_b32 s29, s29, 12
    s_lshl_b32 s30, s25, 9
    s_add_u32 s29, s29, s30
    buffer_load_dwordx4 a[160:163], v4, s[12:15], s29 offen
    s_add_u32 s29, s29, 8192
    buffer_load_dwordx4 a[160:163], v4, s[12:15], s29 offen
    s_add_u32 s29, s29, 8192
    buffer_load_dwordx4 a[160:163], v4, s[12:15], s29 offen
    s_add_u32 s29, s29, 8192
    buffer_load_dwordx4 a[160:163], v4, s[12:15], s29 offen
    s_add_u32 s29, s29, 8192
    buffer_load_dwordx4 a[160:163], v4, s[12:15], s29 offen
    s_add_u32 s29, s29, 8192
    buffer_load_dwordx4 a[160:163], v4, s[12:15], s29 offen
    s_add_u32 s29, s29, 8192
    buffer_load_dwordx4 a[160:163], v4, s[12:15], s29 offen
    s_add_u32 s29, s29, 8192
    s_mul_i32 s29, s24, 4608
    v_mul_u32_u24 v4, 18432, v2
    v_mul_u32_u24 v5, 144, v3
    v_add3_u32 v4, v4, v5, s29
    v_cvt_pk_bf16_f32 v96, v56, v57
    v_cvt_pk_bf16_f32 v97, v58, v59
    v_cvt_pk_bf16_f32 v98, v60, v61
    v_cvt_pk_bf16_f32 v99, v62, v63
    v_cvt_pk_bf16_f32 v100, v64, v65
    v_cvt_pk_bf16_f32 v101, v66, v67
    v_cvt_pk_bf16_f32 v102, v68, v69
    v_cvt_pk_bf16_f32 v103, v70, v71
    v_cvt_pk_bf16_f32 v104, v72, v73
    v_cvt_pk_bf16_f32 v105, v74, v75
    v_mov_b32 v106, 0x3f80
    v_mov_b32 v107, 0
    v_cvt_pk_bf16_f32 v108, v76, v77
    v_cvt_pk_bf16_f32 v109, v78, v79
    v_cvt_pk_bf16_f32 v110, v80, v81
    v_cvt_pk_bf16_f32 v111, v82, v83
    v_cvt_pk_bf16_f32 v112, v84, v85
    v_cvt_pk_bf16_f32 v113, v86, v87
    v_cvt_pk_bf16_f32 v114, v88, v89
    v_cvt_pk_bf16_f32 v115, v90, v91
    v_cvt_pk_bf16_f32 v116, v92, v93
    v_cvt_pk_bf16_f32 v117, v94, v95
    v_mov_b32 v118, 0x3f80
    v_mov_b32 v119, 0
    s_barrier
    ds_write_b128 v4, v[96:99] offset:80
    ds_write_b128 v4, v[100:103] offset:96
    ds_write_b128 v4, v[104:107] offset:112
    ds_write_b128 v4, v[108:111] offset:2384
    ds_write_b128 v4, v[112:115] offset:2400
    ds_write_b128 v4, v[116:119] offset:2416
    s_swappc_b64 s[44:45], s[42:43]
    s_swappc_b64 s[44:45], s[46:47]
    s_swappc_b64 s[44:45], s[48:49]
    ds_write_b128 v4, v[208:211] offset:0
    ds_write_b128 v4, v[212:215] offset:16
    ds_write_b128 v4, v[216:219] offset:32
    ds_write_b128 v4, v[220:223] offset:48
    ds_write_b128 v4, v[224:227] offset:64
    ds_write_b128 v4, v[228:231] offset:2304
    ds_write_b128 v4, v[232:235] offset:2320
    ds_write_b128 v4, v[236:239] offset:2336
    ds_write_b128 v4, v[240:243] offset:2352
    ds_write_b128 v4, v[244:247] offset:2368
    s_mul_i32 s29, s24, 18432
    v_lshrrev_b32 v4, 2, v1
    v_mul_u32_u24 v4, 144, v4
    v_and_b32 v5, 3, v3
    v_lshlrev_b32 v5, 3, v5
    v_add3_u32 v4, v4, v5, s29
    s_mul_i32 s29, s24, 12288
    s_add_u32 s29, s29, 20480
    v_mul_u32_u24 v5, 160, v3
    v_lshl_add_u32 v5, v2, 4, v5
    v_add_u32 v5, s29, v5
    v_add_u32 v10, 5632, v5
    v_cmp_gt_u32 vcc, 2, v2
    s_nop 1
    v_cndmask_b32 v10, v10, v5, vcc
    v_lshlrev_b32 v11, 2, v1
    v_add_u32 v12, s29, v11
    s_lshl_b32 s30, s28, 2
    s_add_u32 s30, s30, s24
    s_mul_i32 s37, s30, 3584
    s_add_u32 s37, s37, 7864320
    v_mov_b32 v13, 2130706432
    v_cmp_gt_u32 vcc, 8, v1
    s_nop 1
    v_cndmask_b32 v13, v13, v11, vcc
    v_add_u32 v8, 65536, v6
    v_add_u32 v9, 131072, v6
    s_waitcnt vmcnt(7)
    s_waitcnt lgkmcnt(0)
    s_barrier
    ds_read_b64_tr_b16 v[128:129], v4 offset:0
    ds_read_b64_tr_b16 v[130:131], v4 offset:2304
    ds_read_b64_tr_b16 v[132:133], v4 offset:32
    ds_read_b64_tr_b16 v[134:135], v4 offset:2336
    ds_read_b64_tr_b16 v[136:137], v4 offset:64
    ds_read_b64_tr_b16 v[138:139], v4 offset:2368
    ds_read_b64_tr_b16 v[140:141], v4 offset:80
    ds_read_b64_tr_b16 v[142:143], v4 offset:2384
    ds_read_b64_tr_b16 v[144:145], v4 offset:112
    ds_read_b64_tr_b16 v[146:147], v4 offset:2416
    ds_read_b64_tr_b16 v[148:149], v4 offset:4608
    ds_read_b64_tr_b16 v[150:151], v4 offset:6912
    ds_read_b64_tr_b16 v[152:153], v4 offset:4640
    ds_read_b64_tr_b16 v[154:155], v4 offset:6944
    ds_read_b64_tr_b16 v[156:157], v4 offset:4672
    ds_read_b64_tr_b16 v[158:159], v4 offset:6976
    ds_read_b64_tr_b16 v[160:161], v4 offset:4688
    ds_read_b64_tr_b16 v[162:163], v4 offset:6992
    ds_read_b64_tr_b16 v[164:165], v4 offset:4720
    ds_read_b64_tr_b16 v[166:167], v4 offset:7024
    s_waitcnt lgkmcnt(10)
    v_mfma_f32_16x16x32_bf16 v[56:59], v[128:131], v[140:143], 0
    v_mfma_f32_16x16x32_bf16 v[60:63], v[128:131], v[144:147], 0
    v_mfma_f32_16x16x32_bf16 v[64:67], v[132:135], v[140:143], 0
    v_mfma_f32_16x16x32_bf16 v[68:71], v[132:135], v[144:147], 0
    v_mfma_f32_16x16x32_bf16 v[72:75], v[136:139], v[140:143], 0
    v_mfma_f32_16x16x32_bf16 v[76:79], v[136:139], v[144:147], 0
    ds_read_b64_tr_b16 v[168:169], v4 offset:9216
    ds_read_b64_tr_b16 v[170:171], v4 offset:11520
    ds_read_b64_tr_b16 v[172:173], v4 offset:9248
    ds_read_b64_tr_b16 v[174:175], v4 offset:11552
    ds_read_b64_tr_b16 v[176:177], v4 offset:9280
    ds_read_b64_tr_b16 v[178:179], v4 offset:11584
    ds_read_b64_tr_b16 v[180:181], v4 offset:9296
    ds_read_b64_tr_b16 v[182:183], v4 offset:11600
    ds_read_b64_tr_b16 v[184:185], v4 offset:9328
    ds_read_b64_tr_b16 v[186:187], v4 offset:11632
    s_waitcnt lgkmcnt(10)
    v_mfma_f32_16x16x32_bf16 v[56:59], v[148:151], v[160:163], v[56:59]
    v_mfma_f32_16x16x32_bf16 v[60:63], v[148:151], v[164:167], v[60:63]
    v_mfma_f32_16x16x32_bf16 v[64:67], v[152:155], v[160:163], v[64:67]
    v_mfma_f32_16x16x32_bf16 v[68:71], v[152:155], v[164:167], v[68:71]
    v_mfma_f32_16x16x32_bf16 v[72:75], v[156:159], v[160:163], v[72:75]
    v_mfma_f32_16x16x32_bf16 v[76:79], v[156:159], v[164:167], v[76:79]
    ds_read_b64_tr_b16 v[188:189], v4 offset:13824
    ds_read_b64_tr_b16 v[190:191], v4 offset:16128
    ds_read_b64_tr_b16 v[192:193], v4 offset:13856
    ds_read_b64_tr_b16 v[194:195], v4 offset:16160
    ds_read_b64_tr_b16 v[196:197], v4 offset:13888
    ds_read_b64_tr_b16 v[198:199], v4 offset:16192
    ds_read_b64_tr_b16 v[200:201], v4 offset:13904
    ds_read_b64_tr_b16 v[202:203], v4 offset:16208
    ds_read_b64_tr_b16 v[204:205], v4 offset:13936
    ds_read_b64_tr_b16 v[206:207], v4 offset:16240
    s_waitcnt lgkmcnt(10)
    v_mfma_f32_16x16x32_bf16 v[56:59], v[168:171], v[180:183], v[56:59]
    v_mfma_f32_16x16x32_bf16 v[60:63], v[168:171], v[184:187], v[60:63]
    v_mfma_f32_16x16x32_bf16 v[64:67], v[172:175], v[180:183], v[64:67]
    v_mfma_f32_16x16x32_bf16 v[68:71], v[172:175], v[184:187], v[68:71]
    v_mfma_f32_16x16x32_bf16 v[72:75], v[176:179], v[180:183], v[72:75]
    v_mfma_f32_16x16x32_bf16 v[76:79], v[176:179], v[184:187], v[76:79]
    s_waitcnt lgkmcnt(0)
    s_barrier
    v_mfma_f32_16x16x32_bf16 v[56:59], v[188:191], v[200:203], v[56:59]
    v_mfma_f32_16x16x32_bf16 v[60:63], v[188:191], v[204:207], v[60:63]
    v_mfma_f32_16x16x32_bf16 v[64:67], v[192:195], v[200:203], v[64:67]
    v_mfma_f32_16x16x32_bf16 v[68:71], v[192:195], v[204:207], v[68:71]
    v_mfma_f32_16x16x32_bf16 v[72:75], v[196:199], v[200:203], v[72:75]
    v_mfma_f32_16x16x32_bf16 v[76:79], v[196:199], v[204:207], v[76:79]
    ds_read_b128 v[96:99], v8 offset:16384
    ds_read_b128 v[100:103], v8 offset:17408
    ds_read_b128 v[104:107], v8 offset:18432
    ds_read_b128 v[108:111], v8 offset:19456
    ds_read_b128 v[112:115], v8 offset:20480
    s_waitcnt lgkmcnt(3)
    v_mfma_f32_16x16x32_bf16 v[16:19], v[96:99], a[0:3], 0
    v_mfma_f32_16x16x32_bf16 v[36:39], v[96:99], a[4:7], 0
    ds_write_b128 v5, v[56:59] offset:0
    ds_write_b128 v5, v[60:63] offset:2560
    ds_write_b128 v5, v[64:67] offset:64
    ds_write_b128 v5, v[68:71] offset:2624
    ds_write_b128 v10, v[72:75] offset:128
    ds_write_b128 v10, v[76:79] offset:2688
    ds_read_b128 v[116:119], v8 offset:21504
    v_mfma_f32_16x16x32_bf16 v[20:23], v[100:103], a[0:3], 0
    v_mfma_f32_16x16x32_bf16 v[40:43], v[100:103], a[4:7], 0
    ds_read_b32 v128, v12 offset:0
    ds_read_b32 v129, v12 offset:256
    ds_read_b32 v130, v12 offset:512
    ds_read_b32 v131, v12 offset:768
    ds_read_b32 v132, v12 offset:1024
    ds_read_b32 v133, v12 offset:1280
    ds_read_b32 v134, v12 offset:1536
    ds_read_b128 v[120:123], v8 offset:22528
    s_waitcnt lgkmcnt(15)
    v_mfma_f32_16x16x32_bf16 v[24:27], v[104:107], a[0:3], 0
    v_mfma_f32_16x16x32_bf16 v[44:47], v[104:107], a[4:7], 0
    ds_read_b32 v135, v12 offset:1792
    ds_read_b32 v136, v12 offset:2048
    ds_read_b32 v137, v12 offset:2304
    ds_read_b32 v138, v12 offset:2560
    ds_read_b32 v139, v12 offset:2816
    ds_read_b32 v140, v12 offset:3072
    ds_read_b32 v141, v12 offset:3328
    ds_read_b128 v[124:127], v8 offset:23552
    v_mfma_f32_16x16x32_bf16 v[28:31], v[108:111], a[0:3], 0
    v_mfma_f32_16x16x32_bf16 v[48:51], v[108:111], a[4:7], 0
    s_add_u32 m0, s38, -1024
    s_sub_u32 s31, s39, 1024
    buffer_load_dwordx4 v6, s[20:23], s31 offen lds
    s_add_u32 m0, s38, 0
    s_nop 0
    buffer_load_dwordx4 v6, s[20:23], s39 offen offset:0 lds
    buffer_load_dwordx4 v6, s[20:23], s39 offen offset:1024 lds
    buffer_load_dwordx4 v6, s[20:23], s39 offen offset:2048 lds
    buffer_load_dwordx4 v6, s[20:23], s39 offen offset:3072 lds
    s_add_u32 s39, s39, 61440
    ds_read_b128 v[96:99], v8 offset:24576
    s_waitcnt lgkmcnt(15)
    v_mfma_f32_16x16x32_bf16 v[32:35], v[112:115], a[0:3], 0
    v_mfma_f32_16x16x32_bf16 v[52:55], v[112:115], a[4:7], 0
    s_waitcnt lgkmcnt(2)
    buffer_atomic_add_f32 v128, v11, s[20:23], s37 offen offset:0
    ds_read_b128 v[100:103], v8 offset:25600
    v_mfma_f32_16x16x32_bf16 v[16:19], v[116:119], a[8:11], v[16:19]
    v_mfma_f32_16x16x32_bf16 v[36:39], v[116:119], a[12:15], v[36:39]
    buffer_atomic_add_f32 v129, v11, s[20:23], s37 offen offset:256
    ds_read_b128 v[104:107], v8 offset:26624
    s_waitcnt lgkmcnt(3)
    v_mfma_f32_16x16x32_bf16 v[20:23], v[120:123], a[8:11], v[20:23]
    v_mfma_f32_16x16x32_bf16 v[40:43], v[120:123], a[12:15], v[40:43]
    buffer_atomic_add_f32 v130, v11, s[20:23], s37 offen offset:512
    ds_read_b128 v[108:111], v8 offset:27648
    v_mfma_f32_16x16x32_bf16 v[24:27], v[124:127], a[8:11], v[24:27]
    v_mfma_f32_16x16x32_bf16 v[44:47], v[124:127], a[12:15], v[44:47]
    buffer_atomic_add_f32 v131, v11, s[20:23], s37 offen offset:768
    ds_read_b128 v[112:115], v8 offset:28672
    s_waitcnt lgkmcnt(3)
    v_mfma_f32_16x16x32_bf16 v[28:31], v[96:99], a[8:11], v[28:31]
    v_mfma_f32_16x16x32_bf16 v[48:51], v[96:99], a[12:15], v[48:51]
    buffer_atomic_add_f32 v132, v11, s[20:23], s37 offen offset:1024
    ds_read_b128 v[116:119], v8 offset:29696
    v_mfma_f32_16x16x32_bf16 v[32:35], v[100:103], a[8:11], v[32:35]
    v_mfma_f32_16x16x32_bf16 v[52:55], v[100:103], a[12:15], v[52:55]
    buffer_atomic_add_f32 v133, v11, s[20:23], s37 offen offset:1280
    ds_read_b128 v[120:123], v8 offset:30720
    s_waitcnt lgkmcnt(3)
    v_mfma_f32_16x16x32_bf16 v[16:19], v[104:107], a[16:19], v[16:19]
    v_mfma_f32_16x16x32_bf16 v[36:39], v[104:107], a[20:23], v[36:39]
    buffer_atomic_add_f32 v134, v11, s[20:23], s37 offen offset:1536
    ds_read_b128 v[124:127], v8 offset:31744
    v_mfma_f32_16x16x32_bf16 v[20:23], v[108:111], a[16:19], v[20:23]
    v_mfma_f32_16x16x32_bf16 v[40:43], v[108:111], a[20:23], v[40:43]
    buffer_atomic_add_f32 v135, v11, s[20:23], s37 offen offset:1792
    ds_read_b128 v[96:99], v8 offset:32768
    s_waitcnt lgkmcnt(3)
    v_mfma_f32_16x16x32_bf16 v[24:27], v[112:115], a[16:19], v[24:27]
    v_mfma_f32_16x16x32_bf16 v[44:47], v[112:115], a[20:23], v[44:47]
    buffer_atomic_add_f32 v136, v11, s[20:23], s37 offen offset:2048
    ds_read_b128 v[100:103], v8 offset:33792
    v_mfma_f32_16x16x32_bf16 v[28:31], v[116:119], a[16:19], v[28:31]
    v_mfma_f32_16x16x32_bf16 v[48:51], v[116:119], a[20:23], v[48:51]
    buffer_atomic_add_f32 v137, v11, s[20:23], s37 offen offset:2304
    ds_read_b128 v[104:107], v8 offset:34816
    s_waitcnt lgkmcnt(3)
    v_mfma_f32_16x16x32_bf16 v[32:35], v[120:123], a[16:19], v[32:35]
    v_mfma_f32_16x16x32_bf16 v[52:55], v[120:123], a[20:23], v[52:55]
    buffer_atomic_add_f32 v138, v11, s[20:23], s37 offen offset:2560
    ds_read_b128 v[108:111], v8 offset:35840
    v_mfma_f32_16x16x32_bf16 v[16:19], v[124:127], a[24:27], v[16:19]
    v_mfma_f32_16x16x32_bf16 v[36:39], v[124:127], a[28:31], v[36:39]
    buffer_atomic_add_f32 v139, v11, s[20:23], s37 offen offset:2816
    ds_read_b128 v[112:115], v8 offset:36864
    s_waitcnt lgkmcnt(3)
    v_mfma_f32_16x16x32_bf16 v[20:23], v[96:99], a[24:27], v[20:23]
    v_mfma_f32_16x16x32_bf16 v[40:43], v[96:99], a[28:31], v[40:43]
    buffer_atomic_add_f32 v140, v11, s[20:23], s37 offen offset:3072
    ds_read_b128 v[116:119], v8 offset:37888
    v_mfma_f32_16x16x32_bf16 v[24:27], v[100:103], a[24:27], v[24:27]
    v_mfma_f32_16x16x32_bf16 v[44:47], v[100:103], a[28:31], v[44:47]
    buffer_atomic_add_f32 v141, v13, s[20:23], s37 offen offset:3328
    ds_read_b128 v[120:123], v8 offset:38912
    s_waitcnt lgkmcnt(3)
    v_mfma_f32_16x16x32_bf16 v[28:31], v[104:107], a[24:27], v[28:31]
    v_mfma_f32_16x16x32_bf16 v[48:51], v[104:107], a[28:31], v[48:51]
    s_lshl_b32 s31, s27, 1
    s_lshr_b32 s30, s24, 1
    ds_read_b128 v[124:127], v8 offset:39936
    v_mfma_f32_16x16x32_bf16 v[32:35], v[108:111], a[24:27], v[32:35]
    v_mfma_f32_16x16x32_bf16 v[52:55], v[108:111], a[28:31], v[52:55]
    s_add_u32 s31, s31, s30
    s_mul_i32 s31, s31, 81920
    ds_read_b128 v[96:99], v8 offset:40960
    s_waitcnt lgkmcnt(3)
    v_mfma_f32_16x16x32_bf16 v[16:19], v[112:115], a[32:35], v[16:19]
    v_mfma_f32_16x16x32_bf16 v[36:39], v[112:115], a[36:39], v[36:39]
    s_and_b32 s30, s24, 1
    s_lshl_b32 s30, s30, 11
    ds_read_b128 v[100:103], v8 offset:41984
    v_mfma_f32_16x16x32_bf16 v[20:23], v[116:119], a[32:35], v[20:23]
    v_mfma_f32_16x16x32_bf16 v[40:43], v[116:119], a[36:39], v[40:43]
    s_add_u32 s31, s31, s30
    s_add_u32 s31, s31, 13520896
    ds_read_b128 v[104:107], v8 offset:43008
    s_waitcnt lgkmcnt(3)
    v_mfma_f32_16x16x32_bf16 v[24:27], v[120:123], a[32:35], v[24:27]
    v_mfma_f32_16x16x32_bf16 v[44:47], v[120:123], a[36:39], v[44:47]
    s_lshl_b32 s30, s28, 12
    s_add_u32 s72, s31, s30
    ds_read_b128 v[108:111], v8 offset:44032
    v_mfma_f32_16x16x32_bf16 v[28:31], v[124:127], a[32:35], v[28:31]
    v_mfma_f32_16x16x32_bf16 v[48:51], v[124:127], a[36:39], v[48:51]
    s_add_u32 s73, s72, 32768
    s_lshr_b32 s30, s28, 1
    ds_read_b128 v[112:115], v8 offset:45056
    s_waitcnt lgkmcnt(3)
    v_mfma_f32_16x16x32_bf16 v[32:35], v[96:99], a[32:35], v[32:35]
    v_mfma_f32_16x16x32_bf16 v[52:55], v[96:99], a[36:39], v[52:55]
    s_lshl_b32 s30, s30, 12
    s_add_u32 s84, s31, s30
    ds_read_b128 v[116:119], v8 offset:46080
    v_mfma_f32_16x16x32_bf16 v[16:19], v[100:103], a[40:43], v[16:19]
    v_mfma_f32_16x16x32_bf16 v[36:39], v[100:103], a[44:47], v[36:39]
    s_and_b32 s30, s28, 1
    s_lshl_b32 s30, s30, 9
    ds_read_b128 v[120:123], v8 offset:47104
    s_waitcnt lgkmcnt(3)
    v_mfma_f32_16x16x32_bf16 v[20:23], v[104:107], a[40:43], v[20:23]
    v_mfma_f32_16x16x32_bf16 v[40:43], v[104:107], a[44:47], v[40:43]
    s_add_u32 s84, s84, s30
    s_add_u32 s84, s84, 65536
    ds_read_b128 v[124:127], v8 offset:48128
    v_mfma_f32_16x16x32_bf16 v[24:27], v[108:111], a[40:43], v[24:27]
    v_mfma_f32_16x16x32_bf16 v[44:47], v[108:111], a[44:47], v[44:47]
    ds_read_b128 v[96:99], v8 offset:49152
    s_waitcnt lgkmcnt(3)
    v_mfma_f32_16x16x32_bf16 v[28:31], v[112:115], a[40:43], v[28:31]
    v_mfma_f32_16x16x32_bf16 v[48:51], v[112:115], a[44:47], v[48:51]
    ds_read_b128 v[100:103], v8 offset:50176
    v_mfma_f32_16x16x32_bf16 v[32:35], v[116:119], a[40:43], v[32:35]
    v_mfma_f32_16x16x32_bf16 v[52:55], v[116:119], a[44:47], v[52:55]
    ds_read_b128 v[104:107], v8 offset:51200
    s_waitcnt lgkmcnt(3)
    v_mfma_f32_16x16x32_bf16 v[16:19], v[120:123], a[48:51], v[16:19]
    v_mfma_f32_16x16x32_bf16 v[36:39], v[120:123], a[52:55], v[36:39]
    ds_read_b128 v[108:111], v8 offset:52224
    v_mfma_f32_16x16x32_bf16 v[20:23], v[124:127], a[48:51], v[20:23]
    v_mfma_f32_16x16x32_bf16 v[40:43], v[124:127], a[52:55], v[40:43]
    ds_read_b128 v[112:115], v8 offset:53248
    s_waitcnt lgkmcnt(3)
    v_mfma_f32_16x16x32_bf16 v[24:27], v[96:99], a[48:51], v[24:27]
    v_mfma_f32_16x16x32_bf16 v[44:47], v[96:99], a[52:55], v[44:47]
    ds_read_b128 v[116:119], v8 offset:54272
    v_mfma_f32_16x16x32_bf16 v[28:31], v[100:103], a[48:51], v[28:31]
    v_mfma_f32_16x16x32_bf16 v[48:51], v[100:103], a[52:55], v[48:51]
    ds_read_b128 v[120:123], v8 offset:55296
    s_waitcnt lgkmcnt(3)
    v_mfma_f32_16x16x32_bf16 v[32:35], v[104:107], a[48:51], v[32:35]
    v_mfma_f32_16x16x32_bf16 v[52:55], v[104:107], a[52:55], v[52:55]
    ds_read_b128 v[124:127], v8 offset:56320
    v_mfma_f32_16x16x32_bf16 v[16:19], v[108:111], a[56:59], v[16:19]
    v_mfma_f32_16x16x32_bf16 v[36:39], v[108:111], a[60:63], v[36:39]
    ds_read_b128 v[96:99], v8 offset:57344
    s_waitcnt lgkmcnt(3)
    v_mfma_f32_16x16x32_bf16 v[20:23], v[112:115], a[56:59], v[20:23]
    v_mfma_f32_16x16x32_bf16 v[40:43], v[112:115], a[60:63], v[40:43]
    ds_read_b128 v[100:103], v8 offset:58368
    v_mfma_f32_16x16x32_bf16 v[24:27], v[116:119], a[56:59], v[24:27]
    v_mfma_f32_16x16x32_bf16 v[44:47], v[116:119], a[60:63], v[44:47]
    ds_read_b128 v[104:107], v8 offset:59392
    s_waitcnt lgkmcnt(3)
    v_mfma_f32_16x16x32_bf16 v[28:31], v[120:123], a[56:59], v[28:31]
    v_mfma_f32_16x16x32_bf16 v[48:51], v[120:123], a[60:63], v[48:51]
    ds_read_b128 v[108:111], v8 offset:60416
    v_mfma_f32_16x16x32_bf16 v[32:35], v[124:127], a[56:59], v[32:35]
    v_mfma_f32_16x16x32_bf16 v[52:55], v[124:127], a[60:63], v[52:55]
    ds_read_b128 v[112:115], v8 offset:61440
    s_waitcnt lgkmcnt(3)
    v_mfma_f32_16x16x32_bf16 v[16:19], v[96:99], a[64:67], v[16:19]
    v_mfma_f32_16x16x32_bf16 v[36:39], v[96:99], a[68:71], v[36:39]
    ds_read_b128 v[116:119], v8 offset:62464
    v_mfma_f32_16x16x32_bf16 v[20:23], v[100:103], a[64:67], v[20:23]
    v_mfma_f32_16x16x32_bf16 v[40:43], v[100:103], a[68:71], v[40:43]
    ds_read_b128 v[120:123], v8 offset:63488
    s_waitcnt lgkmcnt(3)
    v_mfma_f32_16x16x32_bf16 v[24:27], v[104:107], a[64:67], v[24:27]
    v_mfma_f32_16x16x32_bf16 v[44:47], v[104:107], a[68:71], v[44:47]
    ds_read_b128 v[124:127], v8 offset:64512
    v_mfma_f32_16x16x32_bf16 v[28:31], v[108:111], a[64:67], v[28:31]
    v_mfma_f32_16x16x32_bf16 v[48:51], v[108:111], a[68:71], v[48:51]
    ds_read_b128 v[96:99], v9 offset:0
    s_waitcnt lgkmcnt(3)
    v_mfma_f32_16x16x32_bf16 v[32:35], v[112:115], a[64:67], v[32:35]
    v_mfma_f32_16x16x32_bf16 v[52:55], v[112:115], a[68:71], v[52:55]
    ds_read_b128 v[100:103], v9 offset:1024
    v_mfma_f32_16x16x32_bf16 v[16:19], v[116:119], a[72:75], v[16:19]
    v_mfma_f32_16x16x32_bf16 v[36:39], v[116:119], a[76:79], v[36:39]
    ds_read_b128 v[104:107], v9 offset:2048
    s_waitcnt lgkmcnt(3)
    v_mfma_f32_16x16x32_bf16 v[20:23], v[120:123], a[72:75], v[20:23]
    v_mfma_f32_16x16x32_bf16 v[40:43], v[120:123], a[76:79], v[40:43]
    ds_read_b128 v[108:111], v9 offset:3072
    v_mfma_f32_16x16x32_bf16 v[24:27], v[124:127], a[72:75], v[24:27]
    v_mfma_f32_16x16x32_bf16 v[44:47], v[124:127], a[76:79], v[44:47]
    ds_read_b128 v[112:115], v9 offset:4096
    s_waitcnt lgkmcnt(3)
    v_mfma_f32_16x16x32_bf16 v[28:31], v[96:99], a[72:75], v[28:31]
    v_mfma_f32_16x16x32_bf16 v[48:51], v[96:99], a[76:79], v[48:51]
    ds_read_b128 v[116:119], v9 offset:5120
    v_mfma_f32_16x16x32_bf16 v[32:35], v[100:103], a[72:75], v[32:35]
    v_mfma_f32_16x16x32_bf16 v[52:55], v[100:103], a[76:79], v[52:55]
    ds_read_b128 v[120:123], v9 offset:6144
    s_waitcnt lgkmcnt(3)
    v_mfma_f32_16x16x32_bf16 v[16:19], v[104:107], a[80:83], v[16:19]
    v_mfma_f32_16x16x32_bf16 v[36:39], v[104:107], a[84:87], v[36:39]
    ds_read_b128 v[124:127], v9 offset:7168
    v_mfma_f32_16x16x32_bf16 v[20:23], v[108:111], a[80:83], v[20:23]
    v_mfma_f32_16x16x32_bf16 v[40:43], v[108:111], a[84:87], v[40:43]
    ds_read_b128 v[96:99], v9 offset:8192
    s_waitcnt lgkmcnt(3)
    v_mfma_f32_16x16x32_bf16 v[24:27], v[112:115], a[80:83], v[24:27]
    v_mfma_f32_16x16x32_bf16 v[44:47], v[112:115], a[84:87], v[44:47]
    ds_read_b128 v[100:103], v9 offset:9216
    v_mfma_f32_16x16x32_bf16 v[28:31], v[116:119], a[80:83], v[28:31]
    v_mfma_f32_16x16x32_bf16 v[48:51], v[116:119], a[84:87], v[48:51]
    ds_read_b128 v[104:107], v9 offset:10240
    s_waitcnt lgkmcnt(3)
    v_mfma_f32_16x16x32_bf16 v[32:35], v[120:123], a[80:83], v[32:35]
    v_mfma_f32_16x16x32_bf16 v[52:55], v[120:123], a[84:87], v[52:55]
    ds_read_b128 v[108:111], v9 offset:11264
    v_mfma_f32_16x16x32_bf16 v[16:19], v[124:127], a[88:91], v[16:19]
    v_mfma_f32_16x16x32_bf16 v[36:39], v[124:127], a[92:95], v[36:39]
    s_waitcnt vmcnt(14)
    s_barrier
    ds_read_b128 v[112:115], v9 offset:12288
    s_waitcnt lgkmcnt(3)
    v_mfma_f32_16x16x32_bf16 v[20:23], v[96:99], a[88:91], v[20:23]
    v_mfma_f32_16x16x32_bf16 v[40:43], v[96:99], a[92:95], v[40:43]
    ds_read_b128 v[116:119], v9 offset:13312
    v_mfma_f32_16x16x32_bf16 v[24:27], v[100:103], a[88:91], v[24:27]
    v_mfma_f32_16x16x32_bf16 v[44:47], v[100:103], a[92:95], v[44:47]
    ds_read_b128 v[120:123], v9 offset:14336
    s_waitcnt lgkmcnt(3)
    v_mfma_f32_16x16x32_bf16 v[28:31], v[104:107], a[88:91], v[28:31]
    v_mfma_f32_16x16x32_bf16 v[48:51], v[104:107], a[92:95], v[48:51]
    ds_read_b128 v[124:127], v9 offset:15360
    v_mfma_f32_16x16x32_bf16 v[32:35], v[108:111], a[88:91], v[32:35]
    v_mfma_f32_16x16x32_bf16 v[52:55], v[108:111], a[92:95], v[52:55]
    ds_read_b128 v[96:99], v9 offset:16384
    s_waitcnt lgkmcnt(3)
    v_mfma_f32_16x16x32_bf16 v[16:19], v[112:115], a[96:99], v[16:19]
    v_mfma_f32_16x16x32_bf16 v[36:39], v[112:115], a[100:103], v[36:39]
    ds_read_b128 v[100:103], v9 offset:17408
    v_mfma_f32_16x16x32_bf16 v[20:23], v[116:119], a[96:99], v[20:23]
    v_mfma_f32_16x16x32_bf16 v[40:43], v[116:119], a[100:103], v[40:43]
    ds_read_b128 v[104:107], v9 offset:18432
    s_waitcnt lgkmcnt(3)
    v_mfma_f32_16x16x32_bf16 v[24:27], v[120:123], a[96:99], v[24:27]
    v_mfma_f32_16x16x32_bf16 v[44:47], v[120:123], a[100:103], v[44:47]
    ds_read_b128 v[108:111], v9 offset:19456
    v_mfma_f32_16x16x32_bf16 v[28:31], v[124:127], a[96:99], v[28:31]
    v_mfma_f32_16x16x32_bf16 v[48:51], v[124:127], a[100:103], v[48:51]
    ds_read_b128 v[112:115], v9 offset:20480
    s_waitcnt lgkmcnt(3)
    v_mfma_f32_16x16x32_bf16 v[32:35], v[96:99], a[96:99], v[32:35]
    v_mfma_f32_16x16x32_bf16 v[52:55], v[96:99], a[100:103], v[52:55]
    ds_read_b128 v[116:119], v9 offset:21504
    v_mfma_f32_16x16x32_bf16 v[16:19], v[100:103], a[104:107], v[16:19]
    v_mfma_f32_16x16x32_bf16 v[36:39], v[100:103], a[108:111], v[36:39]
    ds_read_b128 v[120:123], v9 offset:22528
    s_waitcnt lgkmcnt(3)
    v_mfma_f32_16x16x32_bf16 v[20:23], v[104:107], a[104:107], v[20:23]
    v_mfma_f32_16x16x32_bf16 v[40:43], v[104:107], a[108:111], v[40:43]
    ds_read_b128 v[124:127], v9 offset:23552
    v_mfma_f32_16x16x32_bf16 v[24:27], v[108:111], a[104:107], v[24:27]
    v_mfma_f32_16x16x32_bf16 v[44:47], v[108:111], a[108:111], v[44:47]
    ds_read_b128 v[96:99], v9 offset:24576
    s_waitcnt lgkmcnt(3)
    v_mfma_f32_16x16x32_bf16 v[28:31], v[112:115], a[104:107], v[28:31]
    v_mfma_f32_16x16x32_bf16 v[48:51], v[112:115], a[108:111], v[48:51]
    ds_read_b128 v[100:103], v9 offset:25600
    v_mfma_f32_16x16x32_bf16 v[32:35], v[116:119], a[104:107], v[32:35]
    v_mfma_f32_16x16x32_bf16 v[52:55], v[116:119], a[108:111], v[52:55]
    ds_read_b128 v[104:107], v9 offset:26624
    s_waitcnt lgkmcnt(3)
    v_mfma_f32_16x16x32_bf16 v[16:19], v[120:123], a[112:115], v[16:19]
    v_mfma_f32_16x16x32_bf16 v[36:39], v[120:123], a[116:119], v[36:39]
    ds_read_b128 v[108:111], v9 offset:27648
    v_mfma_f32_16x16x32_bf16 v[20:23], v[124:127], a[112:115], v[20:23]
    v_mfma_f32_16x16x32_bf16 v[40:43], v[124:127], a[116:119], v[40:43]
    ds_read_b128 v[112:115], v9 offset:28672
    s_waitcnt lgkmcnt(3)
    v_mfma_f32_16x16x32_bf16 v[24:27], v[96:99], a[112:115], v[24:27]
    v_mfma_f32_16x16x32_bf16 v[44:47], v[96:99], a[116:119], v[44:47]
    ds_read_b128 v[116:119], v9 offset:29696
    v_mfma_f32_16x16x32_bf16 v[28:31], v[100:103], a[112:115], v[28:31]
    v_mfma_f32_16x16x32_bf16 v[48:51], v[100:103], a[116:119], v[48:51]
    ds_read_b128 v[120:123], v9 offset:30720
    s_waitcnt lgkmcnt(3)
    v_mfma_f32_16x16x32_bf16 v[32:35], v[104:107], a[112:115], v[32:35]
    v_mfma_f32_16x16x32_bf16 v[52:55], v[104:107], a[116:119], v[52:55]
    ds_read_b128 v[124:127], v9 offset:31744
    v_mfma_f32_16x16x32_bf16 v[16:19], v[108:111], a[120:123], v[16:19]
    v_mfma_f32_16x16x32_bf16 v[36:39], v[108:111], a[124:127], v[36:39]
    s_waitcnt vmcnt(0)
    s_barrier
    s_lshl_b32 s29, s28, 8
    s_add_u32 s29, s29, 7979008
    s_cmp_lg_u32 s24, 0
    s_cbranch_scc1 K1a_nosig
    v_mov_b32 v10, 1
    v_mov_b32 v12, 0
    s_mov_b64 exec, 1
    buffer_atomic_add v10, v12, s[20:23], s29 offen
    s_mov_b64 exec, -1
K1a_nosig:
    ds_read_b128 v[96:99], v6 offset:0
    s_waitcnt lgkmcnt(3)
    v_mfma_f32_16x16x32_bf16 v[20:23], v[112:115], a[120:123], v[20:23]
    v_mfma_f32_16x16x32_bf16 v[40:43], v[112:115], a[124:127], v[40:43]
    ds_read_b128 v[100:103], v6 offset:1024
    v_mfma_f32_16x16x32_bf16 v[24:27], v[116:119], a[120:123], v[24:27]
    v_mfma_f32_16x16x32_bf16 v[44:47], v[116:119], a[124:127], v[44:47]
    ds_read_b128 v[104:107], v6 offset:2048
    s_waitcnt lgkmcnt(3)
    v_mfma_f32_16x16x32_bf16 v[28:31], v[120:123], a[120:123], v[28:31]
    v_mfma_f32_16x16x32_bf16 v[48:51], v[120:123], a[124:127], v[48:51]
    ds_read_b128 v[108:111], v6 offset:3072
    v_mfma_f32_16x16x32_bf16 v[32:35], v[124:127], a[120:123], v[32:35]
    v_mfma_f32_16x16x32_bf16 v[52:55], v[124:127], a[124:127], v[52:55]
    ds_read_b128 v[112:115], v6 offset:4096
    s_waitcnt lgkmcnt(3)
    v_mfma_f32_16x16x32_bf16 v[16:19], v[96:99], a[128:131], v[16:19]
    v_mfma_f32_16x16x32_bf16 v[36:39], v[96:99], a[132:135], v[36:39]
    ds_read_b128 v[116:119], v6 offset:5120
    v_mfma_f32_16x16x32_bf16 v[20:23], v[100:103], a[128:131], v[20:23]
    v_mfma_f32_16x16x32_bf16 v[40:43], v[100:103], a[132:135], v[40:43]
    ds_read_b128 v[120:123], v6 offset:6144
    s_waitcnt lgkmcnt(3)
    v_mfma_f32_16x16x32_bf16 v[24:27], v[104:107], a[128:131], v[24:27]
    v_mfma_f32_16x16x32_bf16 v[44:47], v[104:107], a[132:135], v[44:47]
    ds_read_b128 v[124:127], v6 offset:7168
    v_mfma_f32_16x16x32_bf16 v[28:31], v[108:111], a[128:131], v[28:31]
    v_mfma_f32_16x16x32_bf16 v[48:51], v[108:111], a[132:135], v[48:51]
    ds_read_b128 v[96:99], v6 offset:8192
    s_waitcnt lgkmcnt(3)
    v_mfma_f32_16x16x32_bf16 v[32:35], v[112:115], a[128:131], v[32:35]
    v_mfma_f32_16x16x32_bf16 v[52:55], v[112:115], a[132:135], v[52:55]
    ds_read_b128 v[100:103], v6 offset:9216
    v_mfma_f32_16x16x32_bf16 v[16:19], v[116:119], a[136:139], v[16:19]
    v_mfma_f32_16x16x32_bf16 v[36:39], v[116:119], a[140:143], v[36:39]
    ds_read_b128 v[104:107], v6 offset:10240
    s_waitcnt lgkmcnt(3)
    v_mfma_f32_16x16x32_bf16 v[20:23], v[120:123], a[136:139], v[20:23]
    v_mfma_f32_16x16x32_bf16 v[40:43], v[120:123], a[140:143], v[40:43]
    ds_read_b128 v[108:111], v6 offset:11264
    v_mfma_f32_16x16x32_bf16 v[24:27], v[124:127], a[136:139], v[24:27]
    v_mfma_f32_16x16x32_bf16 v[44:47], v[124:127], a[140:143], v[44:47]
    ds_read_b128 v[112:115], v6 offset:12288
    s_waitcnt lgkmcnt(3)
    v_mfma_f32_16x16x32_bf16 v[28:31], v[96:99], a[136:139], v[28:31]
    v_mfma_f32_16x16x32_bf16 v[48:51], v[96:99], a[140:143], v[48:51]
    ds_read_b128 v[116:119], v6 offset:13312
    v_mfma_f32_16x16x32_bf16 v[32:35], v[100:103], a[136:139], v[32:35]
    v_mfma_f32_16x16x32_bf16 v[52:55], v[100:103], a[140:143], v[52:55]
    ds_read_b128 v[120:123], v6 offset:14336
    s_waitcnt lgkmcnt(3)
    v_mfma_f32_16x16x32_bf16 v[16:19], v[104:107], a[144:147], v[16:19]
    v_mfma_f32_16x16x32_bf16 v[36:39], v[104:107], a[148:151], v[36:39]
    ds_read_b128 v[124:127], v6 offset:15360
    v_mfma_f32_16x16x32_bf16 v[20:23], v[108:111], a[144:147], v[20:23]
    v_mfma_f32_16x16x32_bf16 v[40:43], v[108:111], a[148:151], v[40:43]
    ds_read_b128 v[96:99], v6 offset:16384
    s_waitcnt lgkmcnt(3)
    v_mfma_f32_16x16x32_bf16 v[24:27], v[112:115], a[144:147], v[24:27]
    v_mfma_f32_16x16x32_bf16 v[44:47], v[112:115], a[148:151], v[44:47]
    ds_read_b128 v[100:103], v6 offset:17408
    v_mfma_f32_16x16x32_bf16 v[28:31], v[116:119], a[144:147], v[28:31]
    v_mfma_f32_16x16x32_bf16 v[48:51], v[116:119], a[148:151], v[48:51]
    ds_read_b128 v[104:107], v6 offset:18432
    s_waitcnt lgkmcnt(3)
    v_mfma_f32_16x16x32_bf16 v[32:35], v[120:123], a[144:147], v[32:35]
    v_mfma_f32_16x16x32_bf16 v[52:55], v[120:123], a[148:151], v[52:55]
    ds_read_b128 v[108:111], v6 offset:19456
    v_mfma_f32_16x16x32_bf16 v[16:19], v[124:127], a[152:155], v[16:19]
    v_mfma_f32_16x16x32_bf16 v[36:39], v[124:127], a[156:159], v[36:39]
    s_waitcnt lgkmcnt(2)
    v_mfma_f32_16x16x32_bf16 v[20:23], v[96:99], a[152:155], v[20:23]
    v_mfma_f32_16x16x32_bf16 v[40:43], v[96:99], a[156:159], v[40:43]
    v_mfma_f32_16x16x32_bf16 v[24:27], v[100:103], a[152:155], v[24:27]
    v_mfma_f32_16x16x32_bf16 v[44:47], v[100:103], a[156:159], v[44:47]
    s_waitcnt lgkmcnt(0)
    v_mfma_f32_16x16x32_bf16 v[28:31], v[104:107], a[152:155], v[28:31]
    v_mfma_f32_16x16x32_bf16 v[48:51], v[104:107], a[156:159], v[48:51]
    v_mfma_f32_16x16x32_bf16 v[32:35], v[108:111], a[152:155], v[32:35]
    v_mfma_f32_16x16x32_bf16 v[52:55], v[108:111], a[156:159], v[52:55]
    v_mov_b32 v57, 0
    v_lshlrev_b32 v80, 3, v1
    s_lshl_b32 s30, s24, 11
    s_add_u32 s30, s30, 81920
    v_lshlrev_b32 v78, 2, v1
    v_add_u32 v78, s30, v78
    s_swappc_b64 s[44:45], s[42:43]
    buffer_load_dword v56, v57, s[20:23], s29 offen sc1
    s_swappc_b64 s[44:45], s[46:47]
    s_waitcnt vmcnt(0)
    v_readfirstlane_b32 s38, v56
    s_nop 0
    s_cmp_lt_u32 s38, 16
    s_cbranch_scc1 K1a_nf
    buffer_load_dwordx2 v[58:59], v80, s[20:23], s37 offen offset:0 sc1
    buffer_load_dwordx2 v[60:61], v80, s[20:23], s37 offen offset:512 sc1
    buffer_load_dwordx2 v[62:63], v80, s[20:23], s37 offen offset:1024 sc1
    buffer_load_dwordx2 v[64:65], v80, s[20:23], s37 offen offset:1536 sc1
    buffer_load_dwordx2 v[66:67], v80, s[20:23], s37 offen offset:2048 sc1
    buffer_load_dwordx2 v[68:69], v80, s[20:23], s37 offen offset:2560 sc1
    buffer_load_dwordx2 v[70:71], v80, s[20:23], s37 offen offset:3072 sc1
K1a_nf:
    s_swappc_b64 s[44:45], s[48:49]
    s_cmp_ge_u32 s38, 16
    s_cbranch_scc1 K1a_got
K1a_poll:
    buffer_load_dword v56, v57, s[20:23], s29 offen sc1
    s_waitcnt vmcnt(0)
    v_readfirstlane_b32 s30, v56
    s_nop 0
    s_cmp_ge_u32 s30, 16
    s_cbranch_scc1 K1a_go
    s_add_u32 s38, s38, 1
    s_cmp_ge_u32 s38, 0x40000
    s_cbranch_scc1 K1a_go
    s_sleep 2
    s_branch K1a_poll
K1a_go:
    buffer_load_dwordx2 v[58:59], v80, s[20:23], s37 offen offset:0 sc1
    buffer_load_dwordx2 v[60:61], v80, s[20:23], s37 offen offset:512 sc1
    buffer_load_dwordx2 v[62:63], v80, s[20:23], s37 offen offset:1024 sc1
    buffer_load_dwordx2 v[64:65], v80, s[20:23], s37 offen offset:1536 sc1
    buffer_load_dwordx2 v[66:67], v80, s[20:23], s37 offen offset:2048 sc1
    buffer_load_dwordx2 v[68:69], v80, s[20:23], s37 offen offset:2560 sc1
    buffer_load_dwordx2 v[70:71], v80, s[20:23], s37 offen offset:3072 sc1
K1a_got:
    s_waitcnt vmcnt(0)
    v_cvt_pk_bf16_f32 v58, v58, v59
    v_cvt_pk_bf16_f32 v59, v60, v61
    v_cvt_pk_bf16_f32 v60, v62, v63
    v_cvt_pk_bf16_f32 v61, v64, v65
    v_cvt_pk_bf16_f32 v62, v66, v67
    v_cvt_pk_bf16_f32 v63, v68, v69
    v_cvt_pk_bf16_f32 v64, v70, v71
    ds_write_b32 v78, v58 offset:0
    ds_write_b32 v78, v59 offset:256
    ds_write_b32 v78, v60 offset:512
    ds_write_b32 v78, v61 offset:768
    ds_write_b32 v78, v62 offset:1024
    ds_write_b32 v78, v63 offset:1280
    ds_write_b32 v78, v64 offset:1536
    s_lshl_b32 s41, s27, 8
    s_add_u32 s41, s41, 7983104
    s_mov_b32 s85, 1
    s_branch K1_fin2
K1a_o:
    v_and_b32 v248, 3, v3
    v_mul_u32_u24 v248, 80, v248
    v_lshl_add_u32 v248, v2, 11, v248
    v_lshrrev_b32 v249, 2, v3
    v_cmp_eq_u32 vcc, v249, v2
    v_mov_b32 v249, 83600
    v_lshlrev_b32 v250, 11, v2
    v_add_u32 v250, 83520, v250
    v_cndmask_b32 v201, v249, v250, vcc
    ds_read_b128 a[100:103], v201 offset:0
    ds_read_b128 a[104:107], v201 offset:16
    ds_read_b128 a[108:111], v201 offset:32
    ds_read_b128 a[112:115], v201 offset:48
    ds_read_b128 a[116:119], v201 offset:64
    v_add_u32 v250, 81920, v248
    v_cndmask_b32 v196, v249, v250, vcc
    ds_read_b128 a[0:3], v196 offset:0
    ds_read_b128 a[4:7], v196 offset:16
    ds_read_b128 a[8:11], v196 offset:32
    ds_read_b128 a[12:15], v196 offset:48
    ds_read_b128 a[16:19], v196 offset:64
    v_add_u32 v250, 82240, v248
    v_cndmask_b32 v197, v249, v250, vcc
    ds_read_b128 a[20:23], v197 offset:0
    ds_read_b128 a[24:27], v197 offset:16
    ds_read_b128 a[28:31], v197 offset:32
    ds_read_b128 a[32:35], v197 offset:48
    ds_read_b128 a[36:39], v197 offset:64
    v_lshrrev_b32 v203, 1, v2
    v_lshlrev_b32 v203, 8, v203
    v_lshl_add_u32 v203, v3, 4, v203
    v_and_b32 v251, 1, v2
    v_lshl_add_u32 v203, v251, 3, v203
    s_waitcnt lgkmcnt(5)
    v_mfma_f32_16x16x32_bf16 v[132:135], a[100:103], v[208:211], 0
    v_mfma_f32_16x16x32_bf16 v[156:159], a[100:103], v[228:231], 0
    v_mfma_f32_16x16x32_bf16 v[112:115], a[0:3], v[208:211], 0
    v_mfma_f32_16x16x32_bf16 v[136:139], a[0:3], v[228:231], 0
    v_add_u32 v250, 82560, v248
    v_cndmask_b32 v198, v249, v250, vcc
    ds_read_b128 a[40:43], v198 offset:0
    ds_read_b128 a[44:47], v198 offset:16
    ds_read_b128 a[48:51], v198 offset:32
    ds_read_b128 a[52:55], v198 offset:48
    ds_read_b128 a[56:59], v198 offset:64
    v_mfma_f32_16x16x32_bf16 v[132:135], a[104:107], v[212:215], v[132:135]
    v_mfma_f32_16x16x32_bf16 v[156:159], a[104:107], v[232:235], v[156:159]
    v_mfma_f32_16x16x32_bf16 v[112:115], a[4:7], v[212:215], v[112:115]
    v_mfma_f32_16x16x32_bf16 v[136:139], a[4:7], v[232:235], v[136:139]
    v_add_u32 v250, 82880, v248
    v_cndmask_b32 v199, v249, v250, vcc
    ds_read_b128 a[60:63], v199 offset:0
    ds_read_b128 a[64:67], v199 offset:16
    ds_read_b128 a[68:71], v199 offset:32
    ds_read_b128 a[72:75], v199 offset:48
    ds_read_b128 a[76:79], v199 offset:64
    v_mfma_f32_16x16x32_bf16 v[132:135], a[108:111], v[216:219], v[132:135]
    v_mfma_f32_16x16x32_bf16 v[156:159], a[108:111], v[236:239], v[156:159]
    v_mfma_f32_16x16x32_bf16 v[112:115], a[8:11], v[216:219], v[112:115]
    v_mfma_f32_16x16x32_bf16 v[136:139], a[8:11], v[236:239], v[136:139]
    v_add_u32 v250, 83200, v248
    v_cndmask_b32 v200, v249, v250, vcc
    ds_read_b128 a[80:83], v200 offset:0
    ds_read_b128 a[84:87], v200 offset:16
    ds_read_b128 a[88:91], v200 offset:32
    ds_read_b128 a[92:95], v200 offset:48
    ds_read_b128 a[96:99], v200 offset:64
    v_mfma_f32_16x16x32_bf16 v[132:135], a[112:115], v[220:223], v[132:135]
    v_mfma_f32_16x16x32_bf16 v[156:159], a[112:115], v[240:243], v[156:159]
    v_mfma_f32_16x16x32_bf16 v[112:115], a[12:15], v[220:223], v[112:115]
    v_mfma_f32_16x16x32_bf16 v[136:139], a[12:15], v[240:243], v[136:139]
    v_mfma_f32_16x16x32_bf16 v[132:135], a[116:119], v[224:227], v[132:135]
    v_mfma_f32_16x16x32_bf16 v[156:159], a[116:119], v[244:247], v[156:159]
    v_mfma_f32_16x16x32_bf16 v[112:115], a[16:19], v[224:227], v[112:115]
    v_mfma_f32_16x16x32_bf16 v[136:139], a[16:19], v[244:247], v[136:139]
    s_waitcnt lgkmcnt(10)
    v_mfma_f32_16x16x32_bf16 v[116:119], a[20:23], v[208:211], 0
    v_mfma_f32_16x16x32_bf16 v[140:143], a[20:23], v[228:231], 0
    v_mfma_f32_16x16x32_bf16 v[120:123], a[40:43], v[208:211], 0
    v_mfma_f32_16x16x32_bf16 v[144:147], a[40:43], v[228:231], 0
    v_mfma_f32_16x16x32_bf16 v[116:119], a[24:27], v[212:215], v[116:119]
    v_mfma_f32_16x16x32_bf16 v[140:143], a[24:27], v[232:235], v[140:143]
    v_mfma_f32_16x16x32_bf16 v[120:123], a[44:47], v[212:215], v[120:123]
    v_mfma_f32_16x16x32_bf16 v[144:147], a[44:47], v[232:235], v[144:147]
    v_mfma_f32_16x16x32_bf16 v[116:119], a[28:31], v[216:219], v[116:119]
    v_mfma_f32_16x16x32_bf16 v[140:143], a[28:31], v[236:239], v[140:143]
    v_mfma_f32_16x16x32_bf16 v[120:123], a[48:51], v[216:219], v[120:123]
    v_mfma_f32_16x16x32_bf16 v[144:147], a[48:51], v[236:239], v[144:147]
    v_add_f32 v204, 0x358637bd, v132
    v_rcp_f32 v204, v204
    v_add_f32 v206, 0x358637bd, v156
    v_rcp_f32 v206, v206
    v_mfma_f32_16x16x32_bf16 v[116:119], a[32:35], v[220:223], v[116:119]
    v_mfma_f32_16x16x32_bf16 v[140:143], a[32:35], v[240:243], v[140:143]
    v_mfma_f32_16x16x32_bf16 v[120:123], a[52:55], v[220:223], v[120:123]
    v_mfma_f32_16x16x32_bf16 v[144:147], a[52:55], v[240:243], v[144:147]
    v_pk_mul_f32 v[112:113], v[112:113], v[204:205] op_sel:[0,0] op_sel_hi:[1,0]
    v_pk_mul_f32 v[114:115], v[114:115], v[204:205] op_sel:[0,0] op_sel_hi:[1,0]
    v_cvt_pk_bf16_f32 v176, v112, v113
    v_cvt_pk_bf16_f32 v177, v114, v115
    v_pk_mul_f32 v[136:137], v[136:137], v[206:207] op_sel:[0,0] op_sel_hi:[1,0]
    v_pk_mul_f32 v[138:139], v[138:139], v[206:207] op_sel:[0,0] op_sel_hi:[1,0]
    v_cvt_pk_bf16_f32 v186, v136, v137
    v_cvt_pk_bf16_f32 v187, v138, v139
    v_mfma_f32_16x16x32_bf16 v[116:119], a[36:39], v[224:227], v[116:119]
    v_mfma_f32_16x16x32_bf16 v[140:143], a[36:39], v[244:247], v[140:143]
    v_mfma_f32_16x16x32_bf16 v[120:123], a[56:59], v[224:227], v[120:123]
    v_mfma_f32_16x16x32_bf16 v[144:147], a[56:59], v[244:247], v[144:147]
    s_waitcnt lgkmcnt(0)
    v_mfma_f32_16x16x32_bf16 v[124:127], a[60:63], v[208:211], 0
    v_mfma_f32_16x16x32_bf16 v[148:151], a[60:63], v[228:231], 0
    v_mfma_f32_16x16x32_bf16 v[128:131], a[80:83], v[208:211], 0
    v_mfma_f32_16x16x32_bf16 v[152:155], a[80:83], v[228:231], 0
    v_mfma_f32_16x16x32_bf16 v[124:127], a[64:67], v[212:215], v[124:127]
    v_mfma_f32_16x16x32_bf16 v[148:151], a[64:67], v[232:235], v[148:151]
    v_mfma_f32_16x16x32_bf16 v[128:131], a[84:87], v[212:215], v[128:131]
    v_mfma_f32_16x16x32_bf16 v[152:155], a[84:87], v[232:235], v[152:155]
    v_mfma_f32_16x16x32_bf16 v[124:127], a[68:71], v[216:219], v[124:127]
    v_mfma_f32_16x16x32_bf16 v[148:151], a[68:71], v[236:239], v[148:151]
    v_mfma_f32_16x16x32_bf16 v[128:131], a[88:91], v[216:219], v[128:131]
    v_mfma_f32_16x16x32_bf16 v[152:155], a[88:91], v[236:239], v[152:155]
    v_pk_mul_f32 v[116:117], v[116:117], v[204:205] op_sel:[0,0] op_sel_hi:[1,0]
    v_pk_mul_f32 v[118:119], v[118:119], v[204:205] op_sel:[0,0] op_sel_hi:[1,0]
    v_cvt_pk_bf16_f32 v178, v116, v117
    v_cvt_pk_bf16_f32 v179, v118, v119
    v_pk_mul_f32 v[140:141], v[140:141], v[206:207] op_sel:[0,0] op_sel_hi:[1,0]
    v_pk_mul_f32 v[142:143], v[142:143], v[206:207] op_sel:[0,0] op_sel_hi:[1,0]
    v_cvt_pk_bf16_f32 v188, v140, v141
    v_cvt_pk_bf16_f32 v189, v142, v143
    v_mfma_f32_16x16x32_bf16 v[124:127], a[72:75], v[220:223], v[124:127]
    v_mfma_f32_16x16x32_bf16 v[148:151], a[72:75], v[240:243], v[148:151]
    v_mfma_f32_16x16x32_bf16 v[128:131], a[92:95], v[220:223], v[128:131]
    v_mfma_f32_16x16x32_bf16 v[152:155], a[92:95], v[240:243], v[152:155]
    v_pk_mul_f32 v[120:121], v[120:121], v[204:205] op_sel:[0,0] op_sel_hi:[1,0]
    v_pk_mul_f32 v[122:123], v[122:123], v[204:205] op_sel:[0,0] op_sel_hi:[1,0]
    v_cvt_pk_bf16_f32 v180, v120, v121
    v_cvt_pk_bf16_f32 v181, v122, v123
    v_pk_mul_f32 v[144:145], v[144:145], v[206:207] op_sel:[0,0] op_sel_hi:[1,0]
    v_pk_mul_f32 v[146:147], v[146:147], v[206:207] op_sel:[0,0] op_sel_hi:[1,0]
    v_cvt_pk_bf16_f32 v190, v144, v145
    v_cvt_pk_bf16_f32 v191, v146, v147
    v_mfma_f32_16x16x32_bf16 v[124:127], a[76:79], v[224:227], v[124:127]
    v_mfma_f32_16x16x32_bf16 v[148:151], a[76:79], v[244:247], v[148:151]
    v_mfma_f32_16x16x32_bf16 v[128:131], a[96:99], v[224:227], v[128:131]
    v_mfma_f32_16x16x32_bf16 v[152:155], a[96:99], v[244:247], v[152:155]
    s_nop 4
    v_pk_mul_f32 v[124:125], v[124:125], v[204:205] op_sel:[0,0] op_sel_hi:[1,0]
    v_pk_mul_f32 v[126:127], v[126:127], v[204:205] op_sel:[0,0] op_sel_hi:[1,0]
    v_cvt_pk_bf16_f32 v182, v124, v125
    v_cvt_pk_bf16_f32 v183, v126, v127
    v_pk_mul_f32 v[148:149], v[148:149], v[206:207] op_sel:[0,0] op_sel_hi:[1,0]
    v_pk_mul_f32 v[150:151], v[150:151], v[206:207] op_sel:[0,0] op_sel_hi:[1,0]
    v_cvt_pk_bf16_f32 v192, v148, v149
    v_cvt_pk_bf16_f32 v193, v150, v151
    v_pk_mul_f32 v[128:129], v[128:129], v[204:205] op_sel:[0,0] op_sel_hi:[1,0]
    v_pk_mul_f32 v[130:131], v[130:131], v[204:205] op_sel:[0,0] op_sel_hi:[1,0]
    v_cvt_pk_bf16_f32 v184, v128, v129
    v_cvt_pk_bf16_f32 v185, v130, v131
    v_pk_mul_f32 v[152:153], v[152:153], v[206:207] op_sel:[0,0] op_sel_hi:[1,0]
    v_pk_mul_f32 v[154:155], v[154:155], v[206:207] op_sel:[0,0] op_sel_hi:[1,0]
    v_cvt_pk_bf16_f32 v194, v152, v153
    v_cvt_pk_bf16_f32 v195, v154, v155
    buffer_store_dwordx4 v[176:179], v10, s[20:23], s72 offen offset:0 sc1
    buffer_store_dwordx4 v[180:183], v10, s[20:23], s73 offen offset:0 sc1
    buffer_store_dwordx2 v[184:185], v203, s[20:23], s84 offen offset:0 sc1
    buffer_store_dwordx4 v[186:189], v10, s[20:23], s72 offen offset:1024 sc1
    buffer_store_dwordx4 v[190:193], v10, s[20:23], s73 offen offset:1024 sc1
    buffer_store_dwordx2 v[194:195], v203, s[20:23], s84 offen offset:1024 sc1
    s_cmp_eq_u32 s85, 2
    s_mov_b32 s85, 0
    s_cbranch_scc1 K2_oback2
    s_branch K2_oback1
K1a_sm:
    v_max3_f32 v248, v16, v17, v18
    v_max3_f32 v8, v36, v37, v38
    v_min3_f32 v249, v16, v17, v18
    v_min3_f32 v9, v36, v37, v38
    v_mov_b32 v250, s35
    v_mov_b32 v10, s35
    v_sub_f32 v251, 0, v250
    v_sub_f32 v11, 0, v10
    v_max3_f32 v248, v248, v19, v20
    v_max3_f32 v8, v8, v39, v40
    v_min3_f32 v249, v249, v19, v20
    v_min3_f32 v9, v9, v39, v40
    v_max3_f32 v248, v248, v21, v22
    v_max3_f32 v8, v8, v41, v42
    v_min3_f32 v249, v249, v21, v22
    v_min3_f32 v9, v9, v41, v42
    v_max3_f32 v248, v248, v23, v24
    v_max3_f32 v8, v8, v43, v44
    v_min3_f32 v249, v249, v23, v24
    v_min3_f32 v9, v9, v43, v44
    v_max3_f32 v248, v248, v25, v26
    v_max3_f32 v8, v8, v45, v46
    v_min3_f32 v249, v249, v25, v26
    v_min3_f32 v9, v9, v45, v46
    v_max3_f32 v248, v248, v27, v28
    v_max3_f32 v8, v8, v47, v48
    v_min3_f32 v249, v249, v27, v28
    v_min3_f32 v9, v9, v47, v48
    v_max3_f32 v248, v248, v29, v30
    v_max3_f32 v8, v8, v49, v50
    v_min3_f32 v249, v249, v29, v30
    v_min3_f32 v9, v9, v49, v50
    v_max3_f32 v248, v248, v31, v32
    v_max3_f32 v8, v8, v51, v52
    v_min3_f32 v249, v249, v31, v32
    v_min3_f32 v9, v9, v51, v52
    v_max3_f32 v248, v248, v33, v34
    v_max3_f32 v8, v8, v53, v54
    v_min3_f32 v249, v249, v33, v34
    v_min3_f32 v9, v9, v53, v54
    v_max_f32 v248, v248, v35
    v_max_f32 v8, v8, v55
    v_min_f32 v249, v249, v35
    v_min_f32 v9, v9, v55
    v_mul_f32 v248, v251, v248
    v_mul_f32 v8, v11, v8
    v_mul_f32 v249, v250, v249
    v_mul_f32 v9, v10, v9
    v_pk_fma_f32 v[128:129], v[16:17], v[250:251], v[248:249] op_sel:[0,0,0] op_sel_hi:[1,0,0]
    v_pk_fma_f32 v[168:169], v[36:37], v[10:11], v[8:9] op_sel:[0,0,0] op_sel_hi:[1,0,0]
    v_pk_fma_f32 v[148:149], v[16:17], v[250:251], v[248:249] op_sel:[0,1,1] op_sel_hi:[1,1,1]
    v_pk_fma_f32 v[188:189], v[36:37], v[10:11], v[8:9] op_sel:[0,1,1] op_sel_hi:[1,1,1]
    v_pk_fma_f32 v[130:131], v[18:19], v[250:251], v[248:249] op_sel:[0,0,0] op_sel_hi:[1,0,0]
    v_pk_fma_f32 v[170:171], v[38:39], v[10:11], v[8:9] op_sel:[0,0,0] op_sel_hi:[1,0,0]
    v_pk_fma_f32 v[150:151], v[18:19], v[250:251], v[248:249] op_sel:[0,1,1] op_sel_hi:[1,1,1]
    v_pk_fma_f32 v[190:191], v[38:39], v[10:11], v[8:9] op_sel:[0,1,1] op_sel_hi:[1,1,1]
    v_pk_fma_f32 v[132:133], v[20:21], v[250:251], v[248:249] op_sel:[0,0,0] op_sel_hi:[1,0,0]
    v_pk_fma_f32 v[172:173], v[40:41], v[10:11], v[8:9] op_sel:[0,0,0] op_sel_hi:[1,0,0]
    v_pk_fma_f32 v[152:153], v[20:21], v[250:251], v[248:249] op_sel:[0,1,1] op_sel_hi:[1,1,1]
    v_pk_fma_f32 v[192:193], v[40:41], v[10:11], v[8:9] op_sel:[0,1,1] op_sel_hi:[1,1,1]
    v_pk_fma_f32 v[134:135], v[22:23], v[250:251], v[248:249] op_sel:[0,0,0] op_sel_hi:[1,0,0]
    v_pk_fma_f32 v[174:175], v[42:43], v[10:11], v[8:9] op_sel:[0,0,0] op_sel_hi:[1,0,0]
    v_pk_fma_f32 v[154:155], v[22:23], v[250:251], v[248:249] op_sel:[0,1,1] op_sel_hi:[1,1,1]
    v_pk_fma_f32 v[194:195], v[42:43], v[10:11], v[8:9] op_sel:[0,1,1] op_sel_hi:[1,1,1]
    v_pk_fma_f32 v[136:137], v[24:25], v[250:251], v[248:249] op_sel:[0,0,0] op_sel_hi:[1,0,0]
    v_pk_fma_f32 v[176:177], v[44:45], v[10:11], v[8:9] op_sel:[0,0,0] op_sel_hi:[1,0,0]
    v_pk_fma_f32 v[156:157], v[24:25], v[250:251], v[248:249] op_sel:[0,1,1] op_sel_hi:[1,1,1]
    v_pk_fma_f32 v[196:197], v[44:45], v[10:11], v[8:9] op_sel:[0,1,1] op_sel_hi:[1,1,1]
    v_pk_fma_f32 v[138:139], v[26:27], v[250:251], v[248:249] op_sel:[0,0,0] op_sel_hi:[1,0,0]
    v_pk_fma_f32 v[178:179], v[46:47], v[10:11], v[8:9] op_sel:[0,0,0] op_sel_hi:[1,0,0]
    v_pk_fma_f32 v[158:159], v[26:27], v[250:251], v[248:249] op_sel:[0,1,1] op_sel_hi:[1,1,1]
    v_pk_fma_f32 v[198:199], v[46:47], v[10:11], v[8:9] op_sel:[0,1,1] op_sel_hi:[1,1,1]
    v_pk_fma_f32 v[140:141], v[28:29], v[250:251], v[248:249] op_sel:[0,0,0] op_sel_hi:[1,0,0]
    v_pk_fma_f32 v[180:181], v[48:49], v[10:11], v[8:9] op_sel:[0,0,0] op_sel_hi:[1,0,0]
    v_pk_fma_f32 v[160:161], v[28:29], v[250:251], v[248:249] op_sel:[0,1,1] op_sel_hi:[1,1,1]
    v_pk_fma_f32 v[200:201], v[48:49], v[10:11], v[8:9] op_sel:[0,1,1] op_sel_hi:[1,1,1]
    v_pk_fma_f32 v[142:143], v[30:31], v[250:251], v[248:249] op_sel:[0,0,0] op_sel_hi:[1,0,0]
    v_pk_fma_f32 v[182:183], v[50:51], v[10:11], v[8:9] op_sel:[0,0,0] op_sel_hi:[1,0,0]
    v_pk_fma_f32 v[162:163], v[30:31], v[250:251], v[248:249] op_sel:[0,1,1] op_sel_hi:[1,1,1]
    v_pk_fma_f32 v[202:203], v[50:51], v[10:11], v[8:9] op_sel:[0,1,1] op_sel_hi:[1,1,1]
    s_setpc_b64 s[44:45]
K1a_sm1:
    v_pk_fma_f32 v[144:145], v[32:33], v[250:251], v[248:249] op_sel:[0,0,0] op_sel_hi:[1,0,0]
    v_pk_fma_f32 v[184:185], v[52:53], v[10:11], v[8:9] op_sel:[0,0,0] op_sel_hi:[1,0,0]
    v_pk_fma_f32 v[164:165], v[32:33], v[250:251], v[248:249] op_sel:[0,1,1] op_sel_hi:[1,1,1]
    v_pk_fma_f32 v[204:205], v[52:53], v[10:11], v[8:9] op_sel:[0,1,1] op_sel_hi:[1,1,1]
    v_pk_fma_f32 v[146:147], v[34:35], v[250:251], v[248:249] op_sel:[0,0,0] op_sel_hi:[1,0,0]
    v_pk_fma_f32 v[186:187], v[54:55], v[10:11], v[8:9] op_sel:[0,0,0] op_sel_hi:[1,0,0]
    v_pk_fma_f32 v[166:167], v[34:35], v[250:251], v[248:249] op_sel:[0,1,1] op_sel_hi:[1,1,1]
    v_pk_fma_f32 v[206:207], v[54:55], v[10:11], v[8:9] op_sel:[0,1,1] op_sel_hi:[1,1,1]
    v_exp_f32 v128, v128
    v_exp_f32 v168, v168
    v_exp_f32 v129, v129
    v_exp_f32 v169, v169
    v_exp_f32 v130, v130
    v_exp_f32 v170, v170
    v_exp_f32 v131, v131
    v_exp_f32 v171, v171
    v_exp_f32 v132, v132
    v_exp_f32 v172, v172
    v_exp_f32 v133, v133
    v_exp_f32 v173, v173
    v_exp_f32 v134, v134
    v_exp_f32 v174, v174
    v_exp_f32 v135, v135
    v_exp_f32 v175, v175
    v_exp_f32 v136, v136
    v_exp_f32 v176, v176
    v_exp_f32 v137, v137
    v_exp_f32 v177, v177
    v_exp_f32 v138, v138
    v_exp_f32 v178, v178
    v_exp_f32 v139, v139
    v_exp_f32 v179, v179
    v_exp_f32 v140, v140
    v_exp_f32 v180, v180
    v_exp_f32 v141, v141
    v_exp_f32 v181, v181
    v_exp_f32 v142, v142
    v_exp_f32 v182, v182
    v_exp_f32 v143, v143
    v_exp_f32 v183, v183
    v_exp_f32 v144, v144
    v_exp_f32 v184, v184
    v_exp_f32 v145, v145
    v_exp_f32 v185, v185
    v_exp_f32 v146, v146
    v_exp_f32 v186, v186
    v_exp_f32 v147, v147
    v_exp_f32 v187, v187
    v_exp_f32 v148, v148
    v_exp_f32 v188, v188
    v_exp_f32 v149, v149
    v_exp_f32 v189, v189
    v_exp_f32 v150, v150
    v_exp_f32 v190, v190
    v_exp_f32 v151, v151
    v_exp_f32 v191, v191
    v_exp_f32 v152, v152
    v_exp_f32 v192, v192
    v_exp_f32 v153, v153
    v_exp_f32 v193, v193
    v_exp_f32 v154, v154
    v_exp_f32 v194, v194
    v_exp_f32 v155, v155
    v_exp_f32 v195, v195
    v_exp_f32 v156, v156
    v_exp_f32 v196, v196
    v_exp_f32 v157, v157
    v_exp_f32 v197, v197
    v_exp_f32 v158, v158
    v_exp_f32 v198, v198
    s_setpc_b64 s[44:45]
K1a_sm2:
    v_exp_f32 v159, v159
    v_exp_f32 v199, v199
    v_exp_f32 v160, v160
    v_exp_f32 v200, v200
    v_exp_f32 v161, v161
    v_exp_f32 v201, v201
    v_exp_f32 v162, v162
    v_exp_f32 v202, v202
    v_exp_f32 v163, v163
    v_exp_f32 v203, v203
    v_exp_f32 v164, v164
    v_exp_f32 v204, v204
    v_exp_f32 v165, v165
    v_exp_f32 v205, v205
    v_exp_f32 v166, v166
    v_exp_f32 v206, v206
    v_exp_f32 v167, v167
    v_exp_f32 v207, v207
    v_pk_add_f32 v[252:253], v[128:129], v[130:131]
    v_pk_add_f32 v[12:13], v[168:169], v[170:171]
    v_pk_add_f32 v[254:255], v[148:149], v[150:151]
    v_pk_add_f32 v[14:15], v[188:189], v[190:191]
    v_pk_add_f32 v[252:253], v[252:253], v[132:133]
    v_pk_add_f32 v[12:13], v[12:13], v[172:173]
    v_pk_add_f32 v[254:255], v[254:255], v[152:153]
    v_pk_add_f32 v[14:15], v[14:15], v[192:193]
    v_pk_add_f32 v[252:253], v[252:253], v[134:135]
    v_pk_add_f32 v[12:13], v[12:13], v[174:175]
    v_pk_add_f32 v[254:255], v[254:255], v[154:155]
    v_pk_add_f32 v[14:15], v[14:15], v[194:195]
    v_pk_add_f32 v[252:253], v[252:253], v[136:137]
    v_pk_add_f32 v[12:13], v[12:13], v[176:177]
    v_pk_add_f32 v[254:255], v[254:255], v[156:157]
    v_pk_add_f32 v[14:15], v[14:15], v[196:197]
    v_pk_add_f32 v[252:253], v[252:253], v[138:139]
    v_pk_add_f32 v[12:13], v[12:13], v[178:179]
    v_pk_add_f32 v[254:255], v[254:255], v[158:159]
    v_pk_add_f32 v[14:15], v[14:15], v[198:199]
    v_pk_add_f32 v[252:253], v[252:253], v[140:141]
    v_pk_add_f32 v[12:13], v[12:13], v[180:181]
    v_pk_add_f32 v[254:255], v[254:255], v[160:161]
    v_pk_add_f32 v[14:15], v[14:15], v[200:201]
    v_pk_add_f32 v[252:253], v[252:253], v[142:143]
    v_pk_add_f32 v[12:13], v[12:13], v[182:183]
    v_pk_add_f32 v[254:255], v[254:255], v[162:163]
    v_pk_add_f32 v[14:15], v[14:15], v[202:203]
    v_pk_add_f32 v[252:253], v[252:253], v[144:145]
    v_pk_add_f32 v[12:13], v[12:13], v[184:185]
    v_pk_add_f32 v[254:255], v[254:255], v[164:165]
    v_pk_add_f32 v[14:15], v[14:15], v[204:205]
    v_pk_add_f32 v[252:253], v[252:253], v[146:147]
    v_pk_add_f32 v[12:13], v[12:13], v[186:187]
    v_pk_add_f32 v[254:255], v[254:255], v[166:167]
    v_pk_add_f32 v[14:15], v[14:15], v[206:207]
    v_add_f32 v252, v252, v253
    v_add_f32 v12, v12, v13
    v_add_f32 v253, v254, v255
    v_add_f32 v13, v14, v15
    v_rcp_f32 v252, v252
    v_rcp_f32 v12, v12
    v_rcp_f32 v253, v253
    v_rcp_f32 v13, v13
    v_pk_mul_f32 v[128:129], v[128:129], v[252:253] op_sel:[0,0] op_sel_hi:[1,0]
    v_pk_mul_f32 v[168:169], v[168:169], v[12:13] op_sel:[0,0] op_sel_hi:[1,0]
    v_pk_mul_f32 v[148:149], v[148:149], v[252:253] op_sel:[0,1] op_sel_hi:[1,1]
    v_pk_mul_f32 v[188:189], v[188:189], v[12:13] op_sel:[0,1] op_sel_hi:[1,1]
    v_pk_mul_f32 v[130:131], v[130:131], v[252:253] op_sel:[0,0] op_sel_hi:[1,0]
    v_pk_mul_f32 v[170:171], v[170:171], v[12:13] op_sel:[0,0] op_sel_hi:[1,0]
    v_pk_mul_f32 v[150:151], v[150:151], v[252:253] op_sel:[0,1] op_sel_hi:[1,1]
    v_pk_mul_f32 v[190:191], v[190:191], v[12:13] op_sel:[0,1] op_sel_hi:[1,1]
    v_pk_mul_f32 v[132:133], v[132:133], v[252:253] op_sel:[0,0] op_sel_hi:[1,0]
    v_pk_mul_f32 v[172:173], v[172:173], v[12:13] op_sel:[0,0] op_sel_hi:[1,0]
    v_pk_mul_f32 v[152:153], v[152:153], v[252:253] op_sel:[0,1] op_sel_hi:[1,1]
    v_pk_mul_f32 v[192:193], v[192:193], v[12:13] op_sel:[0,1] op_sel_hi:[1,1]
    v_pk_mul_f32 v[134:135], v[134:135], v[252:253] op_sel:[0,0] op_sel_hi:[1,0]
    v_pk_mul_f32 v[174:175], v[174:175], v[12:13] op_sel:[0,0] op_sel_hi:[1,0]
    v_pk_mul_f32 v[154:155], v[154:155], v[252:253] op_sel:[0,1] op_sel_hi:[1,1]
    v_pk_mul_f32 v[194:195], v[194:195], v[12:13] op_sel:[0,1] op_sel_hi:[1,1]
    v_pk_mul_f32 v[136:137], v[136:137], v[252:253] op_sel:[0,0] op_sel_hi:[1,0]
    v_pk_mul_f32 v[176:177], v[176:177], v[12:13] op_sel:[0,0] op_sel_hi:[1,0]
    v_pk_mul_f32 v[156:157], v[156:157], v[252:253] op_sel:[0,1] op_sel_hi:[1,1]
    v_pk_mul_f32 v[196:197], v[196:197], v[12:13] op_sel:[0,1] op_sel_hi:[1,1]
    v_pk_mul_f32 v[138:139], v[138:139], v[252:253] op_sel:[0,0] op_sel_hi:[1,0]
    v_pk_mul_f32 v[178:179], v[178:179], v[12:13] op_sel:[0,0] op_sel_hi:[1,0]
    v_pk_mul_f32 v[158:159], v[158:159], v[252:253] op_sel:[0,1] op_sel_hi:[1,1]
    v_pk_mul_f32 v[198:199], v[198:199], v[12:13] op_sel:[0,1] op_sel_hi:[1,1]
    v_pk_mul_f32 v[140:141], v[140:141], v[252:253] op_sel:[0,0] op_sel_hi:[1,0]
    v_pk_mul_f32 v[180:181], v[180:181], v[12:13] op_sel:[0,0] op_sel_hi:[1,0]
    v_pk_mul_f32 v[160:161], v[160:161], v[252:253] op_sel:[0,1] op_sel_hi:[1,1]
    v_pk_mul_f32 v[200:201], v[200:201], v[12:13] op_sel:[0,1] op_sel_hi:[1,1]
    v_pk_mul_f32 v[142:143], v[142:143], v[252:253] op_sel:[0,0] op_sel_hi:[1,0]
    v_pk_mul_f32 v[182:183], v[182:183], v[12:13] op_sel:[0,0] op_sel_hi:[1,0]
    v_pk_mul_f32 v[162:163], v[162:163], v[252:253] op_sel:[0,1] op_sel_hi:[1,1]
    v_pk_mul_f32 v[202:203], v[202:203], v[12:13] op_sel:[0,1] op_sel_hi:[1,1]
    v_pk_mul_f32 v[144:145], v[144:145], v[252:253] op_sel:[0,0] op_sel_hi:[1,0]
    v_pk_mul_f32 v[184:185], v[184:185], v[12:13] op_sel:[0,0] op_sel_hi:[1,0]
    v_pk_mul_f32 v[164:165], v[164:165], v[252:253] op_sel:[0,1] op_sel_hi:[1,1]
    v_pk_mul_f32 v[204:205], v[204:205], v[12:13] op_sel:[0,1] op_sel_hi:[1,1]
    v_pk_mul_f32 v[146:147], v[146:147], v[252:253] op_sel:[0,0] op_sel_hi:[1,0]
    v_pk_mul_f32 v[186:187], v[186:187], v[12:13] op_sel:[0,0] op_sel_hi:[1,0]
    v_pk_mul_f32 v[166:167], v[166:167], v[252:253] op_sel:[0,1] op_sel_hi:[1,1]
    v_pk_mul_f32 v[206:207], v[206:207], v[12:13] op_sel:[0,1] op_sel_hi:[1,1]
    v_cvt_pk_bf16_f32 v208, v128, v129
    v_cvt_pk_bf16_f32 v228, v168, v169
    v_cvt_pk_bf16_f32 v209, v130, v131
    v_cvt_pk_bf16_f32 v229, v170, v171
    v_cvt_pk_bf16_f32 v210, v132, v133
    v_cvt_pk_bf16_f32 v230, v172, v173
    v_cvt_pk_bf16_f32 v211, v134, v135
    v_cvt_pk_bf16_f32 v231, v174, v175
    v_cvt_pk_bf16_f32 v212, v136, v137
    v_cvt_pk_bf16_f32 v232, v176, v177
    v_cvt_pk_bf16_f32 v213, v138, v139
    v_cvt_pk_bf16_f32 v233, v178, v179
    v_cvt_pk_bf16_f32 v214, v140, v141
    v_cvt_pk_bf16_f32 v234, v180, v181
    v_cvt_pk_bf16_f32 v215, v142, v143
    v_cvt_pk_bf16_f32 v235, v182, v183
    v_cvt_pk_bf16_f32 v216, v144, v145
    v_cvt_pk_bf16_f32 v236, v184, v185
    v_cvt_pk_bf16_f32 v217, v146, v147
    v_cvt_pk_bf16_f32 v237, v186, v187
    v_cvt_pk_bf16_f32 v218, v148, v149
    v_cvt_pk_bf16_f32 v238, v188, v189
    v_cvt_pk_bf16_f32 v219, v150, v151
    v_cvt_pk_bf16_f32 v239, v190, v191
    v_cvt_pk_bf16_f32 v220, v152, v153
    v_cvt_pk_bf16_f32 v240, v192, v193
    v_cvt_pk_bf16_f32 v221, v154, v155
    v_cvt_pk_bf16_f32 v241, v194, v195
    v_cvt_pk_bf16_f32 v222, v156, v157
    v_cvt_pk_bf16_f32 v242, v196, v197
    v_cvt_pk_bf16_f32 v223, v158, v159
    v_cvt_pk_bf16_f32 v243, v198, v199
    v_cvt_pk_bf16_f32 v224, v160, v161
    v_cvt_pk_bf16_f32 v244, v200, v201
    v_cvt_pk_bf16_f32 v225, v162, v163
    v_cvt_pk_bf16_f32 v245, v202, v203
    v_cvt_pk_bf16_f32 v226, v164, v165
    v_cvt_pk_bf16_f32 v246, v204, v205
    v_cvt_pk_bf16_f32 v227, v166, v167
    v_cvt_pk_bf16_f32 v247, v206, v207
    s_nop 1
    s_setpc_b64 s[44:45]
K2_body:
    v_and_b32 v1, 63, v0
    v_lshrrev_b32 v4, 6, v0
    v_lshrrev_b32 v2, 4, v1
    v_readfirstlane_b32 s24, v4
    v_and_b32 v3, 15, v1
    s_cmp_ge_u32 s2, 256
    s_cbranch_scc1 K2_end
    s_and_b32 s25, s2, 7
    s_lshr_b32 s26, s2, 3
    s_lshr_b32 s31, s26, 3
    s_lshl_b32 s27, s25, 2
    s_add_u32 s27, s27, s31
    s_and_b32 s28, s26, 7
    s_mul_i32 s33, s24, 20480
    s_mul_i32 s3, s31, 3
    s_add_u32 s3, s3, s28
    s_mul_i32 s37, s24, 1835008
    s_lshl_b32 s29, s27, 7
    s_add_u32 s37, s37, s29
    s_mul_i32 s36, s24, 71680
    s_mul_i32 s39, s28, 102400
    s_mul_i32 s29, s24, 25600
    s_add_u32 s39, s39, s29
    s_add_u32 s39, s39, 16142336
    s_mul_i32 s48, s27, 81920
    s_mul_i32 s29, s24, 20480
    s_add_u32 s48, s48, s29
    s_add_u32 s48, s48, 13520896
    s_mul_i32 s30, s28, 276480
    s_add_u32 s30, s30, 11309056
    v_lshrrev_b32 v4, 3, v1
    v_and_b32 v5, 6, v4
    v_xor_b32 v5, v5, v1
    v_and_b32 v5, 7, v5
    v_mul_u32_u24 v6, 4096, v4
    v_lshl_add_u32 v6, v5, 4, v6
    v_add_u32 v7, 31744, v6
    v_add_u32 v8, 63488, v6
    v_add_u32 v9, 95232, v6
    v_lshlrev_b32 v10, 4, v1
    v_add_u32 v11, 4096, v10
    v_lshrrev_b32 v4, 2, v1
    v_lshlrev_b32 v12, 7, v4
    v_and_b32 v5, 3, v1
    v_lshl_add_u32 v12, v5, 3, v12
    v_add_u32 v12, s33, v12
    v_lshrrev_b32 v4, 3, v1
    v_and_b32 v4, 3, v4
    s_add_u32 s29, s24, 3
    s_and_b32 s29, s29, 3
    v_xor_b32 v5, s29, v4
    v_lshl_add_u32 v15, v5, 5, v12
    v_lshl_add_u32 v31, s29, 10, v10
    s_add_u32 s29, s24, 2
    s_and_b32 s29, s29, 3
    v_xor_b32 v5, s29, v4
    v_lshl_add_u32 v14, v5, 5, v12
    v_lshl_add_u32 v30, s29, 10, v10
    s_add_u32 s29, s24, 1
    s_and_b32 s29, s29, 3
    v_xor_b32 v5, s29, v4
    v_lshl_add_u32 v13, v5, 5, v12
    v_lshl_add_u32 v29, s29, 10, v10
    s_add_u32 s29, s24, 0
    s_and_b32 s29, s29, 3
    v_xor_b32 v5, s29, v4
    v_lshl_add_u32 v12, v5, 5, v12
    v_lshl_add_u32 v28, s29, 10, v10
    s_waitcnt lgkmcnt(0)
    s_mov_b32 s8, s78
    s_mov_b32 s9, s79
    s_mov_b32 s10, 7077888
    s_mov_b32 s11, 0x20000
    s_add_u32 s12, s86, s30
    s_addc_u32 s13, s87, 0
    s_mov_b32 s14, 276480
    s_mov_b32 s15, 0x20000
    s_mov_b32 s16, s80
    s_mov_b32 s17, s81
    s_mov_b32 s18, 4096
    s_mov_b32 s19, 0x20000
    s_mov_b32 s20, s86
    s_mov_b32 s21, s87
    s_mov_b32 s22, 16961536
    s_mov_b32 s23, 0x20000
    s_mov_b32 s40, s64
    s_mov_b32 s41, s65
    s_mov_b32 s42, 2621440
    s_mov_b32 s43, 0x20000
    s_mov_b32 s44, s82
    s_mov_b32 s45, s83
    s_mov_b32 s46, 2621440
    s_mov_b32 s47, 0x20000
    v_mov_b32 v167, 0
    s_mul_i32 s6, s24, 7
    s_lshr_b32 s6, s6, 1
    s_lshl_b32 s6, s6, 2
    s_lshl_b32 s4, s28, 8
    s_add_u32 s4, s4, s6
    s_add_u32 s4, s4, 7981056
    v_and_b32 v165, 3, v1
    v_lshlrev_b32 v165, 2, v165
    s_mov_b32 s5, 0
    v_mov_b32 v4, 1
    s_cmp_lg_u32 s85, 3
    s_cbranch_scc1 K2_nu
    s_waitcnt vmcnt(0) lgkmcnt(0)
    s_barrier
    s_cmp_lg_u32 s24, 0
    s_cbranch_scc1 K2_us
    s_mov_b64 exec, 1
    buffer_atomic_add v4, v167, s[20:23], s7 offen
    s_mov_b64 exec, -1
K2_us:
    s_mov_b32 s7, 2130706432
    s_mov_b32 s85, 0
    s_branch K2_nu2
K2_nu:
    s_waitcnt lgkmcnt(0)
    s_barrier
K2_nu2:
    buffer_load_dword v166, v165, s[20:23], s4 offen sc1
    s_add_u32 s32, s3, 0
    s_and_b32 s32, s32, 1
    s_lshl_b32 s35, s32, 17
    s_add_u32 s35, s35, s37
    s_mul_i32 s34, s32, 5120
    s_add_u32 s34, s34, s36
    s_add_u32 m0, s33, 0
    s_nop 0
    buffer_load_dwordx4 v6, s[8:11], s35 offen offset:0  lds
    buffer_load_dwordx4 v7, s[8:11], s35 offen offset:1024  lds
    buffer_load_dwordx4 v8, s[8:11], s35 offen offset:2048  lds
    buffer_load_dwordx4 v9, s[8:11], s35 offen offset:3072  lds
    s_add_u32 s32, s3, 1
    s_and_b32 s32, s32, 1
    s_lshl_b32 s35, s32, 17
    s_add_u32 s35, s35, s37
    s_mul_i32 s34, s32, 5120
    s_add_u32 s34, s34, s36
    s_add_u32 m0, s33, 4096
    s_nop 0
    buffer_load_dwordx4 v6, s[8:11], s35 offen offset:0  lds
    buffer_load_dwordx4 v7, s[8:11], s35 offen offset:1024  lds
    buffer_load_dwordx4 v8, s[8:11], s35 offen offset:2048  lds
    buffer_load_dwordx4 v9, s[8:11], s35 offen offset:3072  lds
    s_add_u32 s32, s3, 0
    s_and_b32 s32, s32, 1
    s_add_u32 s32, s32, 2
    s_lshl_b32 s35, s32, 17
    s_add_u32 s35, s35, s37
    s_mul_i32 s34, s32, 5120
    s_add_u32 s34, s34, s36
    s_add_u32 m0, s33, 8192
    s_nop 0
    buffer_load_dwordx4 v6, s[8:11], s35 offen offset:0  lds
    buffer_load_dwordx4 v7, s[8:11], s35 offen offset:1024  lds
    buffer_load_dwordx4 v8, s[8:11], s35 offen offset:2048  lds
    buffer_load_dwordx4 v9, s[8:11], s35 offen offset:3072  lds
    s_waitcnt vmcnt(12)
    s_branch K2_chk2
K2_wu:
    s_cmp_eq_u32 s85, 1
    s_cbranch_scc1 K1a_o
K2_oback1:
    buffer_load_dword v166, v165, s[20:23], s4 offen sc1
    s_waitcnt vmcnt(0)
K2_chk2:
    v_cmp_eq_u32 vcc, 0, v166
    s_nop 0
    s_and_b32 s6, vcc_lo, 3
    s_cbranch_scc0 K2_wu_ok
    s_add_u32 s5, s5, 1
    s_cmp_ge_u32 s5, 0x40000
    s_cbranch_scc1 K2_wu_ok
    s_sleep 6
    s_branch K2_wu
K2_wu_ok:
    s_add_u32 s32, s3, 0
    s_and_b32 s32, s32, 1
    s_lshl_b32 s35, s32, 17
    s_add_u32 s35, s35, s37
    s_mul_i32 s34, s32, 5120
    s_add_u32 s34, s34, s36
    buffer_load_dwordx4 v[32:35], v10, s[12:15], s34 offen offset:0 sc1
    buffer_load_dwordx4 v[36:39], v10, s[12:15], s34 offen offset:1024 sc1
    buffer_load_dwordx4 v[40:43], v10, s[12:15], s34 offen offset:2048 sc1
    buffer_load_dwordx4 v[44:47], v10, s[12:15], s34 offen offset:3072 sc1
    buffer_load_dwordx4 v[48:51], v11, s[12:15], s34 offen sc1
    s_add_u32 s32, s3, 1
    s_and_b32 s32, s32, 1
    s_lshl_b32 s35, s32, 17
    s_add_u32 s35, s35, s37
    s_mul_i32 s34, s32, 5120
    s_add_u32 s34, s34, s36
    buffer_load_dwordx4 v[52:55], v10, s[12:15], s34 offen offset:0 sc1
    buffer_load_dwordx4 v[56:59], v10, s[12:15], s34 offen offset:1024 sc1
    buffer_load_dwordx4 v[60:63], v10, s[12:15], s34 offen offset:2048 sc1
    buffer_load_dwordx4 v[64:67], v10, s[12:15], s34 offen offset:3072 sc1
    buffer_load_dwordx4 v[68:71], v11, s[12:15], s34 offen sc1
    s_add_u32 s32, s3, 0
    s_and_b32 s32, s32, 1
    s_add_u32 s32, s32, 2
    s_lshl_b32 s35, s32, 17
    s_add_u32 s35, s35, s37
    s_mul_i32 s34, s32, 5120
    s_add_u32 s34, s34, s36
    buffer_load_dwordx4 v[72:75], v10, s[12:15], s34 offen offset:0 sc1
    buffer_load_dwordx4 v[76:79], v10, s[12:15], s34 offen offset:1024 sc1
    buffer_load_dwordx4 v[80:83], v10, s[12:15], s34 offen offset:2048 sc1
    buffer_load_dwordx4 v[84:87], v10, s[12:15], s34 offen offset:3072 sc1
    buffer_load_dwordx4 v[88:91], v11, s[12:15], s34 offen sc1
    s_cmp_lg_u32 s85, 1
    s_cbranch_scc1 K2_oback2
    s_mov_b32 s85, 2
    s_branch K1a_o
K2_oback2:
    s_nop 7
    s_waitcnt vmcnt(10)
    ds_read_b64_tr_b16 v[112:113], v12 offset:0
    ds_read_b64_tr_b16 v[114:115], v12 offset:2048
    ds_read_b64_tr_b16 v[116:117], v13 offset:0
    ds_read_b64_tr_b16 v[118:119], v13 offset:2048
    ds_read_b64_tr_b16 v[120:121], v14 offset:0
    ds_read_b64_tr_b16 v[122:123], v14 offset:2048
    ds_read_b64_tr_b16 v[124:125], v15 offset:0
    ds_read_b64_tr_b16 v[126:127], v15 offset:2048
    s_waitcnt lgkmcnt(0)
    s_add_u32 s32, s3, 1
    s_and_b32 s32, s32, 1
    s_add_u32 s32, s32, 2
    s_lshl_b32 s35, s32, 17
    s_add_u32 s35, s35, s37
    s_mul_i32 s34, s32, 5120
    s_add_u32 s34, s34, s36
    s_add_u32 m0, s33, 0
    v_mfma_f32_16x16x32_bf16 a[0:3], v[32:35], v[112:115], 0
    v_mfma_f32_16x16x32_bf16 a[4:7], v[32:35], v[116:119], 0
    buffer_load_dwordx4 v6, s[8:11], s35 offen offset:0 lds
    v_mfma_f32_16x16x32_bf16 a[8:11], v[32:35], v[120:123], 0
    v_mfma_f32_16x16x32_bf16 a[12:15], v[32:35], v[124:127], 0
    buffer_load_dwordx4 v[32:35], v10, s[12:15], s34 offen offset:0 sc1
    v_mfma_f32_16x16x32_bf16 a[16:19], v[36:39], v[112:115], 0
    v_mfma_f32_16x16x32_bf16 a[20:23], v[36:39], v[116:119], 0
    buffer_load_dwordx4 v7, s[8:11], s35 offen offset:1024 lds
    v_mfma_f32_16x16x32_bf16 a[24:27], v[36:39], v[120:123], 0
    v_mfma_f32_16x16x32_bf16 a[28:31], v[36:39], v[124:127], 0
    buffer_load_dwordx4 v[36:39], v10, s[12:15], s34 offen offset:1024 sc1
    v_mfma_f32_16x16x32_bf16 a[32:35], v[40:43], v[112:115], 0
    v_mfma_f32_16x16x32_bf16 a[36:39], v[40:43], v[116:119], 0
    buffer_load_dwordx4 v8, s[8:11], s35 offen offset:2048 lds
    v_mfma_f32_16x16x32_bf16 a[40:43], v[40:43], v[120:123], 0
    v_mfma_f32_16x16x32_bf16 a[44:47], v[40:43], v[124:127], 0
    buffer_load_dwordx4 v[40:43], v10, s[12:15], s34 offen offset:2048 sc1
    v_mfma_f32_16x16x32_bf16 a[48:51], v[44:47], v[112:115], 0
    v_mfma_f32_16x16x32_bf16 a[52:55], v[44:47], v[116:119], 0
    buffer_load_dwordx4 v9, s[8:11], s35 offen offset:3072 lds
    v_mfma_f32_16x16x32_bf16 a[56:59], v[44:47], v[120:123], 0
    v_mfma_f32_16x16x32_bf16 a[60:63], v[44:47], v[124:127], 0
    buffer_load_dwordx4 v[44:47], v10, s[12:15], s34 offen offset:3072 sc1
    s_waitcnt vmcnt(13)
    ds_read_b64_tr_b16 v[128:129], v12 offset:4096
    ds_read_b64_tr_b16 v[130:131], v12 offset:6144
    ds_read_b64_tr_b16 v[132:133], v13 offset:4096
    ds_read_b64_tr_b16 v[134:135], v13 offset:6144
    ds_read_b64_tr_b16 v[136:137], v14 offset:4096
    ds_read_b64_tr_b16 v[138:139], v14 offset:6144
    ds_read_b64_tr_b16 v[140:141], v15 offset:4096
    ds_read_b64_tr_b16 v[142:143], v15 offset:6144
    v_mfma_f32_16x16x32_bf16 a[64:67], v[48:51], v[112:115], 0
    v_mfma_f32_16x16x32_bf16 a[68:71], v[48:51], v[116:119], 0
    v_mfma_f32_16x16x32_bf16 a[72:75], v[48:51], v[120:123], 0
    v_mfma_f32_16x16x32_bf16 a[76:79], v[48:51], v[124:127], 0
    buffer_load_dwordx4 v[48:51], v11, s[12:15], s34 offen sc1
    buffer_load_dword v166, v165, s[20:23], s4 offen sc1
    s_waitcnt lgkmcnt(0)
    s_add_u32 s32, s3, 0
    s_and_b32 s32, s32, 1
    s_add_u32 s32, s32, 4
    s_lshl_b32 s35, s32, 17
    s_add_u32 s35, s35, s37
    s_mul_i32 s34, s32, 5120
    s_add_u32 s34, s34, s36
    s_add_u32 m0, s33, 4096
    v_mfma_f32_16x16x32_bf16 a[0:3], v[52:55], v[128:131], a[0:3]
    v_mfma_f32_16x16x32_bf16 a[4:7], v[52:55], v[132:135], a[4:7]
    buffer_load_dwordx4 v6, s[8:11], s35 offen offset:0 lds
    v_mfma_f32_16x16x32_bf16 a[8:11], v[52:55], v[136:139], a[8:11]
    v_mfma_f32_16x16x32_bf16 a[12:15], v[52:55], v[140:143], a[12:15]
    buffer_load_dwordx4 v[52:55], v10, s[12:15], s34 offen offset:0 sc1
    v_mfma_f32_16x16x32_bf16 a[16:19], v[56:59], v[128:131], a[16:19]
    v_mfma_f32_16x16x32_bf16 a[20:23], v[56:59], v[132:135], a[20:23]
    buffer_load_dwordx4 v7, s[8:11], s35 offen offset:1024 lds
    v_mfma_f32_16x16x32_bf16 a[24:27], v[56:59], v[136:139], a[24:27]
    v_mfma_f32_16x16x32_bf16 a[28:31], v[56:59], v[140:143], a[28:31]
    buffer_load_dwordx4 v[56:59], v10, s[12:15], s34 offen offset:1024 sc1
    v_mfma_f32_16x16x32_bf16 a[32:35], v[60:63], v[128:131], a[32:35]
    v_mfma_f32_16x16x32_bf16 a[36:39], v[60:63], v[132:135], a[36:39]
    buffer_load_dwordx4 v8, s[8:11], s35 offen offset:2048 lds
    v_mfma_f32_16x16x32_bf16 a[40:43], v[60:63], v[136:139], a[40:43]
    v_mfma_f32_16x16x32_bf16 a[44:47], v[60:63], v[140:143], a[44:47]
    buffer_load_dwordx4 v[60:63], v10, s[12:15], s34 offen offset:2048 sc1
    v_mfma_f32_16x16x32_bf16 a[48:51], v[64:67], v[128:131], a[48:51]
    v_mfma_f32_16x16x32_bf16 a[52:55], v[64:67], v[132:135], a[52:55]
    buffer_load_dwordx4 v9, s[8:11], s35 offen offset:3072 lds
    v_mfma_f32_16x16x32_bf16 a[56:59], v[64:67], v[136:139], a[56:59]
    v_mfma_f32_16x16x32_bf16 a[60:63], v[64:67], v[140:143], a[60:63]
    buffer_load_dwordx4 v[64:67], v10, s[12:15], s34 offen offset:3072 sc1
    s_waitcnt vmcnt(18)
    ds_read_b64_tr_b16 v[144:145], v12 offset:8192
    ds_read_b64_tr_b16 v[146:147], v12 offset:10240
    ds_read_b64_tr_b16 v[148:149], v13 offset:8192
    ds_read_b64_tr_b16 v[150:151], v13 offset:10240
    ds_read_b64_tr_b16 v[152:153], v14 offset:8192
    ds_read_b64_tr_b16 v[154:155], v14 offset:10240
    ds_read_b64_tr_b16 v[156:157], v15 offset:8192
    ds_read_b64_tr_b16 v[158:159], v15 offset:10240
    v_mfma_f32_16x16x32_bf16 a[64:67], v[68:71], v[128:131], a[64:67]
    v_mfma_f32_16x16x32_bf16 a[68:71], v[68:71], v[132:135], a[68:71]
    v_mfma_f32_16x16x32_bf16 a[72:75], v[68:71], v[136:139], a[72:75]
    v_mfma_f32_16x16x32_bf16 a[76:79], v[68:71], v[140:143], a[76:79]
    buffer_load_dwordx4 v[68:71], v11, s[12:15], s34 offen sc1
    s_waitcnt lgkmcnt(0)
    s_add_u32 s32, s3, 1
    s_and_b32 s32, s32, 1
    s_add_u32 s32, s32, 4
    s_lshl_b32 s35, s32, 17
    s_add_u32 s35, s35, s37
    s_mul_i32 s34, s32, 5120
    s_add_u32 s34, s34, s36
    s_add_u32 m0, s33, 8192
    v_mfma_f32_16x16x32_bf16 a[0:3], v[72:75], v[144:147], a[0:3]
    v_mfma_f32_16x16x32_bf16 a[4:7], v[72:75], v[148:151], a[4:7]
    buffer_load_dwordx4 v6, s[8:11], s35 offen offset:0 lds
    v_mfma_f32_16x16x32_bf16 a[8:11], v[72:75], v[152:155], a[8:11]
    v_mfma_f32_16x16x32_bf16 a[12:15], v[72:75], v[156:159], a[12:15]
    buffer_load_dwordx4 v[72:75], v10, s[12:15], s34 offen offset:0 sc1
    v_mfma_f32_16x16x32_bf16 a[16:19], v[76:79], v[144:147], a[16:19]
    v_mfma_f32_16x16x32_bf16 a[20:23], v[76:79], v[148:151], a[20:23]
    buffer_load_dwordx4 v7, s[8:11], s35 offen offset:1024 lds
    v_mfma_f32_16x16x32_bf16 a[24:27], v[76:79], v[152:155], a[24:27]
    v_mfma_f32_16x16x32_bf16 a[28:31], v[76:79], v[156:159], a[28:31]
    buffer_load_dwordx4 v[76:79], v10, s[12:15], s34 offen offset:1024 sc1
    v_mfma_f32_16x16x32_bf16 a[32:35], v[80:83], v[144:147], a[32:35]
    v_mfma_f32_16x16x32_bf16 a[36:39], v[80:83], v[148:151], a[36:39]
    buffer_load_dwordx4 v8, s[8:11], s35 offen offset:2048 lds
    v_mfma_f32_16x16x32_bf16 a[40:43], v[80:83], v[152:155], a[40:43]
    v_mfma_f32_16x16x32_bf16 a[44:47], v[80:83], v[156:159], a[44:47]
    buffer_load_dwordx4 v[80:83], v10, s[12:15], s34 offen offset:2048 sc1
    v_mfma_f32_16x16x32_bf16 a[48:51], v[84:87], v[144:147], a[48:51]
    v_mfma_f32_16x16x32_bf16 a[52:55], v[84:87], v[148:151], a[52:55]
    buffer_load_dwordx4 v9, s[8:11], s35 offen offset:3072 lds
    v_mfma_f32_16x16x32_bf16 a[56:59], v[84:87], v[152:155], a[56:59]
    v_mfma_f32_16x16x32_bf16 a[60:63], v[84:87], v[156:159], a[60:63]
    buffer_load_dwordx4 v[84:87], v10, s[12:15], s34 offen offset:3072 sc1
    s_waitcnt vmcnt(18)
    ds_read_b64_tr_b16 v[112:113], v12 offset:0
    ds_read_b64_tr_b16 v[114:115], v12 offset:2048
    ds_read_b64_tr_b16 v[116:117], v13 offset:0
    ds_read_b64_tr_b16 v[118:119], v13 offset:2048
    ds_read_b64_tr_b16 v[120:121], v14 offset:0
    ds_read_b64_tr_b16 v[122:123], v14 offset:2048
    ds_read_b64_tr_b16 v[124:125], v15 offset:0
    ds_read_b64_tr_b16 v[126:127], v15 offset:2048
    v_mfma_f32_16x16x32_bf16 a[64:67], v[88:91], v[144:147], a[64:67]
    v_mfma_f32_16x16x32_bf16 a[68:71], v[88:91], v[148:151], a[68:71]
    v_mfma_f32_16x16x32_bf16 a[72:75], v[88:91], v[152:155], a[72:75]
    v_mfma_f32_16x16x32_bf16 a[76:79], v[88:91], v[156:159], a[76:79]
    buffer_load_dwordx4 v[88:91], v11, s[12:15], s34 offen sc1
    s_waitcnt vmcnt(18)
    s_mov_b32 s5, 0
K2_w2:
    v_cmp_eq_u32 vcc, 0, v166
    s_nop 0
    s_and_b32 s6, vcc_lo, 15
    s_cbranch_scc0 K2_w2_ok
    s_add_u32 s5, s5, 1
    s_cmp_ge_u32 s5, 0x40000
    s_cbranch_scc1 K2_w2_ok
    s_sleep 1
    buffer_load_dword v166, v165, s[20:23], s4 offen sc1
    s_waitcnt vmcnt(0)
    s_branch K2_w2
K2_w2_ok:
    s_lshr_b32 s4, s27, 1
    s_lshl_b32 s4, s4, 8
    s_add_u32 s4, s4, 7983104
    s_waitcnt lgkmcnt(0)
    s_add_u32 s32, s3, 0
    s_and_b32 s32, s32, 1
    s_add_u32 s32, s32, 6
    s_lshl_b32 s35, s32, 17
    s_add_u32 s35, s35, s37
    s_mul_i32 s34, s32, 5120
    s_add_u32 s34, s34, s36
    s_add_u32 m0, s33, 0
    v_mfma_f32_16x16x32_bf16 a[0:3], v[32:35], v[112:115], a[0:3]
    v_mfma_f32_16x16x32_bf16 a[4:7], v[32:35], v[116:119], a[4:7]
    buffer_load_dwordx4 v6, s[8:11], s35 offen offset:0 lds
    v_mfma_f32_16x16x32_bf16 a[8:11], v[32:35], v[120:123], a[8:11]
    v_mfma_f32_16x16x32_bf16 a[12:15], v[32:35], v[124:127], a[12:15]
    buffer_load_dwordx4 v[32:35], v10, s[12:15], s34 offen offset:0 sc1
    v_mfma_f32_16x16x32_bf16 a[16:19], v[36:39], v[112:115], a[16:19]
    v_mfma_f32_16x16x32_bf16 a[20:23], v[36:39], v[116:119], a[20:23]
    buffer_load_dwordx4 v7, s[8:11], s35 offen offset:1024 lds
    v_mfma_f32_16x16x32_bf16 a[24:27], v[36:39], v[120:123], a[24:27]
    v_mfma_f32_16x16x32_bf16 a[28:31], v[36:39], v[124:127], a[28:31]
    buffer_load_dwordx4 v[36:39], v10, s[12:15], s34 offen offset:1024 sc1
    v_mfma_f32_16x16x32_bf16 a[32:35], v[40:43], v[112:115], a[32:35]
    v_mfma_f32_16x16x32_bf16 a[36:39], v[40:43], v[116:119], a[36:39]
    buffer_load_dwordx4 v8, s[8:11], s35 offen offset:2048 lds
    v_mfma_f32_16x16x32_bf16 a[40:43], v[40:43], v[120:123], a[40:43]
    v_mfma_f32_16x16x32_bf16 a[44:47], v[40:43], v[124:127], a[44:47]
    buffer_load_dwordx4 v[40:43], v10, s[12:15], s34 offen offset:2048 sc1
    v_mfma_f32_16x16x32_bf16 a[48:51], v[44:47], v[112:115], a[48:51]
    v_mfma_f32_16x16x32_bf16 a[52:55], v[44:47], v[116:119], a[52:55]
    buffer_load_dwordx4 v9, s[8:11], s35 offen offset:3072 lds
    v_mfma_f32_16x16x32_bf16 a[56:59], v[44:47], v[120:123], a[56:59]
    v_mfma_f32_16x16x32_bf16 a[60:63], v[44:47], v[124:127], a[60:63]
    buffer_load_dwordx4 v[44:47], v10, s[12:15], s34 offen offset:3072 sc1
    s_waitcnt vmcnt(17)
    ds_read_b64_tr_b16 v[128:129], v12 offset:4096
    ds_read_b64_tr_b16 v[130:131], v12 offset:6144
    ds_read_b64_tr_b16 v[132:133], v13 offset:4096
    ds_read_b64_tr_b16 v[134:135], v13 offset:6144
    ds_read_b64_tr_b16 v[136:137], v14 offset:4096
    ds_read_b64_tr_b16 v[138:139], v14 offset:6144
    ds_read_b64_tr_b16 v[140:141], v15 offset:4096
    ds_read_b64_tr_b16 v[142:143], v15 offset:6144
    v_mfma_f32_16x16x32_bf16 a[64:67], v[48:51], v[112:115], a[64:67]
    v_mfma_f32_16x16x32_bf16 a[68:71], v[48:51], v[116:119], a[68:71]
    v_mfma_f32_16x16x32_bf16 a[72:75], v[48:51], v[120:123], a[72:75]
    v_mfma_f32_16x16x32_bf16 a[76:79], v[48:51], v[124:127], a[76:79]
    buffer_load_dwordx4 v[48:51], v11, s[12:15], s34 offen sc1
    s_waitcnt lgkmcnt(0)
    s_add_u32 s32, s3, 1
    s_and_b32 s32, s32, 1
    s_add_u32 s32, s32, 6
    s_lshl_b32 s35, s32, 17
    s_add_u32 s35, s35, s37
    s_mul_i32 s34, s32, 5120
    s_add_u32 s34, s34, s36
    s_add_u32 m0, s33, 4096
    v_mfma_f32_16x16x32_bf16 a[0:3], v[52:55], v[128:131], a[0:3]
    v_mfma_f32_16x16x32_bf16 a[4:7], v[52:55], v[132:135], a[4:7]
    buffer_load_dwordx4 v6, s[8:11], s35 offen offset:0 lds
    v_mfma_f32_16x16x32_bf16 a[8:11], v[52:55], v[136:139], a[8:11]
    v_mfma_f32_16x16x32_bf16 a[12:15], v[52:55], v[140:143], a[12:15]
    buffer_load_dwordx4 v[52:55], v10, s[12:15], s34 offen offset:0 sc1
    v_mfma_f32_16x16x32_bf16 a[16:19], v[56:59], v[128:131], a[16:19]
    v_mfma_f32_16x16x32_bf16 a[20:23], v[56:59], v[132:135], a[20:23]
    buffer_load_dwordx4 v7, s[8:11], s35 offen offset:1024 lds
    v_mfma_f32_16x16x32_bf16 a[24:27], v[56:59], v[136:139], a[24:27]
    v_mfma_f32_16x16x32_bf16 a[28:31], v[56:59], v[140:143], a[28:31]
    buffer_load_dwordx4 v[56:59], v10, s[12:15], s34 offen offset:1024 sc1
    v_mfma_f32_16x16x32_bf16 a[32:35], v[60:63], v[128:131], a[32:35]
    v_mfma_f32_16x16x32_bf16 a[36:39], v[60:63], v[132:135], a[36:39]
    buffer_load_dwordx4 v8, s[8:11], s35 offen offset:2048 lds
    v_mfma_f32_16x16x32_bf16 a[40:43], v[60:63], v[136:139], a[40:43]
    v_mfma_f32_16x16x32_bf16 a[44:47], v[60:63], v[140:143], a[44:47]
    buffer_load_dwordx4 v[60:63], v10, s[12:15], s34 offen offset:2048 sc1
    v_mfma_f32_16x16x32_bf16 a[48:51], v[64:67], v[128:131], a[48:51]
    v_mfma_f32_16x16x32_bf16 a[52:55], v[64:67], v[132:135], a[52:55]
    buffer_load_dwordx4 v9, s[8:11], s35 offen offset:3072 lds
    v_mfma_f32_16x16x32_bf16 a[56:59], v[64:67], v[136:139], a[56:59]
    v_mfma_f32_16x16x32_bf16 a[60:63], v[64:67], v[140:143], a[60:63]
    buffer_load_dwordx4 v[64:67], v10, s[12:15], s34 offen offset:3072 sc1
    s_waitcnt vmcnt(17)
    ds_read_b64_tr_b16 v[144:145], v12 offset:8192
    ds_read_b64_tr_b16 v[146:147], v12 offset:10240
    ds_read_b64_tr_b16 v[148:149], v13 offset:8192
    ds_read_b64_tr_b16 v[150:151], v13 offset:10240
    ds_read_b64_tr_b16 v[152:153], v14 offset:8192
    ds_read_b64_tr_b16 v[154:155], v14 offset:10240
    ds_read_b64_tr_b16 v[156:157], v15 offset:8192
    ds_read_b64_tr_b16 v[158:159], v15 offset:10240
    v_mfma_f32_16x16x32_bf16 a[64:67], v[68:71], v[128:131], a[64:67]
    v_mfma_f32_16x16x32_bf16 a[68:71], v[68:71], v[132:135], a[68:71]
    v_mfma_f32_16x16x32_bf16 a[72:75], v[68:71], v[136:139], a[72:75]
    v_mfma_f32_16x16x32_bf16 a[76:79], v[68:71], v[140:143], a[76:79]
    buffer_load_dwordx4 v[68:71], v11, s[12:15], s34 offen sc1
    s_barrier
    s_cmp_lg_u32 s24, 0
    s_cbranch_scc1 K2_nosig
    v_mov_b32 v165, 1
    s_mov_b64 exec, 1
    buffer_atomic_add v165, v167, s[20:23], s7 offen
    s_mov_b64 exec, -1
K2_nosig:
    s_waitcnt lgkmcnt(0)
    s_add_u32 s32, s3, 0
    s_and_b32 s32, s32, 1
    s_add_u32 s32, s32, 8
    s_lshl_b32 s35, s32, 17
    s_add_u32 s35, s35, s37
    s_mul_i32 s34, s32, 5120
    s_add_u32 s34, s34, s36
    s_add_u32 m0, s33, 8192
    v_mfma_f32_16x16x32_bf16 a[0:3], v[72:75], v[144:147], a[0:3]
    v_mfma_f32_16x16x32_bf16 a[4:7], v[72:75], v[148:151], a[4:7]
    buffer_load_dwordx4 v6, s[8:11], s35 offen offset:0 lds
    v_mfma_f32_16x16x32_bf16 a[8:11], v[72:75], v[152:155], a[8:11]
    v_mfma_f32_16x16x32_bf16 a[12:15], v[72:75], v[156:159], a[12:15]
    buffer_load_dwordx4 v[72:75], v10, s[12:15], s34 offen offset:0 sc1
    v_mfma_f32_16x16x32_bf16 a[16:19], v[76:79], v[144:147], a[16:19]
    v_mfma_f32_16x16x32_bf16 a[20:23], v[76:79], v[148:151], a[20:23]
    buffer_load_dwordx4 v7, s[8:11], s35 offen offset:1024 lds
    v_mfma_f32_16x16x32_bf16 a[24:27], v[76:79], v[152:155], a[24:27]
    v_mfma_f32_16x16x32_bf16 a[28:31], v[76:79], v[156:159], a[28:31]
    buffer_load_dwordx4 v[76:79], v10, s[12:15], s34 offen offset:1024 sc1
    v_mfma_f32_16x16x32_bf16 a[32:35], v[80:83], v[144:147], a[32:35]
    v_mfma_f32_16x16x32_bf16 a[36:39], v[80:83], v[148:151], a[36:39]
    buffer_load_dwordx4 v8, s[8:11], s35 offen offset:2048 lds
    v_mfma_f32_16x16x32_bf16 a[40:43], v[80:83], v[152:155], a[40:43]
    v_mfma_f32_16x16x32_bf16 a[44:47], v[80:83], v[156:159], a[44:47]
    buffer_load_dwordx4 v[80:83], v10, s[12:15], s34 offen offset:2048 sc1
    v_mfma_f32_16x16x32_bf16 a[48:51], v[84:87], v[144:147], a[48:51]
    v_mfma_f32_16x16x32_bf16 a[52:55], v[84:87], v[148:151], a[52:55]
    buffer_load_dwordx4 v9, s[8:11], s35 offen offset:3072 lds
    v_mfma_f32_16x16x32_bf16 a[56:59], v[84:87], v[152:155], a[56:59]
    v_mfma_f32_16x16x32_bf16 a[60:63], v[84:87], v[156:159], a[60:63]
    buffer_load_dwordx4 v[84:87], v10, s[12:15], s34 offen offset:3072 sc1
    s_waitcnt vmcnt(17)
    ds_read_b64_tr_b16 v[112:113], v12 offset:0
    ds_read_b64_tr_b16 v[114:115], v12 offset:2048
    ds_read_b64_tr_b16 v[116:117], v13 offset:0
    ds_read_b64_tr_b16 v[118:119], v13 offset:2048
    ds_read_b64_tr_b16 v[120:121], v14 offset:0
    ds_read_b64_tr_b16 v[122:123], v14 offset:2048
    ds_read_b64_tr_b16 v[124:125], v15 offset:0
    ds_read_b64_tr_b16 v[126:127], v15 offset:2048
    v_mfma_f32_16x16x32_bf16 a[64:67], v[88:91], v[144:147], a[64:67]
    v_mfma_f32_16x16x32_bf16 a[68:71], v[88:91], v[148:151], a[68:71]
    v_mfma_f32_16x16x32_bf16 a[72:75], v[88:91], v[152:155], a[72:75]
    v_mfma_f32_16x16x32_bf16 a[76:79], v[88:91], v[156:159], a[76:79]
    buffer_load_dwordx4 v[88:91], v11, s[12:15], s34 offen sc1
    s_waitcnt lgkmcnt(0)
    s_add_u32 s32, s3, 1
    s_and_b32 s32, s32, 1
    s_add_u32 s32, s32, 8
    s_lshl_b32 s35, s32, 17
    s_add_u32 s35, s35, s37
    s_mul_i32 s34, s32, 5120
    s_add_u32 s34, s34, s36
    s_add_u32 m0, s33, 0
    v_mfma_f32_16x16x32_bf16 a[0:3], v[32:35], v[112:115], a[0:3]
    v_mfma_f32_16x16x32_bf16 a[4:7], v[32:35], v[116:119], a[4:7]
    buffer_load_dwordx4 v6, s[8:11], s35 offen offset:0 lds
    v_mfma_f32_16x16x32_bf16 a[8:11], v[32:35], v[120:123], a[8:11]
    v_mfma_f32_16x16x32_bf16 a[12:15], v[32:35], v[124:127], a[12:15]
    buffer_load_dwordx4 v[32:35], v10, s[12:15], s34 offen offset:0 sc1
    v_mfma_f32_16x16x32_bf16 a[16:19], v[36:39], v[112:115], a[16:19]
    v_mfma_f32_16x16x32_bf16 a[20:23], v[36:39], v[116:119], a[20:23]
    buffer_load_dwordx4 v7, s[8:11], s35 offen offset:1024 lds
    v_mfma_f32_16x16x32_bf16 a[24:27], v[36:39], v[120:123], a[24:27]
    v_mfma_f32_16x16x32_bf16 a[28:31], v[36:39], v[124:127], a[28:31]
    buffer_load_dwordx4 v[36:39], v10, s[12:15], s34 offen offset:1024 sc1
    v_mfma_f32_16x16x32_bf16 a[32:35], v[40:43], v[112:115], a[32:35]
    v_mfma_f32_16x16x32_bf16 a[36:39], v[40:43], v[116:119], a[36:39]
    buffer_load_dwordx4 v8, s[8:11], s35 offen offset:2048 lds
    v_mfma_f32_16x16x32_bf16 a[40:43], v[40:43], v[120:123], a[40:43]
    v_mfma_f32_16x16x32_bf16 a[44:47], v[40:43], v[124:127], a[44:47]
    buffer_load_dwordx4 v[40:43], v10, s[12:15], s34 offen offset:2048 sc1
    v_mfma_f32_16x16x32_bf16 a[48:51], v[44:47], v[112:115], a[48:51]
    v_mfma_f32_16x16x32_bf16 a[52:55], v[44:47], v[116:119], a[52:55]
    buffer_load_dwordx4 v9, s[8:11], s35 offen offset:3072 lds
    v_mfma_f32_16x16x32_bf16 a[56:59], v[44:47], v[120:123], a[56:59]
    v_mfma_f32_16x16x32_bf16 a[60:63], v[44:47], v[124:127], a[60:63]
    buffer_load_dwordx4 v[44:47], v10, s[12:15], s34 offen offset:3072 sc1
    s_waitcnt vmcnt(17)
    ds_read_b64_tr_b16 v[128:129], v12 offset:4096
    ds_read_b64_tr_b16 v[130:131], v12 offset:6144
    ds_read_b64_tr_b16 v[132:133], v13 offset:4096
    ds_read_b64_tr_b16 v[134:135], v13 offset:6144
    ds_read_b64_tr_b16 v[136:137], v14 offset:4096
    ds_read_b64_tr_b16 v[138:139], v14 offset:6144
    ds_read_b64_tr_b16 v[140:141], v15 offset:4096
    ds_read_b64_tr_b16 v[142:143], v15 offset:6144
    v_mfma_f32_16x16x32_bf16 a[64:67], v[48:51], v[112:115], a[64:67]
    v_mfma_f32_16x16x32_bf16 a[68:71], v[48:51], v[116:119], a[68:71]
    v_mfma_f32_16x16x32_bf16 a[72:75], v[48:51], v[120:123], a[72:75]
    v_mfma_f32_16x16x32_bf16 a[76:79], v[48:51], v[124:127], a[76:79]
    buffer_load_dwordx4 v[48:51], v11, s[12:15], s34 offen sc1
    buffer_load_dword v166, v167, s[20:23], s4 offen sc1
    s_waitcnt lgkmcnt(0)
    s_add_u32 s32, s3, 0
    s_and_b32 s32, s32, 1
    s_add_u32 s32, s32, 10
    s_lshl_b32 s35, s32, 17
    s_add_u32 s35, s35, s37
    s_mul_i32 s34, s32, 5120
    s_add_u32 s34, s34, s36
    s_add_u32 m0, s33, 4096
    v_mfma_f32_16x16x32_bf16 a[0:3], v[52:55], v[128:131], a[0:3]
    v_mfma_f32_16x16x32_bf16 a[4:7], v[52:55], v[132:135], a[4:7]
    buffer_load_dwordx4 v6, s[8:11], s35 offen offset:0 lds
    v_mfma_f32_16x16x32_bf16 a[8:11], v[52:55], v[136:139], a[8:11]
    v_mfma_f32_16x16x32_bf16 a[12:15], v[52:55], v[140:143], a[12:15]
    buffer_load_dwordx4 v[52:55], v10, s[12:15], s34 offen offset:0 sc1
    v_mfma_f32_16x16x32_bf16 a[16:19], v[56:59], v[128:131], a[16:19]
    v_mfma_f32_16x16x32_bf16 a[20:23], v[56:59], v[132:135], a[20:23]
    buffer_load_dwordx4 v7, s[8:11], s35 offen offset:1024 lds
    v_mfma_f32_16x16x32_bf16 a[24:27], v[56:59], v[136:139], a[24:27]
    v_mfma_f32_16x16x32_bf16 a[28:31], v[56:59], v[140:143], a[28:31]
    buffer_load_dwordx4 v[56:59], v10, s[12:15], s34 offen offset:1024 sc1
    v_mfma_f32_16x16x32_bf16 a[32:35], v[60:63], v[128:131], a[32:35]
    v_mfma_f32_16x16x32_bf16 a[36:39], v[60:63], v[132:135], a[36:39]
    buffer_load_dwordx4 v8, s[8:11], s35 offen offset:2048 lds
    v_mfma_f32_16x16x32_bf16 a[40:43], v[60:63], v[136:139], a[40:43]
    v_mfma_f32_16x16x32_bf16 a[44:47], v[60:63], v[140:143], a[44:47]
    buffer_load_dwordx4 v[60:63], v10, s[12:15], s34 offen offset:2048 sc1
    v_mfma_f32_16x16x32_bf16 a[48:51], v[64:67], v[128:131], a[48:51]
    v_mfma_f32_16x16x32_bf16 a[52:55], v[64:67], v[132:135], a[52:55]
    buffer_load_dwordx4 v9, s[8:11], s35 offen offset:3072 lds
    v_mfma_f32_16x16x32_bf16 a[56:59], v[64:67], v[136:139], a[56:59]
    v_mfma_f32_16x16x32_bf16 a[60:63], v[64:67], v[140:143], a[60:63]
    buffer_load_dwordx4 v[64:67], v10, s[12:15], s34 offen offset:3072 sc1
    s_waitcnt vmcnt(18)
    ds_read_b64_tr_b16 v[144:145], v12 offset:8192
    ds_read_b64_tr_b16 v[146:147], v12 offset:10240
    ds_read_b64_tr_b16 v[148:149], v13 offset:8192
    ds_read_b64_tr_b16 v[150:151], v13 offset:10240
    ds_read_b64_tr_b16 v[152:153], v14 offset:8192
    ds_read_b64_tr_b16 v[154:155], v14 offset:10240
    ds_read_b64_tr_b16 v[156:157], v15 offset:8192
    ds_read_b64_tr_b16 v[158:159], v15 offset:10240
    v_mfma_f32_16x16x32_bf16 a[64:67], v[68:71], v[128:131], a[64:67]
    v_mfma_f32_16x16x32_bf16 a[68:71], v[68:71], v[132:135], a[68:71]
    v_mfma_f32_16x16x32_bf16 a[72:75], v[68:71], v[136:139], a[72:75]
    v_mfma_f32_16x16x32_bf16 a[76:79], v[68:71], v[140:143], a[76:79]
    buffer_load_dwordx4 v[68:71], v11, s[12:15], s34 offen sc1
    s_waitcnt lgkmcnt(0)
    s_add_u32 s32, s3, 1
    s_and_b32 s32, s32, 1
    s_add_u32 s32, s32, 10
    s_lshl_b32 s35, s32, 17
    s_add_u32 s35, s35, s37
    s_mul_i32 s34, s32, 5120
    s_add_u32 s34, s34, s36
    s_add_u32 m0, s33, 8192
    v_mfma_f32_16x16x32_bf16 a[0:3], v[72:75], v[144:147], a[0:3]
    v_mfma_f32_16x16x32_bf16 a[4:7], v[72:75], v[148:151], a[4:7]
    buffer_load_dwordx4 v6, s[8:11], s35 offen offset:0 lds
    v_mfma_f32_16x16x32_bf16 a[8:11], v[72:75], v[152:155], a[8:11]
    v_mfma_f32_16x16x32_bf16 a[12:15], v[72:75], v[156:159], a[12:15]
    buffer_load_dwordx4 v[72:75], v10, s[12:15], s34 offen offset:0 sc1
    v_mfma_f32_16x16x32_bf16 a[16:19], v[76:79], v[144:147], a[16:19]
    v_mfma_f32_16x16x32_bf16 a[20:23], v[76:79], v[148:151], a[20:23]
    buffer_load_dwordx4 v7, s[8:11], s35 offen offset:1024 lds
    v_mfma_f32_16x16x32_bf16 a[24:27], v[76:79], v[152:155], a[24:27]
    v_mfma_f32_16x16x32_bf16 a[28:31], v[76:79], v[156:159], a[28:31]
    buffer_load_dwordx4 v[76:79], v10, s[12:15], s34 offen offset:1024 sc1
    v_mfma_f32_16x16x32_bf16 a[32:35], v[80:83], v[144:147], a[32:35]
    v_mfma_f32_16x16x32_bf16 a[36:39], v[80:83], v[148:151], a[36:39]
    buffer_load_dwordx4 v8, s[8:11], s35 offen offset:2048 lds
    v_mfma_f32_16x16x32_bf16 a[40:43], v[80:83], v[152:155], a[40:43]
    v_mfma_f32_16x16x32_bf16 a[44:47], v[80:83], v[156:159], a[44:47]
    buffer_load_dwordx4 v[80:83], v10, s[12:15], s34 offen offset:2048 sc1
    v_mfma_f32_16x16x32_bf16 a[48:51], v[84:87], v[144:147], a[48:51]
    v_mfma_f32_16x16x32_bf16 a[52:55], v[84:87], v[148:151], a[52:55]
    buffer_load_dwordx4 v9, s[8:11], s35 offen offset:3072 lds
    v_mfma_f32_16x16x32_bf16 a[56:59], v[84:87], v[152:155], a[56:59]
    v_mfma_f32_16x16x32_bf16 a[60:63], v[84:87], v[156:159], a[60:63]
    buffer_load_dwordx4 v[84:87], v10, s[12:15], s34 offen offset:3072 sc1
    s_waitcnt vmcnt(18)
    ds_read_b64_tr_b16 v[112:113], v12 offset:0
    ds_read_b64_tr_b16 v[114:115], v12 offset:2048
    ds_read_b64_tr_b16 v[116:117], v13 offset:0
    ds_read_b64_tr_b16 v[118:119], v13 offset:2048
    ds_read_b64_tr_b16 v[120:121], v14 offset:0
    ds_read_b64_tr_b16 v[122:123], v14 offset:2048
    ds_read_b64_tr_b16 v[124:125], v15 offset:0
    ds_read_b64_tr_b16 v[126:127], v15 offset:2048
    v_mfma_f32_16x16x32_bf16 a[64:67], v[88:91], v[144:147], a[64:67]
    v_mfma_f32_16x16x32_bf16 a[68:71], v[88:91], v[148:151], a[68:71]
    v_mfma_f32_16x16x32_bf16 a[72:75], v[88:91], v[152:155], a[72:75]
    v_mfma_f32_16x16x32_bf16 a[76:79], v[88:91], v[156:159], a[76:79]
    buffer_load_dwordx4 v[88:91], v11, s[12:15], s34 offen sc1
    s_waitcnt lgkmcnt(0)
    s_add_u32 s32, s3, 0
    s_and_b32 s32, s32, 1
    s_add_u32 s32, s32, 12
    s_lshl_b32 s35, s32, 17
    s_add_u32 s35, s35, s37
    s_mul_i32 s34, s32, 5120
    s_add_u32 s34, s34, s36
    s_add_u32 m0, s33, 0
    v_mfma_f32_16x16x32_bf16 a[0:3], v[32:35], v[112:115], a[0:3]
    v_mfma_f32_16x16x32_bf16 a[4:7], v[32:35], v[116:119], a[4:7]
    buffer_load_dwordx4 v6, s[8:11], s35 offen offset:0 lds
    v_mfma_f32_16x16x32_bf16 a[8:11], v[32:35], v[120:123], a[8:11]
    v_mfma_f32_16x16x32_bf16 a[12:15], v[32:35], v[124:127], a[12:15]
    buffer_load_dwordx4 v[32:35], v10, s[12:15], s34 offen offset:0 sc1
    v_mfma_f32_16x16x32_bf16 a[16:19], v[36:39], v[112:115], a[16:19]
    v_mfma_f32_16x16x32_bf16 a[20:23], v[36:39], v[116:119], a[20:23]
    buffer_load_dwordx4 v7, s[8:11], s35 offen offset:1024 lds
    v_mfma_f32_16x16x32_bf16 a[24:27], v[36:39], v[120:123], a[24:27]
    v_mfma_f32_16x16x32_bf16 a[28:31], v[36:39], v[124:127], a[28:31]
    buffer_load_dwordx4 v[36:39], v10, s[12:15], s34 offen offset:1024 sc1
    v_mfma_f32_16x16x32_bf16 a[32:35], v[40:43], v[112:115], a[32:35]
    v_mfma_f32_16x16x32_bf16 a[36:39], v[40:43], v[116:119], a[36:39]
    buffer_load_dwordx4 v8, s[8:11], s35 offen offset:2048 lds
    v_mfma_f32_16x16x32_bf16 a[40:43], v[40:43], v[120:123], a[40:43]
    v_mfma_f32_16x16x32_bf16 a[44:47], v[40:43], v[124:127], a[44:47]
    buffer_load_dwordx4 v[40:43], v10, s[12:15], s34 offen offset:2048 sc1
    v_mfma_f32_16x16x32_bf16 a[48:51], v[44:47], v[112:115], a[48:51]
    v_mfma_f32_16x16x32_bf16 a[52:55], v[44:47], v[116:119], a[52:55]
    buffer_load_dwordx4 v9, s[8:11], s35 offen offset:3072 lds
    v_mfma_f32_16x16x32_bf16 a[56:59], v[44:47], v[120:123], a[56:59]
    v_mfma_f32_16x16x32_bf16 a[60:63], v[44:47], v[124:127], a[60:63]
    buffer_load_dwordx4 v[44:47], v10, s[12:15], s34 offen offset:3072 sc1
    s_waitcnt vmcnt(17)
    ds_read_b64_tr_b16 v[128:129], v12 offset:4096
    ds_read_b64_tr_b16 v[130:131], v12 offset:6144
    ds_read_b64_tr_b16 v[132:133], v13 offset:4096
    ds_read_b64_tr_b16 v[134:135], v13 offset:6144
    ds_read_b64_tr_b16 v[136:137], v14 offset:4096
    ds_read_b64_tr_b16 v[138:139], v14 offset:6144
    ds_read_b64_tr_b16 v[140:141], v15 offset:4096
    ds_read_b64_tr_b16 v[142:143], v15 offset:6144
    v_mfma_f32_16x16x32_bf16 a[64:67], v[48:51], v[112:115], a[64:67]
    v_mfma_f32_16x16x32_bf16 a[68:71], v[48:51], v[116:119], a[68:71]
    v_mfma_f32_16x16x32_bf16 a[72:75], v[48:51], v[120:123], a[72:75]
    v_mfma_f32_16x16x32_bf16 a[76:79], v[48:51], v[124:127], a[76:79]
    buffer_load_dwordx4 v[48:51], v11, s[12:15], s34 offen sc1
    s_waitcnt lgkmcnt(0)
    s_add_u32 s32, s3, 1
    s_and_b32 s32, s32, 1
    s_add_u32 s32, s32, 12
    s_lshl_b32 s35, s32, 17
    s_add_u32 s35, s35, s37
    s_mul_i32 s34, s32, 5120
    s_add_u32 s34, s34, s36
    s_add_u32 m0, s33, 4096
    v_mfma_f32_16x16x32_bf16 a[0:3], v[52:55], v[128:131], a[0:3]
    v_mfma_f32_16x16x32_bf16 a[4:7], v[52:55], v[132:135], a[4:7]
    buffer_load_dwordx4 v6, s[8:11], s35 offen offset:0 lds
    v_mfma_f32_16x16x32_bf16 a[8:11], v[52:55], v[136:139], a[8:11]
    v_mfma_f32_16x16x32_bf16 a[12:15], v[52:55], v[140:143], a[12:15]
    buffer_load_dwordx4 v[52:55], v10, s[12:15], s34 offen offset:0 sc1
    v_mfma_f32_16x16x32_bf16 a[16:19], v[56:59], v[128:131], a[16:19]
    v_mfma_f32_16x16x32_bf16 a[20:23], v[56:59], v[132:135], a[20:23]
    buffer_load_dwordx4 v7, s[8:11], s35 offen offset:1024 lds
    v_mfma_f32_16x16x32_bf16 a[24:27], v[56:59], v[136:139], a[24:27]
    v_mfma_f32_16x16x32_bf16 a[28:31], v[56:59], v[140:143], a[28:31]
    buffer_load_dwordx4 v[56:59], v10, s[12:15], s34 offen offset:1024 sc1
    v_mfma_f32_16x16x32_bf16 a[32:35], v[60:63], v[128:131], a[32:35]
    v_mfma_f32_16x16x32_bf16 a[36:39], v[60:63], v[132:135], a[36:39]
    buffer_load_dwordx4 v8, s[8:11], s35 offen offset:2048 lds
    v_mfma_f32_16x16x32_bf16 a[40:43], v[60:63], v[136:139], a[40:43]
    v_mfma_f32_16x16x32_bf16 a[44:47], v[60:63], v[140:143], a[44:47]
    buffer_load_dwordx4 v[60:63], v10, s[12:15], s34 offen offset:2048 sc1
    v_mfma_f32_16x16x32_bf16 a[48:51], v[64:67], v[128:131], a[48:51]
    v_mfma_f32_16x16x32_bf16 a[52:55], v[64:67], v[132:135], a[52:55]
    buffer_load_dwordx4 v9, s[8:11], s35 offen offset:3072 lds
    v_mfma_f32_16x16x32_bf16 a[56:59], v[64:67], v[136:139], a[56:59]
    v_mfma_f32_16x16x32_bf16 a[60:63], v[64:67], v[140:143], a[60:63]
    buffer_load_dwordx4 v[64:67], v10, s[12:15], s34 offen offset:3072 sc1
    s_waitcnt vmcnt(17)
    ds_read_b64_tr_b16 v[144:145], v12 offset:8192
    ds_read_b64_tr_b16 v[146:147], v12 offset:10240
    ds_read_b64_tr_b16 v[148:149], v13 offset:8192
    ds_read_b64_tr_b16 v[150:151], v13 offset:10240
    ds_read_b64_tr_b16 v[152:153], v14 offset:8192
    ds_read_b64_tr_b16 v[154:155], v14 offset:10240
    ds_read_b64_tr_b16 v[156:157], v15 offset:8192
    ds_read_b64_tr_b16 v[158:159], v15 offset:10240
    v_mfma_f32_16x16x32_bf16 a[64:67], v[68:71], v[128:131], a[64:67]
    v_mfma_f32_16x16x32_bf16 a[68:71], v[68:71], v[132:135], a[68:71]
    v_mfma_f32_16x16x32_bf16 a[72:75], v[68:71], v[136:139], a[72:75]
    v_mfma_f32_16x16x32_bf16 a[76:79], v[68:71], v[140:143], a[76:79]
    buffer_load_dwordx4 v[68:71], v11, s[12:15], s34 offen sc1
    v_readfirstlane_b32 s6, v166
    s_nop 0
    s_cmp_ge_u32 s6, 8
    s_cbranch_scc1 K2_wa_ok
    s_mov_b32 s5, 0
K2_wa:
    buffer_load_dword v166, v167, s[20:23], s4 offen sc1
    s_waitcnt vmcnt(0)
    v_readfirstlane_b32 s6, v166
    s_nop 0
    s_cmp_ge_u32 s6, 8
    s_cbranch_scc1 K2_wa_ok
    s_add_u32 s5, s5, 1
    s_cmp_ge_u32 s5, 0x40000
    s_cbranch_scc1 K2_wa_ok
    s_sleep 2
    s_branch K2_wa
K2_wa_ok:
    s_waitcnt lgkmcnt(0)
    v_mfma_f32_16x16x32_bf16 a[0:3], v[72:75], v[144:147], a[0:3]
    v_mfma_f32_16x16x32_bf16 a[4:7], v[72:75], v[148:151], a[4:7]
    v_mfma_f32_16x16x32_bf16 a[8:11], v[72:75], v[152:155], a[8:11]
    v_mfma_f32_16x16x32_bf16 a[12:15], v[72:75], v[156:159], a[12:15]
    v_mfma_f32_16x16x32_bf16 a[16:19], v[76:79], v[144:147], a[16:19]
    v_mfma_f32_16x16x32_bf16 a[20:23], v[76:79], v[148:151], a[20:23]
    v_mfma_f32_16x16x32_bf16 a[24:27], v[76:79], v[152:155], a[24:27]
    v_mfma_f32_16x16x32_bf16 a[28:31], v[76:79], v[156:159], a[28:31]
    v_mfma_f32_16x16x32_bf16 a[32:35], v[80:83], v[144:147], a[32:35]
    v_mfma_f32_16x16x32_bf16 a[36:39], v[80:83], v[148:151], a[36:39]
    v_mfma_f32_16x16x32_bf16 a[40:43], v[80:83], v[152:155], a[40:43]
    v_mfma_f32_16x16x32_bf16 a[44:47], v[80:83], v[156:159], a[44:47]
    v_mfma_f32_16x16x32_bf16 a[48:51], v[84:87], v[144:147], a[48:51]
    v_mfma_f32_16x16x32_bf16 a[52:55], v[84:87], v[148:151], a[52:55]
    v_mfma_f32_16x16x32_bf16 a[56:59], v[84:87], v[152:155], a[56:59]
    v_mfma_f32_16x16x32_bf16 a[60:63], v[84:87], v[156:159], a[60:63]
    s_waitcnt vmcnt(9)
    ds_read_b64_tr_b16 v[112:113], v12 offset:0
    ds_read_b64_tr_b16 v[114:115], v12 offset:2048
    ds_read_b64_tr_b16 v[116:117], v13 offset:0
    ds_read_b64_tr_b16 v[118:119], v13 offset:2048
    ds_read_b64_tr_b16 v[120:121], v14 offset:0
    ds_read_b64_tr_b16 v[122:123], v14 offset:2048
    ds_read_b64_tr_b16 v[124:125], v15 offset:0
    ds_read_b64_tr_b16 v[126:127], v15 offset:2048
    v_mfma_f32_16x16x32_bf16 a[64:67], v[88:91], v[144:147], a[64:67]
    v_mfma_f32_16x16x32_bf16 a[68:71], v[88:91], v[148:151], a[68:71]
    v_mfma_f32_16x16x32_bf16 a[72:75], v[88:91], v[152:155], a[72:75]
    v_mfma_f32_16x16x32_bf16 a[76:79], v[88:91], v[156:159], a[76:79]
    s_add_u32 s32, s3, 0
    s_and_b32 s32, s32, 1
    s_lshl_b32 s35, s32, 12
    s_add_u32 s35, s35, s48
    s_mul_i32 s34, s32, 5120
    s_add_u32 s34, s34, s39
    buffer_load_dwordx4 v[144:147], v28, s[20:23], s35 offen sc1
    buffer_load_dwordx4 v[148:151], v29, s[20:23], s35 offen sc1
    buffer_load_dwordx4 v[152:155], v30, s[20:23], s35 offen sc1
    buffer_load_dwordx4 v[156:159], v31, s[20:23], s35 offen sc1
    buffer_load_dwordx4 v[72:75], v10, s[20:23], s34 offen offset:0
    buffer_load_dwordx4 v[76:79], v10, s[20:23], s34 offen offset:1024
    buffer_load_dwordx4 v[80:83], v10, s[20:23], s34 offen offset:2048
    buffer_load_dwordx4 v[84:87], v10, s[20:23], s34 offen offset:3072
    buffer_load_dwordx4 v[88:91], v11, s[20:23], s34 offen
    s_waitcnt lgkmcnt(0)
    v_mfma_f32_16x16x32_bf16 a[0:3], v[32:35], v[112:115], a[0:3]
    v_mfma_f32_16x16x32_bf16 a[4:7], v[32:35], v[116:119], a[4:7]
    v_mfma_f32_16x16x32_bf16 a[8:11], v[32:35], v[120:123], a[8:11]
    v_mfma_f32_16x16x32_bf16 a[12:15], v[32:35], v[124:127], a[12:15]
    v_mfma_f32_16x16x32_bf16 a[16:19], v[36:39], v[112:115], a[16:19]
    v_mfma_f32_16x16x32_bf16 a[20:23], v[36:39], v[116:119], a[20:23]
    v_mfma_f32_16x16x32_bf16 a[24:27], v[36:39], v[120:123], a[24:27]
    v_mfma_f32_16x16x32_bf16 a[28:31], v[36:39], v[124:127], a[28:31]
    v_mfma_f32_16x16x32_bf16 a[32:35], v[40:43], v[112:115], a[32:35]
    v_mfma_f32_16x16x32_bf16 a[36:39], v[40:43], v[116:119], a[36:39]
    v_mfma_f32_16x16x32_bf16 a[40:43], v[40:43], v[120:123], a[40:43]
    v_mfma_f32_16x16x32_bf16 a[44:47], v[40:43], v[124:127], a[44:47]
    v_mfma_f32_16x16x32_bf16 a[48:51], v[44:47], v[112:115], a[48:51]
    v_mfma_f32_16x16x32_bf16 a[52:55], v[44:47], v[116:119], a[52:55]
    v_mfma_f32_16x16x32_bf16 a[56:59], v[44:47], v[120:123], a[56:59]
    v_mfma_f32_16x16x32_bf16 a[60:63], v[44:47], v[124:127], a[60:63]
    s_waitcnt vmcnt(9)
    ds_read_b64_tr_b16 v[128:129], v12 offset:4096
    ds_read_b64_tr_b16 v[130:131], v12 offset:6144
    ds_read_b64_tr_b16 v[132:133], v13 offset:4096
    ds_read_b64_tr_b16 v[134:135], v13 offset:6144
    ds_read_b64_tr_b16 v[136:137], v14 offset:4096
    ds_read_b64_tr_b16 v[138:139], v14 offset:6144
    ds_read_b64_tr_b16 v[140:141], v15 offset:4096
    ds_read_b64_tr_b16 v[142:143], v15 offset:6144
    v_mfma_f32_16x16x32_bf16 a[64:67], v[48:51], v[112:115], a[64:67]
    v_mfma_f32_16x16x32_bf16 a[68:71], v[48:51], v[116:119], a[68:71]
    v_mfma_f32_16x16x32_bf16 a[72:75], v[48:51], v[120:123], a[72:75]
    v_mfma_f32_16x16x32_bf16 a[76:79], v[48:51], v[124:127], a[76:79]
    s_add_u32 s32, s3, 1
    s_and_b32 s32, s32, 1
    s_lshl_b32 s35, s32, 12
    s_add_u32 s35, s35, s48
    s_mul_i32 s34, s32, 5120
    s_add_u32 s34, s34, s39
    buffer_load_dwordx4 v[112:115], v28, s[20:23], s35 offen sc1
    buffer_load_dwordx4 v[116:119], v29, s[20:23], s35 offen sc1
    buffer_load_dwordx4 v[120:123], v30, s[20:23], s35 offen sc1
    buffer_load_dwordx4 v[124:127], v31, s[20:23], s35 offen sc1
    buffer_load_dwordx4 v[32:35], v10, s[20:23], s34 offen offset:0
    buffer_load_dwordx4 v[36:39], v10, s[20:23], s34 offen offset:1024
    buffer_load_dwordx4 v[40:43], v10, s[20:23], s34 offen offset:2048
    buffer_load_dwordx4 v[44:47], v10, s[20:23], s34 offen offset:3072
    buffer_load_dwordx4 v[48:51], v11, s[20:23], s34 offen
    s_waitcnt lgkmcnt(0)
    v_mfma_f32_16x16x32_bf16 a[0:3], v[52:55], v[128:131], a[0:3]
    v_mfma_f32_16x16x32_bf16 a[4:7], v[52:55], v[132:135], a[4:7]
    v_mfma_f32_16x16x32_bf16 a[8:11], v[52:55], v[136:139], a[8:11]
    v_mfma_f32_16x16x32_bf16 a[12:15], v[52:55], v[140:143], a[12:15]
    v_mfma_f32_16x16x32_bf16 a[16:19], v[56:59], v[128:131], a[16:19]
    v_mfma_f32_16x16x32_bf16 a[20:23], v[56:59], v[132:135], a[20:23]
    v_mfma_f32_16x16x32_bf16 a[24:27], v[56:59], v[136:139], a[24:27]
    v_mfma_f32_16x16x32_bf16 a[28:31], v[56:59], v[140:143], a[28:31]
    v_mfma_f32_16x16x32_bf16 a[32:35], v[60:63], v[128:131], a[32:35]
    v_mfma_f32_16x16x32_bf16 a[36:39], v[60:63], v[132:135], a[36:39]
    v_mfma_f32_16x16x32_bf16 a[40:43], v[60:63], v[136:139], a[40:43]
    v_mfma_f32_16x16x32_bf16 a[44:47], v[60:63], v[140:143], a[44:47]
    v_mfma_f32_16x16x32_bf16 a[48:51], v[64:67], v[128:131], a[48:51]
    v_mfma_f32_16x16x32_bf16 a[52:55], v[64:67], v[132:135], a[52:55]
    v_mfma_f32_16x16x32_bf16 a[56:59], v[64:67], v[136:139], a[56:59]
    v_mfma_f32_16x16x32_bf16 a[60:63], v[64:67], v[140:143], a[60:63]
    s_waitcnt vmcnt(9)
    v_mfma_f32_16x16x32_bf16 a[64:67], v[68:71], v[128:131], a[64:67]
    v_mfma_f32_16x16x32_bf16 a[68:71], v[68:71], v[132:135], a[68:71]
    v_mfma_f32_16x16x32_bf16 a[72:75], v[68:71], v[136:139], a[72:75]
    v_mfma_f32_16x16x32_bf16 a[76:79], v[68:71], v[140:143], a[76:79]
    s_add_u32 s32, s3, 0
    s_and_b32 s32, s32, 1
    s_add_u32 s32, s32, 2
    s_lshl_b32 s35, s32, 12
    s_add_u32 s35, s35, s48
    s_mul_i32 s34, s32, 5120
    s_add_u32 s34, s34, s39
    buffer_load_dwordx4 v[128:131], v28, s[20:23], s35 offen sc1
    buffer_load_dwordx4 v[132:135], v29, s[20:23], s35 offen sc1
    buffer_load_dwordx4 v[136:139], v30, s[20:23], s35 offen sc1
    buffer_load_dwordx4 v[140:143], v31, s[20:23], s35 offen sc1
    buffer_load_dwordx4 v[52:55], v10, s[20:23], s34 offen offset:0
    buffer_load_dwordx4 v[56:59], v10, s[20:23], s34 offen offset:1024
    buffer_load_dwordx4 v[60:63], v10, s[20:23], s34 offen offset:2048
    buffer_load_dwordx4 v[64:67], v10, s[20:23], s34 offen offset:3072
    buffer_load_dwordx4 v[68:71], v11, s[20:23], s34 offen
    v_mfma_f32_16x16x32_bf16 a[0:3], v[72:75], v[144:147], a[0:3]
    v_mfma_f32_16x16x32_bf16 a[4:7], v[72:75], v[148:151], a[4:7]
    v_mfma_f32_16x16x32_bf16 a[8:11], v[72:75], v[152:155], a[8:11]
    v_mfma_f32_16x16x32_bf16 a[12:15], v[72:75], v[156:159], a[12:15]
    v_mfma_f32_16x16x32_bf16 a[16:19], v[76:79], v[144:147], a[16:19]
    v_mfma_f32_16x16x32_bf16 a[20:23], v[76:79], v[148:151], a[20:23]
    v_mfma_f32_16x16x32_bf16 a[24:27], v[76:79], v[152:155], a[24:27]
    v_mfma_f32_16x16x32_bf16 a[28:31], v[76:79], v[156:159], a[28:31]
    v_mfma_f32_16x16x32_bf16 a[32:35], v[80:83], v[144:147], a[32:35]
    v_mfma_f32_16x16x32_bf16 a[36:39], v[80:83], v[148:151], a[36:39]
    v_mfma_f32_16x16x32_bf16 a[40:43], v[80:83], v[152:155], a[40:43]
    v_mfma_f32_16x16x32_bf16 a[44:47], v[80:83], v[156:159], a[44:47]
    v_mfma_f32_16x16x32_bf16 a[48:51], v[84:87], v[144:147], a[48:51]
    v_mfma_f32_16x16x32_bf16 a[52:55], v[84:87], v[148:151], a[52:55]
    v_mfma_f32_16x16x32_bf16 a[56:59], v[84:87], v[152:155], a[56:59]
    v_mfma_f32_16x16x32_bf16 a[60:63], v[84:87], v[156:159], a[60:63]
    s_waitcnt vmcnt(9)
    v_mfma_f32_16x16x32_bf16 a[64:67], v[88:91], v[144:147], a[64:67]
    v_mfma_f32_16x16x32_bf16 a[68:71], v[88:91], v[148:151], a[68:71]
    v_mfma_f32_16x16x32_bf16 a[72:75], v[88:91], v[152:155], a[72:75]
    v_mfma_f32_16x16x32_bf16 a[76:79], v[88:91], v[156:159], a[76:79]
    s_add_u32 s32, s3, 1
    s_and_b32 s32, s32, 1
    s_add_u32 s32, s32, 2
    s_lshl_b32 s35, s32, 12
    s_add_u32 s35, s35, s48
    s_mul_i32 s34, s32, 5120
    s_add_u32 s34, s34, s39
    buffer_load_dwordx4 v[144:147], v28, s[20:23], s35 offen sc1
    buffer_load_dwordx4 v[148:151], v29, s[20:23], s35 offen sc1
    buffer_load_dwordx4 v[152:155], v30, s[20:23], s35 offen sc1
    buffer_load_dwordx4 v[156:159], v31, s[20:23], s35 offen sc1
    buffer_load_dwordx4 v[72:75], v10, s[20:23], s34 offen offset:0
    buffer_load_dwordx4 v[76:79], v10, s[20:23], s34 offen offset:1024
    buffer_load_dwordx4 v[80:83], v10, s[20:23], s34 offen offset:2048
    buffer_load_dwordx4 v[84:87], v10, s[20:23], s34 offen offset:3072
    buffer_load_dwordx4 v[88:91], v11, s[20:23], s34 offen
    v_mfma_f32_16x16x32_bf16 a[0:3], v[32:35], v[112:115], a[0:3]
    v_mfma_f32_16x16x32_bf16 a[4:7], v[32:35], v[116:119], a[4:7]
    v_mfma_f32_16x16x32_bf16 a[8:11], v[32:35], v[120:123], a[8:11]
    v_mfma_f32_16x16x32_bf16 a[12:15], v[32:35], v[124:127], a[12:15]
    v_mfma_f32_16x16x32_bf16 a[16:19], v[36:39], v[112:115], a[16:19]
    v_mfma_f32_16x16x32_bf16 a[20:23], v[36:39], v[116:119], a[20:23]
    v_mfma_f32_16x16x32_bf16 a[24:27], v[36:39], v[120:123], a[24:27]
    v_mfma_f32_16x16x32_bf16 a[28:31], v[36:39], v[124:127], a[28:31]
    v_mfma_f32_16x16x32_bf16 a[32:35], v[40:43], v[112:115], a[32:35]
    v_mfma_f32_16x16x32_bf16 a[36:39], v[40:43], v[116:119], a[36:39]
    v_mfma_f32_16x16x32_bf16 a[40:43], v[40:43], v[120:123], a[40:43]
    v_mfma_f32_16x16x32_bf16 a[44:47], v[40:43], v[124:127], a[44:47]
    v_mfma_f32_16x16x32_bf16 a[48:51], v[44:47], v[112:115], a[48:51]
    v_mfma_f32_16x16x32_bf16 a[52:55], v[44:47], v[116:119], a[52:55]
    v_mfma_f32_16x16x32_bf16 a[56:59], v[44:47], v[120:123], a[56:59]
    v_mfma_f32_16x16x32_bf16 a[60:63], v[44:47], v[124:127], a[60:63]
    s_waitcnt vmcnt(9)
    v_mfma_f32_16x16x32_bf16 a[64:67], v[48:51], v[112:115], a[64:67]
    v_mfma_f32_16x16x32_bf16 a[68:71], v[48:51], v[116:119], a[68:71]
    v_mfma_f32_16x16x32_bf16 a[72:75], v[48:51], v[120:123], a[72:75]
    v_mfma_f32_16x16x32_bf16 a[76:79], v[48:51], v[124:127], a[76:79]
    s_mov_b32 s32, 0
    s_add_u32 s32, s32, 4
    s_lshl_b32 s35, s32, 12
    s_add_u32 s35, s35, s48
    s_mul_i32 s34, s32, 5120
    s_add_u32 s34, s34, s39
    buffer_load_dwordx4 v[112:115], v28, s[20:23], s35 offen sc1
    buffer_load_dwordx4 v[116:119], v29, s[20:23], s35 offen sc1
    buffer_load_dwordx4 v[120:123], v30, s[20:23], s35 offen sc1
    buffer_load_dwordx4 v[124:127], v31, s[20:23], s35 offen sc1
    buffer_load_dwordx4 v[32:35], v10, s[20:23], s34 offen offset:0
    buffer_load_dwordx4 v[36:39], v10, s[20:23], s34 offen offset:1024
    buffer_load_dwordx4 v[40:43], v10, s[20:23], s34 offen offset:2048
    buffer_load_dwordx4 v[44:47], v10, s[20:23], s34 offen offset:3072
    buffer_load_dwordx4 v[48:51], v11, s[20:23], s34 offen
    v_mfma_f32_16x16x32_bf16 a[0:3], v[52:55], v[128:131], a[0:3]
    v_mfma_f32_16x16x32_bf16 a[4:7], v[52:55], v[132:135], a[4:7]
    v_mfma_f32_16x16x32_bf16 a[8:11], v[52:55], v[136:139], a[8:11]
    v_mfma_f32_16x16x32_bf16 a[12:15], v[52:55], v[140:143], a[12:15]
    v_mfma_f32_16x16x32_bf16 a[16:19], v[56:59], v[128:131], a[16:19]
    v_mfma_f32_16x16x32_bf16 a[20:23], v[56:59], v[132:135], a[20:23]
    v_mfma_f32_16x16x32_bf16 a[24:27], v[56:59], v[136:139], a[24:27]
    v_mfma_f32_16x16x32_bf16 a[28:31], v[56:59], v[140:143], a[28:31]
    v_mfma_f32_16x16x32_bf16 a[32:35], v[60:63], v[128:131], a[32:35]
    v_mfma_f32_16x16x32_bf16 a[36:39], v[60:63], v[132:135], a[36:39]
    v_mfma_f32_16x16x32_bf16 a[40:43], v[60:63], v[136:139], a[40:43]
    v_mfma_f32_16x16x32_bf16 a[44:47], v[60:63], v[140:143], a[44:47]
    v_mfma_f32_16x16x32_bf16 a[48:51], v[64:67], v[128:131], a[48:51]
    v_mfma_f32_16x16x32_bf16 a[52:55], v[64:67], v[132:135], a[52:55]
    v_mfma_f32_16x16x32_bf16 a[56:59], v[64:67], v[136:139], a[56:59]
    v_mfma_f32_16x16x32_bf16 a[60:63], v[64:67], v[140:143], a[60:63]
    s_waitcnt vmcnt(9)
    v_mfma_f32_16x16x32_bf16 a[64:67], v[68:71], v[128:131], a[64:67]
    v_mfma_f32_16x16x32_bf16 a[68:71], v[68:71], v[132:135], a[68:71]
    v_mfma_f32_16x16x32_bf16 a[72:75], v[68:71], v[136:139], a[72:75]
    v_mfma_f32_16x16x32_bf16 a[76:79], v[68:71], v[140:143], a[76:79]
    v_mul_u32_u24 v16, 1280, v3
    v_mul_u32_u24 v4, 40, v2
    v_add_u32 v16, v16, v4
    s_lshl_b32 s29, s27, 2
    s_add_u32 s29, s29, s24
    s_mul_i32 s49, s29, 20480
    s_mul_i32 s30, s28, 160
    s_add_u32 s49, s49, s30
    s_lshl_b32 s29, s29, 5
    v_lshlrev_b32 v4, 1, v3
    buffer_load_dwordx4 v[18:21], v16, s[40:43], s49 offen
    buffer_load_dwordx4 v[22:25], v16, s[40:43], s49 offen offset:16
    buffer_load_dwordx2 v[26:27], v16, s[40:43], s49 offen offset:32
    buffer_load_ushort v17, v4, s[16:19], s29 offen
    v_mfma_f32_16x16x32_bf16 a[0:3], v[72:75], v[144:147], a[0:3]
    v_mfma_f32_16x16x32_bf16 a[4:7], v[72:75], v[148:151], a[4:7]
    v_mfma_f32_16x16x32_bf16 a[8:11], v[72:75], v[152:155], a[8:11]
    v_mfma_f32_16x16x32_bf16 a[12:15], v[72:75], v[156:159], a[12:15]
    v_mfma_f32_16x16x32_bf16 a[16:19], v[76:79], v[144:147], a[16:19]
    v_mfma_f32_16x16x32_bf16 a[20:23], v[76:79], v[148:151], a[20:23]
    v_mfma_f32_16x16x32_bf16 a[24:27], v[76:79], v[152:155], a[24:27]
    v_mfma_f32_16x16x32_bf16 a[28:31], v[76:79], v[156:159], a[28:31]
    v_mfma_f32_16x16x32_bf16 a[32:35], v[80:83], v[144:147], a[32:35]
    v_mfma_f32_16x16x32_bf16 a[36:39], v[80:83], v[148:151], a[36:39]
    v_mfma_f32_16x16x32_bf16 a[40:43], v[80:83], v[152:155], a[40:43]
    v_mfma_f32_16x16x32_bf16 a[44:47], v[80:83], v[156:159], a[44:47]
    v_mfma_f32_16x16x32_bf16 a[48:51], v[84:87], v[144:147], a[48:51]
    v_mfma_f32_16x16x32_bf16 a[52:55], v[84:87], v[148:151], a[52:55]
    v_mfma_f32_16x16x32_bf16 a[56:59], v[84:87], v[152:155], a[56:59]
    v_mfma_f32_16x16x32_bf16 a[60:63], v[84:87], v[156:159], a[60:63]
    s_waitcnt vmcnt(4)
    v_mfma_f32_16x16x32_bf16 a[64:67], v[88:91], v[144:147], a[64:67]
    v_mfma_f32_16x16x32_bf16 a[68:71], v[88:91], v[148:151], a[68:71]
    v_mfma_f32_16x16x32_bf16 a[72:75], v[88:91], v[152:155], a[72:75]
    v_mfma_f32_16x16x32_bf16 a[76:79], v[88:91], v[156:159], a[76:79]
    v_add_u32 v4, s33, v10
    v_mfma_f32_16x16x32_bf16 a[4:7], v[32:35], v[116:119], a[4:7]
    v_mfma_f32_16x16x32_bf16 a[20:23], v[36:39], v[116:119], a[20:23]
    v_mfma_f32_16x16x32_bf16 a[36:39], v[40:43], v[116:119], a[36:39]
    v_mfma_f32_16x16x32_bf16 a[52:55], v[44:47], v[116:119], a[52:55]
    v_mfma_f32_16x16x32_bf16 a[68:71], v[48:51], v[116:119], a[68:71]
    v_mfma_f32_16x16x32_bf16 a[8:11], v[32:35], v[120:123], a[8:11]
    s_nop 2
    ds_write_b128 v4, a[4:7] offset:0
    v_mfma_f32_16x16x32_bf16 a[24:27], v[36:39], v[120:123], a[24:27]
    ds_write_b128 v4, a[20:23] offset:1024
    v_mfma_f32_16x16x32_bf16 a[40:43], v[40:43], v[120:123], a[40:43]
    ds_write_b128 v4, a[36:39] offset:2048
    v_mfma_f32_16x16x32_bf16 a[56:59], v[44:47], v[120:123], a[56:59]
    ds_write_b128 v4, a[52:55] offset:3072
    v_mfma_f32_16x16x32_bf16 a[72:75], v[48:51], v[120:123], a[72:75]
    ds_write_b128 v4, a[68:71] offset:4096
    v_mfma_f32_16x16x32_bf16 a[12:15], v[32:35], v[124:127], a[12:15]
    ds_write_b128 v4, a[8:11] offset:5120
    v_mfma_f32_16x16x32_bf16 a[28:31], v[36:39], v[124:127], a[28:31]
    ds_write_b128 v4, a[24:27] offset:6144
    v_mfma_f32_16x16x32_bf16 a[44:47], v[40:43], v[124:127], a[44:47]
    ds_write_b128 v4, a[40:43] offset:7168
    v_mfma_f32_16x16x32_bf16 a[60:63], v[44:47], v[124:127], a[60:63]
    ds_write_b128 v4, a[56:59] offset:8192
    v_mfma_f32_16x16x32_bf16 a[76:79], v[48:51], v[124:127], a[76:79]
    ds_write_b128 v4, a[72:75] offset:9216
    v_mfma_f32_16x16x32_bf16 a[0:3], v[32:35], v[112:115], a[0:3]
    ds_write_b128 v4, a[12:15] offset:10240
    v_mfma_f32_16x16x32_bf16 a[16:19], v[36:39], v[112:115], a[16:19]
    ds_write_b128 v4, a[28:31] offset:11264
    v_mfma_f32_16x16x32_bf16 a[32:35], v[40:43], v[112:115], a[32:35]
    ds_write_b128 v4, a[44:47] offset:12288
    v_mfma_f32_16x16x32_bf16 a[48:51], v[44:47], v[112:115], a[48:51]
    ds_write_b128 v4, a[60:63] offset:13312
    v_mfma_f32_16x16x32_bf16 a[64:67], v[48:51], v[112:115], a[64:67]
    ds_write_b128 v4, a[76:79] offset:14336
K2_epi:
    s_sub_u32 s29, s24, 1
    s_and_b32 s29, s29, 3
    s_mul_i32 s29, s29, 20480
    s_add_u32 s29, s29, 0
    v_add_u32 v13, s29, v10
    s_sub_u32 s29, s24, 2
    s_and_b32 s29, s29, 3
    s_mul_i32 s29, s29, 20480
    s_add_u32 s29, s29, 5120
    v_add_u32 v14, s29, v10
    s_sub_u32 s29, s24, 3
    s_and_b32 s29, s29, 3
    s_mul_i32 s29, s29, 20480
    s_add_u32 s29, s29, 10240
    v_add_u32 v15, s29, v10
    v_accvgpr_read_b32 v112, a0
    v_accvgpr_read_b32 v113, a1
    v_accvgpr_read_b32 v114, a2
    v_accvgpr_read_b32 v115, a3
    v_accvgpr_read_b32 v116, a16
    v_accvgpr_read_b32 v117, a17
    v_accvgpr_read_b32 v118, a18
    v_accvgpr_read_b32 v119, a19
    v_accvgpr_read_b32 v120, a32
    v_accvgpr_read_b32 v121, a33
    v_accvgpr_read_b32 v122, a34
    v_accvgpr_read_b32 v123, a35
    v_accvgpr_read_b32 v124, a48
    v_accvgpr_read_b32 v125, a49
    v_accvgpr_read_b32 v126, a50
    v_accvgpr_read_b32 v127, a51
    v_accvgpr_read_b32 v128, a64
    v_accvgpr_read_b32 v129, a65
    v_accvgpr_read_b32 v130, a66
    v_accvgpr_read_b32 v131, a67
    s_waitcnt lgkmcnt(0)
    s_cbranch_execz K2_nb
    s_barrier
K2_nb:
    ds_read_b128 v[32:35], v13 offset:0
    ds_read_b128 v[36:39], v14 offset:0
    ds_read_b128 v[40:43], v15 offset:0
    ds_read_b128 v[44:47], v13 offset:1024
    ds_read_b128 v[48:51], v14 offset:1024
    ds_read_b128 v[52:55], v15 offset:1024
    ds_read_b128 v[56:59], v13 offset:2048
    ds_read_b128 v[60:63], v14 offset:2048
    ds_read_b128 v[64:67], v15 offset:2048
    ds_read_b128 v[68:71], v13 offset:3072
    ds_read_b128 v[72:75], v14 offset:3072
    ds_read_b128 v[76:79], v15 offset:3072
    ds_read_b128 v[80:83], v13 offset:4096
    ds_read_b128 v[84:87], v14 offset:4096
    ds_read_b128 v[88:91], v15 offset:4096
    s_waitcnt vmcnt(0)
    v_lshlrev_b32 v17, 16, v17
    v_lshlrev_b32 v92, 16, v18
    v_and_b32 v93, 0xffff0000, v18
    v_lshlrev_b32 v94, 16, v19
    v_and_b32 v95, 0xffff0000, v19
    v_lshlrev_b32 v96, 16, v20
    v_and_b32 v97, 0xffff0000, v20
    v_lshlrev_b32 v98, 16, v21
    v_and_b32 v99, 0xffff0000, v21
    v_lshlrev_b32 v100, 16, v22
    v_and_b32 v101, 0xffff0000, v22
    v_lshlrev_b32 v102, 16, v23
    v_and_b32 v103, 0xffff0000, v23
    v_lshlrev_b32 v104, 16, v24
    v_and_b32 v105, 0xffff0000, v24
    v_lshlrev_b32 v106, 16, v25
    v_and_b32 v107, 0xffff0000, v25
    v_lshlrev_b32 v108, 16, v26
    v_and_b32 v109, 0xffff0000, v26
    v_lshlrev_b32 v110, 16, v27
    v_and_b32 v111, 0xffff0000, v27
    v_pk_add_f32 v[112:113], v[112:113], v[16:17] op_sel:[0,1] op_sel_hi:[1,1]
    v_pk_add_f32 v[114:115], v[114:115], v[16:17] op_sel:[0,1] op_sel_hi:[1,1]
    v_pk_add_f32 v[116:117], v[116:117], v[16:17] op_sel:[0,1] op_sel_hi:[1,1]
    v_pk_add_f32 v[118:119], v[118:119], v[16:17] op_sel:[0,1] op_sel_hi:[1,1]
    v_pk_add_f32 v[120:121], v[120:121], v[16:17] op_sel:[0,1] op_sel_hi:[1,1]
    v_pk_add_f32 v[122:123], v[122:123], v[16:17] op_sel:[0,1] op_sel_hi:[1,1]
    v_pk_add_f32 v[124:125], v[124:125], v[16:17] op_sel:[0,1] op_sel_hi:[1,1]
    v_pk_add_f32 v[126:127], v[126:127], v[16:17] op_sel:[0,1] op_sel_hi:[1,1]
    v_pk_add_f32 v[128:129], v[128:129], v[16:17] op_sel:[0,1] op_sel_hi:[1,1]
    v_pk_add_f32 v[130:131], v[130:131], v[16:17] op_sel:[0,1] op_sel_hi:[1,1]
    v_pk_add_f32 v[92:93], v[92:93], v[112:113]
    v_pk_add_f32 v[94:95], v[94:95], v[114:115]
    v_pk_add_f32 v[96:97], v[96:97], v[116:117]
    v_pk_add_f32 v[98:99], v[98:99], v[118:119]
    v_pk_add_f32 v[100:101], v[100:101], v[120:121]
    v_pk_add_f32 v[102:103], v[102:103], v[122:123]
    v_pk_add_f32 v[104:105], v[104:105], v[124:125]
    v_pk_add_f32 v[106:107], v[106:107], v[126:127]
    v_pk_add_f32 v[108:109], v[108:109], v[128:129]
    v_pk_add_f32 v[110:111], v[110:111], v[130:131]
    s_waitcnt lgkmcnt(12)
    v_pk_add_f32 v[32:33], v[32:33], v[36:37]
    v_pk_add_f32 v[34:35], v[34:35], v[38:39]
    v_pk_add_f32 v[92:93], v[92:93], v[40:41]
    v_pk_add_f32 v[94:95], v[94:95], v[42:43]
    v_pk_add_f32 v[32:33], v[32:33], v[92:93]
    v_pk_add_f32 v[34:35], v[34:35], v[94:95]
    v_cvt_pk_bf16_f32 v18, v32, v33
    v_cvt_pk_bf16_f32 v19, v34, v35
    s_waitcnt lgkmcnt(9)
    v_pk_add_f32 v[44:45], v[44:45], v[48:49]
    v_pk_add_f32 v[46:47], v[46:47], v[50:51]
    v_pk_add_f32 v[96:97], v[96:97], v[52:53]
    v_pk_add_f32 v[98:99], v[98:99], v[54:55]
    v_pk_add_f32 v[44:45], v[44:45], v[96:97]
    v_pk_add_f32 v[46:47], v[46:47], v[98:99]
    v_cvt_pk_bf16_f32 v20, v44, v45
    v_cvt_pk_bf16_f32 v21, v46, v47
    s_waitcnt lgkmcnt(6)
    v_pk_add_f32 v[56:57], v[56:57], v[60:61]
    v_pk_add_f32 v[58:59], v[58:59], v[62:63]
    v_pk_add_f32 v[100:101], v[100:101], v[64:65]
    v_pk_add_f32 v[102:103], v[102:103], v[66:67]
    v_pk_add_f32 v[56:57], v[56:57], v[100:101]
    v_pk_add_f32 v[58:59], v[58:59], v[102:103]
    v_cvt_pk_bf16_f32 v22, v56, v57
    v_cvt_pk_bf16_f32 v23, v58, v59
    s_waitcnt lgkmcnt(3)
    v_pk_add_f32 v[68:69], v[68:69], v[72:73]
    v_pk_add_f32 v[70:71], v[70:71], v[74:75]
    v_pk_add_f32 v[104:105], v[104:105], v[76:77]
    v_pk_add_f32 v[106:107], v[106:107], v[78:79]
    v_pk_add_f32 v[68:69], v[68:69], v[104:105]
    v_pk_add_f32 v[70:71], v[70:71], v[106:107]
    v_cvt_pk_bf16_f32 v24, v68, v69
    v_cvt_pk_bf16_f32 v25, v70, v71
    s_waitcnt lgkmcnt(0)
    v_pk_add_f32 v[80:81], v[80:81], v[84:85]
    v_pk_add_f32 v[82:83], v[82:83], v[86:87]
    v_pk_add_f32 v[108:109], v[108:109], v[88:89]
    v_pk_add_f32 v[110:111], v[110:111], v[90:91]
    v_pk_add_f32 v[80:81], v[80:81], v[108:109]
    v_pk_add_f32 v[82:83], v[82:83], v[110:111]
    v_cvt_pk_bf16_f32 v26, v80, v81
    v_cvt_pk_bf16_f32 v27, v82, v83
    s_cbranch_execz K2_end
    buffer_store_dwordx4 v[18:21], v16, s[44:47], s49 offen
    buffer_store_dwordx4 v[22:25], v16, s[44:47], s49 offen offset:16
    buffer_store_dwordx2 v[26:27], v16, s[44:47], s49 offen offset:32
K2_end:
    s_endpgm
K1_end:
    s_endpgm
CODE_END:
.section .rodata,"a"
.p2align 6
.amdhsa_kernel kp_kernel
  .amdhsa_next_free_vgpr 136
  .amdhsa_next_free_sgpr 102
  .amdhsa_accum_offset 136
  .amdhsa_group_segment_fixed_size 0
  .amdhsa_kernarg_size 96
  .amdhsa_user_sgpr_count 2
  .amdhsa_user_sgpr_kernarg_segment_ptr 1
  .amdhsa_system_sgpr_workgroup_id_x 1
  .amdhsa_float_denorm_mode_32 3
.end_amdhsa_kernel
.p2align 6
.amdhsa_kernel k1_kernel
  .amdhsa_next_free_vgpr 420
  .amdhsa_next_free_sgpr 102
  .amdhsa_accum_offset 256
  .amdhsa_group_segment_fixed_size 0
  .amdhsa_kernarg_size 96
  .amdhsa_user_sgpr_count 2
  .amdhsa_user_sgpr_kernarg_segment_ptr 1
  .amdhsa_system_sgpr_workgroup_id_x 1
  .amdhsa_float_denorm_mode_32 3
.end_amdhsa_kernel
```
